```python
import torch

def _softmax(x, axis=-1):
    return torch.softmax(x, dim=axis)
def _gelu(x):
    return torch.nn.functional.gelu(x, approximate="tanh")
def _silu(x):
    return torch.nn.functional.silu(x)
def _sigmoid(x):
    return torch.sigmoid(x)
def _layernorm(x, axis=-1, eps=1e-5):
    m = x.mean(dim=axis, keepdim=True)
    v = x.var(dim=axis, keepdim=True, unbiased=False)
    return (x - m) / torch.sqrt(v + eps)
def _scatter_add(tgt, idx, src, axis=0):
    return tgt.clone().index_add_(axis, idx, src)
def _segment_sum(src, seg, n):
    out = torch.zeros((n,) + src.shape[1:], dtype=src.dtype)
    return out.index_add_(0, seg, src)
def _pad(x, pw):
    flat = tuple(v for pair in reversed(pw) for v in pair)
    return torch.nn.functional.pad(x, flat)

kernel_name = 'concat_heads__gqa_block_cached__gqa_block_cached__near_ridge'

def setup_inputs():

    _w = (lambda a: (lambda t: t.to(torch.bfloat16) if t.is_floating_point() else t)(torch.as_tensor(a)))
    def _A_setup():
        B, Sq, D = 8, 160, 576
        Hq, Hkv, Sk, Dh = 32, 16, 1024, 128
        assert Hq % Hkv == 0, (Hq, Hkv)
        return {
            "x": _w((lambda *s: torch.randn(*s, dtype=torch.bfloat16) * 0.8)(B, Sq, D)),
            "k_cache": _w((lambda *s: torch.randn(*s, dtype=torch.bfloat16) * 0.8)(B, Hkv, Sk, Dh)),
            "v_cache": _w((lambda *s: torch.randn(*s, dtype=torch.bfloat16) * 0.05)(B, Hkv, Sk, Dh)),
            "wq": _w((lambda *s: torch.randn(*s, dtype=torch.bfloat16) * 0.8)(D, Hq * Dh) * (D ** -0.5)),
            "wo": _w((lambda *s: torch.randn(*s, dtype=torch.bfloat16) * 0.05)(Hq * Dh, D) * ((Hq * Dh) ** -0.5)),
        }
    _A_in = _A_setup()

    def _B_setup():
        B, Sq, D = 8, 160, 576
        Hq, Hkv, Sk, Dh = 32, 16, 1024, 128
        assert Hq % Hkv == 0, (Hq, Hkv)
        return {
            "x": _w((lambda *s: torch.randn(*s, dtype=torch.bfloat16) * 0.8)(B, Sq, D)),
            "k_cache": _w((lambda *s: torch.randn(*s, dtype=torch.bfloat16) * 0.8)(B, Hkv, Sk, Dh)),
            "v_cache": _w((lambda *s: torch.randn(*s, dtype=torch.bfloat16) * 0.05)(B, Hkv, Sk, Dh)),
            "wq": _w((lambda *s: torch.randn(*s, dtype=torch.bfloat16) * 0.8)(D, Hq * Dh) * (D ** -0.5)),
            "wo": _w((lambda *s: torch.randn(*s, dtype=torch.bfloat16) * 0.05)(Hq * Dh, D) * ((Hq * Dh) ** -0.5)),
        }
    _B_in = _B_setup()

    return {
        "A_x": _A_in["x"],
        "A_k_cache": _A_in["k_cache"],
        "A_v_cache": _A_in["v_cache"],
        "A_wq": _A_in["wq"],
        "A_wo": _A_in["wo"],
        "B_x": _B_in["x"],
        "B_k_cache": _B_in["k_cache"],
        "B_v_cache": _B_in["v_cache"],
        "B_wq": _B_in["wq"],
        "B_wo": _B_in["wo"],
    }

def reference(A_x, A_k_cache, A_v_cache, A_wq, A_wo, B_x, B_k_cache, B_v_cache, B_wq, B_wo):
    def _A_ref(x, k_cache, v_cache, wq, wo):
        B, Sq, D = x.shape
        Hq, Dh = 32, 128
        Hkv = k_cache.shape[1]
        rep = Hq // Hkv
        q = (lambda x, *d: x.permute(*d))((x @ wq).reshape(B, Sq, Hq, Dh), 0, 2, 1, 3)
        k = (lambda x, n, axis: torch.repeat_interleave(x, n, dim=axis))(k_cache, rep, axis=1)
        v = (lambda x, n, axis: torch.repeat_interleave(x, n, dim=axis))(v_cache, rep, axis=1)
        scores = torch.einsum("bhqd,bhkd->bhqk", q, k) * (Dh ** -0.5)
        p = _softmax(scores, axis=-1)
        o = torch.einsum("bhqk,bhkd->bhqd", p, v)
        return (lambda x, *d: x.permute(*d))(o, 0, 2, 1, 3).reshape(B, Sq, Hq * Dh) @ wo

    def _B_ref(x, k_cache, v_cache, wq, wo):
        B, Sq, D = x.shape
        Hq, Dh = 32, 128
        Hkv = k_cache.shape[1]
        rep = Hq // Hkv
        q = (lambda x, *d: x.permute(*d))((x @ wq).reshape(B, Sq, Hq, Dh), 0, 2, 1, 3)
        k = (lambda x, n, axis: torch.repeat_interleave(x, n, dim=axis))(k_cache, rep, axis=1)
        v = (lambda x, n, axis: torch.repeat_interleave(x, n, dim=axis))(v_cache, rep, axis=1)
        scores = torch.einsum("bhqd,bhkd->bhqk", q, k) * (Dh ** -0.5)
        p = _softmax(scores, axis=-1)
        o = torch.einsum("bhqk,bhkd->bhqd", p, v)
        return (lambda x, *d: x.permute(*d))(o, 0, 2, 1, 3).reshape(B, Sq, Hq * Dh) @ wo

    a = _A_ref(A_x, A_k_cache, A_v_cache, A_wq, A_wo)
    b = _B_ref(B_x, B_k_cache, B_v_cache, B_wq, B_wo)
    return torch.concatenate([a, b], axis=-1)
```

```asm
; @launch grid=(256,1,1) block=(256,1,1) lds=163840
.amdgcn_target "amdgcn-amd-amdhsa--gfx950"
.text
.globl concat_heads__gqa_block_cached__gqa_block_cached__near_ridge_kernel
.p2align 8
.type concat_heads__gqa_block_cached__gqa_block_cached__near_ridge_kernel,@function
concat_heads__gqa_block_cached__gqa_block_cached__near_ridge_kernel:
K1_START:
    s_cmp_ge_u32 s2, 256
    s_cbranch_scc1 K1_END
    s_and_b32 s3, s2, 7
    s_lshr_b32 s14, s2, 3
    s_lshr_b32 s37, s3, 2
    s_and_b32 s3, s3, 3
    s_lshl_b32 s3, s3, 2
    s_and_b32 s39, s14, 3
    s_add_u32 s39, s39, s3
    s_lshr_b32 s38, s14, 2
    s_mul_i32 s3, s37, 40
    s_add_u32 s14, s0, s3
    s_addc_u32 s15, s1, 0
    s_load_dwordx8 s[4:11], s[14:15], 0
    s_load_dwordx2 s[12:13], s[0:1], 96
    s_load_dwordx2 s[88:89], s[14:15], 32
    s_load_dwordx2 s[100:101], s[0:1], 88
    s_load_dwordx2 s[58:59], s[0:1], 80
    v_and_b32 v1, 63, v0
    v_lshrrev_b32 v201, 6, v0
    s_nop 0
    v_readfirstlane_b32 s36, v201
    v_lshrrev_b32 v201, 2, v1
    v_mul_u32_u24 v201, 1152, v201
    v_lshrrev_b32 v202, 4, v1
    v_sub_u32 v202, 0, v202
    v_and_b32 v202, 3, v202
    v_and_b32 v203, 3, v1
    v_xor_b32 v202, v202, v203
    v_lshl_add_u32 v2, v202, 4, v201
    v_lshrrev_b32 v201, 5, v1
    v_lshlrev_b32 v201, 16, v201
    v_and_b32 v202, 31, v1
    v_lshl_add_u32 v3, v202, 4, v201
    s_waitcnt lgkmcnt(0)
    s_or_b32 s14, s2, s36
    s_cmp_lg_u32 s14, 0
    s_cbranch_scc1 K1_NONON
    s_memrealtime s[44:45]
    s_waitcnt lgkmcnt(0)
    s_or_b32 s44, s44, 1
    v_mov_b32 v201, 0
    v_mov_b32 v202, s44
    global_store_dword v201, v202, s[100:101] sc1
K1_NONON:
    s_mul_i32 s3, s38, 184320
    s_add_u32 s16, s4, s3
    s_addc_u32 s17, s5, 0
    s_mov_b32 s18, 184320
    s_mov_b32 s19, 0x20000
    s_lshl_b32 s3, s39, 9
    s_add_u32 s20, s10, s3
    s_addc_u32 s21, s11, 0
    s_sub_u32 s22, 4718592, s3
    s_mov_b32 s23, 0x20000
    s_lshl_b32 s3, s38, 4
    s_add_u32 s3, s3, s39
    s_lshr_b32 s14, s3, 14
    s_lshl_b32 s3, s3, 18
    s_add_u32 s24, s6, s3
    s_addc_u32 s25, s7, s14
    s_sub_u32 s24, s24, 2400
    s_subb_u32 s25, s25, 0
    s_mov_b32 s26, 264544
    s_mov_b32 s27, 0x20000
    s_add_u32 s28, s8, s3
    s_addc_u32 s29, s9, s14
    s_sub_u32 s28, s28, 2400
    s_subb_u32 s29, s29, 0
    s_mov_b32 s30, 264544
    s_mov_b32 s31, 0x20000
    s_lshl_b32 s3, s37, 3
    s_add_u32 s3, s3, s38
    s_mul_i32 s3, s3, 1310720
    s_lshl_b32 s14, s39, 1
    s_lshr_b32 s15, s36, 1
    s_add_u32 s14, s14, s15
    s_lshl_b32 s14, s14, 12
    s_add_u32 s3, s3, s14
    s_and_b32 s15, s36, 1
    s_mul_i32 s15, s15, 655360
    s_add_u32 s3, s3, s15
    s_add_u32 s32, s12, s3
    s_addc_u32 s33, s13, 0
    s_mov_b32 s34, 528384
    s_mov_b32 s35, 0x20000
    s_mul_i32 s3, s36, 3
    s_lshl_b32 s14, s36, 1
    s_add_u32 s14, s14, 1
    s_cmp_lt_u32 s36, 2
    s_cselect_b32 s3, s3, s14
    s_mul_i32 s40, s3, 18432
    s_lshl_b32 s41, s3, 10
    s_and_b32 s3, s36, 1
    s_lshl_b32 s3, s3, 2
    s_lshr_b32 s14, s36, 1
    s_lshl_b32 s14, s14, 4
    s_add_u32 s3, s3, s14
    s_lshl_b32 s42, s3, 13
    s_mul_i32 s43, s36, 4352
    s_add_u32 s43, s43, 10240
    s_mul_i32 s47, s36, 4224
    v_add_u32 v62, 17408, v2
    v_add_u32 v63, 34816, v2
    v_add_u32 v64, 7104, v3
    v_add_u32 v65, 14208, v3
    v_add_u32 v66, 21312, v3
    s_and_b32 s3, s39, 3
    s_mul_i32 s3, s3, 5
    s_lshl_b32 s98, s38, 1
    s_add_u32 s98, s98, s3
    s_cmp_ge_u32 s98, 18
    s_cselect_b32 s3, 18, 0
    s_sub_u32 s98, s98, s3
    s_lshl_b32 s96, s98, 6
    s_add_u32 s96, s96, s40
    s_lshl_b32 s97, s98, 18
    s_add_u32 s97, s97, s42
    s_add_u32 m0, s41, 135168
    s_nop 0
    buffer_load_dwordx4 v2, s[16:19], s96 offen offset:0 lds
    buffer_load_dwordx4 v62, s[16:19], s96 offen offset:1024 lds
    buffer_load_dwordx4 v63, s[16:19], s96 offen offset:2048 lds
    s_add_u32 m0, s43, 135168
    s_nop 0
    buffer_load_dwordx4 v3, s[20:23], s97 offen offset:0 lds
    buffer_load_dwordx4 v64, s[20:23], s97 offen offset:1088 lds
    buffer_load_dwordx4 v65, s[20:23], s97 offen offset:2176 lds
    buffer_load_dwordx4 v66, s[20:23], s97 offen offset:3264 lds
    s_add_u32 s98, s98, 1
    s_cmp_ge_u32 s98, 18
    s_cselect_b32 s98, 0, s98
    s_lshl_b32 s96, s98, 6
    s_add_u32 s96, s96, s40
    s_lshl_b32 s97, s98, 18
    s_add_u32 s97, s97, s42
    s_getpc_b64 s[14:15]
K1_PC:
    s_sub_u32 s14, s14, K1_PC-K1_START
    s_subb_u32 s15, s15, 0
    s_lshr_b32 s3, s2, 3
    s_lshl_b32 s3, s3, 2
    s_add_u32 s3, s3, s36
    s_lshl_b32 s3, s3, 6
    v_add_u32 v72, s3, v1
    v_lshlrev_b32 v72, 7, v72
    v_min_u32 v72, K1_END-K1_START, v72
    global_load_dword v73, v72, s[14:15]
    v_and_b32 v201, 15, v1
    v_lshrrev_b32 v202, 2, v201
    v_sub_u32 v202, 0, v202
    v_and_b32 v202, 3, v202
    v_lshrrev_b32 v203, 4, v1
    v_xor_b32 v202, v202, v203
    v_lshlrev_b32 v202, 4, v202
    v_lshl_add_u32 v202, v201, 6, v202
    s_and_b32 s3, s36, 1
    s_mul_i32 s3, s3, 5120
    v_add_u32 v202, s3, v202
    v_add_u32 v56, 135168, v202
    v_add_u32 v57, 101376, v202
    v_add_u32 v58, 33792, v202
    v_lshrrev_b32 v201, 2, v1
    v_and_b32 v201, 3, v201
    v_lshrrev_b32 v202, 5, v1
    v_lshl_add_u32 v201, v202, 3, v201
    v_mul_u32_u24 v201, 1088, v201
    v_lshrrev_b32 v202, 4, v1
    v_and_b32 v202, 1, v202
    v_lshl_add_u32 v201, v202, 9, v201
    v_and_b32 v202, 3, v1
    v_lshl_add_u32 v201, v202, 4, v201
    s_lshr_b32 s3, s36, 1
    s_lshl_b32 s3, s3, 8
    v_add_u32 v201, s3, v201
    v_add_u32 v59, 145408, v201
    v_add_u32 v60, 111616, v201
    v_add_u32 v61, 44032, v201
    v_lshrrev_b32 v201, 4, v1
    v_and_b32 v202, 15, v1
    v_lshlrev_b32 v202, 4, v202
    v_lshl_add_u32 v203, v201, 12, v202
    s_lshl_b32 s3, s36, 10
    v_add_u32 v203, s3, v203
    v_add_u32 v6, 2400, v203
    v_add_u32 v7, 1600, v203
    v_add_u32 v8, 800, v203
    v_add_u32 v9, 0, v203
    v_lshl_add_u32 v203, v201, 11, v202
    s_lshr_b32 s3, s36, 1
    s_lshl_b32 s3, s3, 13
    s_and_b32 s14, s36, 1
    s_lshl_b32 s14, s14, 10
    s_add_u32 s3, s3, s14
    v_add_u32 v203, s3, v203
    v_add_u32 v10, 2400, v203
    v_add_u32 v11, 1600, v203
    v_add_u32 v12, 800, v203
    v_add_u32 v13, 0, v203
    v_and_b32 v202, 15, v1
    v_mul_u32_u24 v202, 1056, v202
    v_lshl_add_u32 v14, v201, 4, v202
    v_lshrrev_b32 v202, 2, v1
    v_and_b32 v202, 7, v202
    v_mul_u32_u24 v202, 1056, v202
    v_lshrrev_b32 v203, 5, v1
    v_lshl_add_u32 v202, v203, 8, v202
    v_and_b32 v203, 3, v1
    v_lshl_add_u32 v15, v203, 3, v202
    v_add_u32 v201, 0, v1
    v_mul_u32_u24 v202, 52429, v201
    v_lshrrev_b32 v202, 20, v202
    v_mul_u32_u24 v203, 20, v202
    v_sub_u32 v203, v201, v203
    v_lshrrev_b32 v201, 1, v202
    v_and_b32 v201, 2, v201
    v_xor_b32 v203, v203, v201
    v_mul_u32_u24 v202, 1152, v202
    v_lshl_add_u32 v202, v203, 4, v202
    v_add_u32 v202, 8192, v202
    v_accvgpr_write_b32 a224, v202
    v_add_u32 v201, 64, v1
    v_mul_u32_u24 v202, 52429, v201
    v_lshrrev_b32 v202, 20, v202
    v_mul_u32_u24 v203, 20, v202
    v_sub_u32 v203, v201, v203
    v_lshrrev_b32 v201, 1, v202
    v_and_b32 v201, 2, v201
    v_xor_b32 v203, v203, v201
    v_mul_u32_u24 v202, 1152, v202
    v_lshl_add_u32 v202, v203, 4, v202
    v_add_u32 v202, 7168, v202
    v_accvgpr_write_b32 a225, v202
    v_add_u32 v201, 128, v1
    v_mul_u32_u24 v202, 52429, v201
    v_lshrrev_b32 v202, 20, v202
    v_mul_u32_u24 v203, 20, v202
    v_sub_u32 v203, v201, v203
    v_lshrrev_b32 v201, 1, v202
    v_and_b32 v201, 2, v201
    v_xor_b32 v203, v203, v201
    v_mul_u32_u24 v202, 1152, v202
    v_lshl_add_u32 v202, v203, 4, v202
    v_add_u32 v202, 6144, v202
    v_accvgpr_write_b32 a226, v202
    v_add_u32 v201, 192, v1
    v_mul_u32_u24 v202, 52429, v201
    v_lshrrev_b32 v202, 20, v202
    v_mul_u32_u24 v203, 20, v202
    v_sub_u32 v203, v201, v203
    v_lshrrev_b32 v201, 1, v202
    v_and_b32 v201, 2, v201
    v_xor_b32 v203, v203, v201
    v_mul_u32_u24 v202, 1152, v202
    v_lshl_add_u32 v202, v203, 4, v202
    v_add_u32 v202, 5120, v202
    v_accvgpr_write_b32 a227, v202
    v_add_u32 v201, 256, v1
    v_mul_u32_u24 v202, 52429, v201
    v_lshrrev_b32 v202, 20, v202
    v_mul_u32_u24 v203, 20, v202
    v_sub_u32 v203, v201, v203
    v_lshrrev_b32 v201, 1, v202
    v_and_b32 v201, 2, v201
    v_xor_b32 v203, v203, v201
    v_mul_u32_u24 v202, 1152, v202
    v_lshl_add_u32 v202, v203, 4, v202
    v_add_u32 v202, 8192, v202
    v_accvgpr_write_b32 a228, v202
    v_add_u32 v201, 320, v1
    v_mul_u32_u24 v202, 52429, v201
    v_lshrrev_b32 v202, 20, v202
    v_mul_u32_u24 v203, 20, v202
    v_sub_u32 v203, v201, v203
    v_lshrrev_b32 v201, 1, v202
    v_and_b32 v201, 2, v201
    v_xor_b32 v203, v203, v201
    v_mul_u32_u24 v202, 1152, v202
    v_lshl_add_u32 v202, v203, 4, v202
    v_add_u32 v202, 7168, v202
    v_accvgpr_write_b32 a229, v202
    v_add_u32 v201, 384, v1
    v_mul_u32_u24 v202, 52429, v201
    v_lshrrev_b32 v202, 20, v202
    v_mul_u32_u24 v203, 20, v202
    v_sub_u32 v203, v201, v203
    v_lshrrev_b32 v201, 1, v202
    v_and_b32 v201, 2, v201
    v_xor_b32 v203, v203, v201
    v_mul_u32_u24 v202, 1152, v202
    v_lshl_add_u32 v202, v203, 4, v202
    v_add_u32 v202, 6144, v202
    v_accvgpr_write_b32 a230, v202
    v_add_u32 v201, 448, v1
    v_mul_u32_u24 v202, 52429, v201
    v_lshrrev_b32 v202, 20, v202
    v_mul_u32_u24 v203, 20, v202
    v_sub_u32 v203, v201, v203
    v_lshrrev_b32 v201, 1, v202
    v_and_b32 v201, 2, v201
    v_xor_b32 v203, v203, v201
    v_mul_u32_u24 v202, 1152, v202
    v_lshl_add_u32 v202, v203, 4, v202
    v_add_u32 v202, 5120, v202
    v_accvgpr_write_b32 a231, v202
    v_add_u32 v201, 512, v1
    v_mul_u32_u24 v202, 52429, v201
    v_lshrrev_b32 v202, 20, v202
    v_mul_u32_u24 v203, 20, v202
    v_sub_u32 v203, v201, v203
    v_lshrrev_b32 v201, 1, v202
    v_and_b32 v201, 2, v201
    v_xor_b32 v203, v203, v201
    v_mul_u32_u24 v202, 1152, v202
    v_lshl_add_u32 v202, v203, 4, v202
    v_add_u32 v202, 8192, v202
    v_accvgpr_write_b32 a232, v202
    v_add_u32 v201, 576, v1
    v_mul_u32_u24 v202, 52429, v201
    v_lshrrev_b32 v202, 20, v202
    v_mul_u32_u24 v203, 20, v202
    v_sub_u32 v203, v201, v203
    v_lshrrev_b32 v201, 1, v202
    v_and_b32 v201, 2, v201
    v_xor_b32 v203, v203, v201
    v_mul_u32_u24 v202, 1152, v202
    v_lshl_add_u32 v202, v203, 4, v202
    v_add_u32 v202, 7168, v202
    v_accvgpr_write_b32 a233, v202
    v_lshrrev_b32 v201, 2, v1
    v_mul_u32_u24 v201, 320, v201
    v_and_b32 v202, 3, v1
    v_lshl_add_u32 v201, v202, 3, v201
    s_lshr_b32 s3, s36, 1
    s_mul_i32 s3, s3, 20480
    s_and_b32 s14, s39, 1
    s_lshl_b32 s15, s14, 5
    s_add_u32 s3, s3, s15
    v_add_u32 v201, s3, v201
    v_lshrrev_b32 v202, 4, v1
    v_and_b32 v202, 1, v202
    v_lshlrev_b32 v202, 5, v202
    v_add_u32 v203, v201, v202
    v_sub_u32 v201, v201, v202
    s_cmp_eq_u32 s14, 0
    s_cselect_b64 vcc, -1, 0
    v_cndmask_b32 v202, v201, v203, vcc
    v_accvgpr_write_b32 a234, v202
    v_cndmask_b32 v202, v203, v201, vcc
    v_accvgpr_write_b32 a235, v202
    v_mov_b32 v68, 0
    v_mov_b32 v69, 0
    v_mov_b32 v70, 0
    v_mov_b32 v71, 0
    s_nop 1
    v_mfma_f32_32x32x16_bf16 v[96:111], v[68:71], v[68:71], 0
    v_mfma_f32_32x32x16_bf16 v[112:127], v[68:71], v[68:71], 0
    v_mfma_f32_32x32x16_bf16 v[128:143], v[68:71], v[68:71], 0
    v_mfma_f32_32x32x16_bf16 v[144:159], v[68:71], v[68:71], 0
    v_mfma_f32_32x32x16_bf16 v[160:175], v[68:71], v[68:71], 0
    v_mfma_f32_32x32x16_bf16 v[176:191], v[68:71], v[68:71], 0
    v_mfma_f32_32x32x16_bf16 v[192:207], v[68:71], v[68:71], 0
    v_mfma_f32_32x32x16_bf16 v[208:223], v[68:71], v[68:71], 0
    v_mfma_f32_32x32x16_bf16 v[224:239], v[68:71], v[68:71], 0
    v_mfma_f32_32x32x16_bf16 v[240:255], v[68:71], v[68:71], 0
    v_mfma_f32_32x32x16_bf16 a[0:15], v[68:71], v[68:71], 0
    v_mfma_f32_32x32x16_bf16 a[16:31], v[68:71], v[68:71], 0
    v_mfma_f32_32x32x16_bf16 a[32:47], v[68:71], v[68:71], 0
    v_mfma_f32_32x32x16_bf16 a[48:63], v[68:71], v[68:71], 0
    v_mfma_f32_32x32x16_bf16 a[64:79], v[68:71], v[68:71], 0
    v_mfma_f32_32x32x16_bf16 a[80:95], v[68:71], v[68:71], 0
    v_mfma_f32_32x32x16_bf16 a[96:111], v[68:71], v[68:71], 0
    v_mfma_f32_32x32x16_bf16 a[112:127], v[68:71], v[68:71], 0
    v_mfma_f32_32x32x16_bf16 a[128:143], v[68:71], v[68:71], 0
    v_mfma_f32_32x32x16_bf16 a[144:159], v[68:71], v[68:71], 0
    s_add_u32 m0, s41, 101376
    s_nop 0
    buffer_load_dwordx4 v2, s[16:19], s96 offen offset:0 lds
    buffer_load_dwordx4 v62, s[16:19], s96 offen offset:1024 lds
    buffer_load_dwordx4 v63, s[16:19], s96 offen offset:2048 lds
    s_add_u32 m0, s43, 101376
    s_nop 0
    buffer_load_dwordx4 v3, s[20:23], s97 offen offset:0 lds
    buffer_load_dwordx4 v64, s[20:23], s97 offen offset:1088 lds
    buffer_load_dwordx4 v65, s[20:23], s97 offen offset:2176 lds
    buffer_load_dwordx4 v66, s[20:23], s97 offen offset:3264 lds
    s_add_u32 s98, s98, 1
    s_cmp_ge_u32 s98, 18
    s_cselect_b32 s98, 0, s98
    s_lshl_b32 s96, s98, 6
    s_add_u32 s96, s96, s40
    s_lshl_b32 s97, s98, 18
    s_add_u32 s97, s97, s42
    s_waitcnt vmcnt(8)
    s_barrier
    ds_read_b128 v[16:19], v56 offset:0
    ds_read_b128 v[20:23], v56 offset:1024
    ds_read_b128 v[24:27], v56 offset:2048
    ds_read_b128 v[28:31], v56 offset:3072
    ds_read_b128 v[32:35], v56 offset:4096
    ds_read_b64_tr_b16 a[160:161], v59 offset:0
    ds_read_b64_tr_b16 a[162:163], v59 offset:4352
    ds_read_b64_tr_b16 a[164:165], v59 offset:8
    ds_read_b64_tr_b16 a[166:167], v59 offset:4360
    ds_read_b64_tr_b16 a[168:169], v59 offset:64
    ds_read_b64_tr_b16 a[170:171], v59 offset:4416
    ds_read_b64_tr_b16 a[172:173], v59 offset:72
    ds_read_b64_tr_b16 a[174:175], v59 offset:4424
    ds_read_b64_tr_b16 a[176:177], v59 offset:128
    ds_read_b64_tr_b16 a[178:179], v59 offset:4480
    ds_read_b64_tr_b16 a[180:181], v59 offset:136
    ds_read_b64_tr_b16 a[182:183], v59 offset:4488
    ds_read_b64_tr_b16 a[184:185], v59 offset:192
    ds_read_b64_tr_b16 a[186:187], v59 offset:4544
    ds_read_b64_tr_b16 a[188:189], v59 offset:200
    ds_read_b64_tr_b16 a[190:191], v59 offset:4552
    s_add_u32 m0, s41, 33792
    s_nop 0
    buffer_load_dwordx4 v2, s[16:19], s96 offen offset:0 lds
    buffer_load_dwordx4 v62, s[16:19], s96 offen offset:1024 lds
    buffer_load_dwordx4 v63, s[16:19], s96 offen offset:2048 lds
    s_add_u32 m0, s43, 33792
    s_nop 0
    buffer_load_dwordx4 v3, s[20:23], s97 offen offset:0 lds
    buffer_load_dwordx4 v64, s[20:23], s97 offen offset:1088 lds
    buffer_load_dwordx4 v65, s[20:23], s97 offen offset:2176 lds
    buffer_load_dwordx4 v66, s[20:23], s97 offen offset:3264 lds
    s_add_u32 s98, s98, 1
    s_cmp_ge_u32 s98, 18
    s_cselect_b32 s98, 0, s98
    s_lshl_b32 s96, s98, 6
    s_add_u32 s96, s96, s40
    s_lshl_b32 s97, s98, 18
    s_add_u32 s97, s97, s42
    v_lshlrev_b32 v74, 14, v1
    v_add_u32 v74, 2400, v74
    buffer_load_dword v75, v74, s[24:27], 0 offen
    buffer_load_dword v76, v74, s[28:31], 0 offen
    s_waitcnt lgkmcnt(0)
    v_mfma_f32_16x16x32_bf16 v[96:99], a[160:163], v[16:19], v[96:99]
    v_mfma_f32_16x16x32_bf16 v[100:103], a[160:163], v[20:23], v[100:103]
    v_mfma_f32_16x16x32_bf16 v[104:107], a[160:163], v[24:27], v[104:107]
    v_mfma_f32_16x16x32_bf16 v[108:111], a[160:163], v[28:31], v[108:111]
    v_mfma_f32_16x16x32_bf16 v[112:115], a[160:163], v[32:35], v[112:115]
    v_mfma_f32_16x16x32_bf16 v[116:119], a[164:167], v[16:19], v[116:119]
    v_mfma_f32_16x16x32_bf16 v[120:123], a[164:167], v[20:23], v[120:123]
    v_mfma_f32_16x16x32_bf16 v[124:127], a[164:167], v[24:27], v[124:127]
    v_mfma_f32_16x16x32_bf16 v[128:131], a[164:167], v[28:31], v[128:131]
    v_mfma_f32_16x16x32_bf16 v[132:135], a[164:167], v[32:35], v[132:135]
    v_mfma_f32_16x16x32_bf16 v[136:139], a[168:171], v[16:19], v[136:139]
    v_mfma_f32_16x16x32_bf16 v[140:143], a[168:171], v[20:23], v[140:143]
    v_mfma_f32_16x16x32_bf16 v[144:147], a[168:171], v[24:27], v[144:147]
    v_mfma_f32_16x16x32_bf16 v[148:151], a[168:171], v[28:31], v[148:151]
    v_mfma_f32_16x16x32_bf16 v[152:155], a[168:171], v[32:35], v[152:155]
    v_mfma_f32_16x16x32_bf16 v[156:159], a[172:175], v[16:19], v[156:159]
    v_mfma_f32_16x16x32_bf16 v[160:163], a[172:175], v[20:23], v[160:163]
    v_mfma_f32_16x16x32_bf16 v[164:167], a[172:175], v[24:27], v[164:167]
    v_mfma_f32_16x16x32_bf16 v[168:171], a[172:175], v[28:31], v[168:171]
    v_mfma_f32_16x16x32_bf16 v[172:175], a[172:175], v[32:35], v[172:175]
    v_mfma_f32_16x16x32_bf16 v[176:179], a[176:179], v[16:19], v[176:179]
    v_mfma_f32_16x16x32_bf16 v[180:183], a[176:179], v[20:23], v[180:183]
    v_mfma_f32_16x16x32_bf16 v[184:187], a[176:179], v[24:27], v[184:187]
    v_mfma_f32_16x16x32_bf16 v[188:191], a[176:179], v[28:31], v[188:191]
    s_waitcnt vmcnt(9) lgkmcnt(0)
    s_barrier
    v_mfma_f32_16x16x32_bf16 v[192:195], a[176:179], v[32:35], v[192:195]
    s_add_u32 m0, s41, 135168
    v_mfma_f32_16x16x32_bf16 v[196:199], a[180:183], v[16:19], v[196:199]
    buffer_load_dwordx4 v2, s[16:19], s96 offen offset:0 lds
    v_mfma_f32_16x16x32_bf16 v[200:203], a[180:183], v[20:23], v[200:203]
    ds_read_b128 v[36:39], v57 offset:0
    ds_read_b128 v[40:43], v57 offset:1024
    ds_read_b128 v[44:47], v57 offset:2048
    ds_read_b128 v[48:51], v57 offset:3072
    ds_read_b128 v[52:55], v57 offset:4096
    v_mfma_f32_16x16x32_bf16 v[204:207], a[180:183], v[24:27], v[204:207]
    buffer_load_dwordx4 v62, s[16:19], s96 offen offset:1024 lds
    v_mfma_f32_16x16x32_bf16 v[208:211], a[180:183], v[28:31], v[208:211]
    ds_read_b64_tr_b16 a[192:193], v60 offset:0
    ds_read_b64_tr_b16 a[194:195], v60 offset:4352
    ds_read_b64_tr_b16 a[196:197], v60 offset:8
    ds_read_b64_tr_b16 a[198:199], v60 offset:4360
    v_mfma_f32_16x16x32_bf16 v[212:215], a[180:183], v[32:35], v[212:215]
    buffer_load_dwordx4 v63, s[16:19], s96 offen offset:2048 lds
    v_mfma_f32_16x16x32_bf16 v[216:219], a[184:187], v[16:19], v[216:219]
    s_add_u32 m0, s43, 135168
    v_mfma_f32_16x16x32_bf16 v[220:223], a[184:187], v[20:23], v[220:223]
    buffer_load_dwordx4 v3, s[20:23], s97 offen offset:0 lds
    v_mfma_f32_16x16x32_bf16 v[224:227], a[184:187], v[24:27], v[224:227]
    ds_read_b64_tr_b16 a[200:201], v60 offset:64
    ds_read_b64_tr_b16 a[202:203], v60 offset:4416
    ds_read_b64_tr_b16 a[204:205], v60 offset:72
    ds_read_b64_tr_b16 a[206:207], v60 offset:4424
    v_mfma_f32_16x16x32_bf16 v[228:231], a[184:187], v[28:31], v[228:231]
    buffer_load_dwordx4 v64, s[20:23], s97 offen offset:1088 lds
    v_mfma_f32_16x16x32_bf16 v[232:235], a[184:187], v[32:35], v[232:235]
    ds_read_b64_tr_b16 a[208:209], v60 offset:128
    ds_read_b64_tr_b16 a[210:211], v60 offset:4480
    ds_read_b64_tr_b16 a[212:213], v60 offset:136
    ds_read_b64_tr_b16 a[214:215], v60 offset:4488
    v_mfma_f32_16x16x32_bf16 v[236:239], a[188:191], v[16:19], v[236:239]
    buffer_load_dwordx4 v65, s[20:23], s97 offen offset:2176 lds
    v_mfma_f32_16x16x32_bf16 v[240:243], a[188:191], v[20:23], v[240:243]
    ds_read_b64_tr_b16 a[216:217], v60 offset:192
    ds_read_b64_tr_b16 a[218:219], v60 offset:4544
    ds_read_b64_tr_b16 a[220:221], v60 offset:200
    ds_read_b64_tr_b16 a[222:223], v60 offset:4552
    v_mfma_f32_16x16x32_bf16 v[244:247], a[188:191], v[24:27], v[244:247]
    buffer_load_dwordx4 v66, s[20:23], s97 offen offset:3264 lds
    v_mfma_f32_16x16x32_bf16 v[248:251], a[188:191], v[28:31], v[248:251]
    v_mfma_f32_16x16x32_bf16 v[252:255], a[188:191], v[32:35], v[252:255]
    s_add_u32 s98, s98, 1
    s_cmp_ge_u32 s98, 18
    s_cselect_b32 s98, 0, s98
    s_lshl_b32 s96, s98, 6
    s_add_u32 s96, s96, s40
    s_lshl_b32 s97, s98, 18
    s_add_u32 s97, s97, s42
    s_waitcnt vmcnt(9) lgkmcnt(0)
    s_barrier
    v_mfma_f32_16x16x32_bf16 v[96:99], a[192:195], v[36:39], v[96:99]
    ds_read_b128 v[16:19], v58 offset:0
    v_mfma_f32_16x16x32_bf16 v[100:103], a[192:195], v[40:43], v[100:103]
    s_add_u32 m0, s41, 101376
    v_mfma_f32_16x16x32_bf16 v[104:107], a[192:195], v[44:47], v[104:107]
    buffer_load_dwordx4 v2, s[16:19], s96 offen offset:0 lds
    v_mfma_f32_16x16x32_bf16 v[108:111], a[192:195], v[48:51], v[108:111]
    ds_read_b128 v[20:23], v58 offset:1024
    v_mfma_f32_16x16x32_bf16 v[112:115], a[192:195], v[52:55], v[112:115]
    ds_read_b128 v[24:27], v58 offset:2048
    v_mfma_f32_16x16x32_bf16 v[116:119], a[196:199], v[36:39], v[116:119]
    ds_read_b128 v[28:31], v58 offset:3072
    v_mfma_f32_16x16x32_bf16 v[120:123], a[196:199], v[40:43], v[120:123]
    ds_read_b128 v[32:35], v58 offset:4096
    v_mfma_f32_16x16x32_bf16 v[124:127], a[196:199], v[44:47], v[124:127]
    buffer_load_dwordx4 v62, s[16:19], s96 offen offset:1024 lds
    v_mfma_f32_16x16x32_bf16 v[128:131], a[196:199], v[48:51], v[128:131]
    ds_read_b64_tr_b16 a[160:161], v61 offset:0
    v_mfma_f32_16x16x32_bf16 v[132:135], a[196:199], v[52:55], v[132:135]
    v_mfma_f32_16x16x32_bf16 v[136:139], a[200:203], v[36:39], v[136:139]
    ds_read_b64_tr_b16 a[162:163], v61 offset:4352
    v_mfma_f32_16x16x32_bf16 v[140:143], a[200:203], v[40:43], v[140:143]
    ds_read_b64_tr_b16 a[164:165], v61 offset:8
    v_mfma_f32_16x16x32_bf16 v[144:147], a[200:203], v[44:47], v[144:147]
    buffer_load_dwordx4 v63, s[16:19], s96 offen offset:2048 lds
    v_mfma_f32_16x16x32_bf16 v[148:151], a[200:203], v[48:51], v[148:151]
    ds_read_b64_tr_b16 a[166:167], v61 offset:4360
    v_mfma_f32_16x16x32_bf16 v[152:155], a[200:203], v[52:55], v[152:155]
    ds_read_b64_tr_b16 a[168:169], v61 offset:64
    v_mfma_f32_16x16x32_bf16 v[156:159], a[204:207], v[36:39], v[156:159]
    ds_read_b64_tr_b16 a[170:171], v61 offset:4416
    v_mfma_f32_16x16x32_bf16 v[160:163], a[204:207], v[40:43], v[160:163]
    s_add_u32 m0, s43, 101376
    v_mfma_f32_16x16x32_bf16 v[164:167], a[204:207], v[44:47], v[164:167]
    buffer_load_dwordx4 v3, s[20:23], s97 offen offset:0 lds
    v_mfma_f32_16x16x32_bf16 v[168:171], a[204:207], v[48:51], v[168:171]
    v_mfma_f32_16x16x32_bf16 v[172:175], a[204:207], v[52:55], v[172:175]
    ds_read_b64_tr_b16 a[172:173], v61 offset:72
    v_mfma_f32_16x16x32_bf16 v[176:179], a[208:211], v[36:39], v[176:179]
    ds_read_b64_tr_b16 a[174:175], v61 offset:4424
    v_mfma_f32_16x16x32_bf16 v[180:183], a[208:211], v[40:43], v[180:183]
    ds_read_b64_tr_b16 a[176:177], v61 offset:128
    v_mfma_f32_16x16x32_bf16 v[184:187], a[208:211], v[44:47], v[184:187]
    buffer_load_dwordx4 v64, s[20:23], s97 offen offset:1088 lds
    v_mfma_f32_16x16x32_bf16 v[188:191], a[208:211], v[48:51], v[188:191]
    ds_read_b64_tr_b16 a[178:179], v61 offset:4480
    v_mfma_f32_16x16x32_bf16 v[192:195], a[208:211], v[52:55], v[192:195]
    ds_read_b64_tr_b16 a[180:181], v61 offset:136
    v_mfma_f32_16x16x32_bf16 v[196:199], a[212:215], v[36:39], v[196:199]
    v_mfma_f32_16x16x32_bf16 v[200:203], a[212:215], v[40:43], v[200:203]
    ds_read_b64_tr_b16 a[182:183], v61 offset:4488
    v_mfma_f32_16x16x32_bf16 v[204:207], a[212:215], v[44:47], v[204:207]
    buffer_load_dwordx4 v65, s[20:23], s97 offen offset:2176 lds
    v_mfma_f32_16x16x32_bf16 v[208:211], a[212:215], v[48:51], v[208:211]
    ds_read_b64_tr_b16 a[184:185], v61 offset:192
    v_mfma_f32_16x16x32_bf16 v[212:215], a[212:215], v[52:55], v[212:215]
    ds_read_b64_tr_b16 a[186:187], v61 offset:4544
    v_mfma_f32_16x16x32_bf16 v[216:219], a[216:219], v[36:39], v[216:219]
    ds_read_b64_tr_b16 a[188:189], v61 offset:200
    v_mfma_f32_16x16x32_bf16 v[220:223], a[216:219], v[40:43], v[220:223]
    ds_read_b64_tr_b16 a[190:191], v61 offset:4552
    v_mfma_f32_16x16x32_bf16 v[224:227], a[216:219], v[44:47], v[224:227]
    buffer_load_dwordx4 v66, s[20:23], s97 offen offset:3264 lds
    v_mfma_f32_16x16x32_bf16 v[228:231], a[216:219], v[48:51], v[228:231]
    s_add_u32 s98, s98, 1
    s_cmp_ge_u32 s98, 18
    s_cselect_b32 s98, 0, s98
    v_mfma_f32_16x16x32_bf16 v[232:235], a[216:219], v[52:55], v[232:235]
    v_mfma_f32_16x16x32_bf16 v[236:239], a[220:223], v[36:39], v[236:239]
    v_mfma_f32_16x16x32_bf16 v[240:243], a[220:223], v[40:43], v[240:243]
    s_lshl_b32 s96, s98, 6
    s_add_u32 s96, s96, s40
    v_mfma_f32_16x16x32_bf16 v[244:247], a[220:223], v[44:47], v[244:247]
    v_mfma_f32_16x16x32_bf16 v[248:251], a[220:223], v[48:51], v[248:251]
    v_mfma_f32_16x16x32_bf16 v[252:255], a[220:223], v[52:55], v[252:255]
    s_lshl_b32 s97, s98, 18
    s_add_u32 s97, s97, s42
    s_waitcnt vmcnt(7) lgkmcnt(0)
    s_barrier
    v_mfma_f32_16x16x32_bf16 v[96:99], a[160:163], v[16:19], v[96:99]
    ds_read_b128 v[36:39], v56 offset:0
    v_mfma_f32_16x16x32_bf16 v[100:103], a[160:163], v[20:23], v[100:103]
    s_add_u32 m0, s41, 33792
    v_mfma_f32_16x16x32_bf16 v[104:107], a[160:163], v[24:27], v[104:107]
    buffer_load_dwordx4 v2, s[16:19], s96 offen offset:0 lds
    v_mfma_f32_16x16x32_bf16 v[108:111], a[160:163], v[28:31], v[108:111]
    ds_read_b128 v[40:43], v56 offset:1024
    v_mfma_f32_16x16x32_bf16 v[112:115], a[160:163], v[32:35], v[112:115]
    ds_read_b128 v[44:47], v56 offset:2048
    v_mfma_f32_16x16x32_bf16 v[116:119], a[164:167], v[16:19], v[116:119]
    ds_read_b128 v[48:51], v56 offset:3072
    v_mfma_f32_16x16x32_bf16 v[120:123], a[164:167], v[20:23], v[120:123]
    ds_read_b128 v[52:55], v56 offset:4096
    v_mfma_f32_16x16x32_bf16 v[124:127], a[164:167], v[24:27], v[124:127]
    buffer_load_dwordx4 v62, s[16:19], s96 offen offset:1024 lds
    v_mfma_f32_16x16x32_bf16 v[128:131], a[164:167], v[28:31], v[128:131]
    ds_read_b64_tr_b16 a[192:193], v59 offset:0
    v_mfma_f32_16x16x32_bf16 v[132:135], a[164:167], v[32:35], v[132:135]
    v_mfma_f32_16x16x32_bf16 v[136:139], a[168:171], v[16:19], v[136:139]
    ds_read_b64_tr_b16 a[194:195], v59 offset:4352
    v_mfma_f32_16x16x32_bf16 v[140:143], a[168:171], v[20:23], v[140:143]
    ds_read_b64_tr_b16 a[196:197], v59 offset:8
    v_mfma_f32_16x16x32_bf16 v[144:147], a[168:171], v[24:27], v[144:147]
    buffer_load_dwordx4 v63, s[16:19], s96 offen offset:2048 lds
    v_mfma_f32_16x16x32_bf16 v[148:151], a[168:171], v[28:31], v[148:151]
    ds_read_b64_tr_b16 a[198:199], v59 offset:4360
    v_mfma_f32_16x16x32_bf16 v[152:155], a[168:171], v[32:35], v[152:155]
    ds_read_b64_tr_b16 a[200:201], v59 offset:64
    v_mfma_f32_16x16x32_bf16 v[156:159], a[172:175], v[16:19], v[156:159]
    ds_read_b64_tr_b16 a[202:203], v59 offset:4416
    v_mfma_f32_16x16x32_bf16 v[160:163], a[172:175], v[20:23], v[160:163]
    s_add_u32 m0, s43, 33792
    v_mfma_f32_16x16x32_bf16 v[164:167], a[172:175], v[24:27], v[164:167]
    buffer_load_dwordx4 v3, s[20:23], s97 offen offset:0 lds
    v_mfma_f32_16x16x32_bf16 v[168:171], a[172:175], v[28:31], v[168:171]
    v_mfma_f32_16x16x32_bf16 v[172:175], a[172:175], v[32:35], v[172:175]
    ds_read_b64_tr_b16 a[204:205], v59 offset:72
    v_mfma_f32_16x16x32_bf16 v[176:179], a[176:179], v[16:19], v[176:179]
    ds_read_b64_tr_b16 a[206:207], v59 offset:4424
    v_mfma_f32_16x16x32_bf16 v[180:183], a[176:179], v[20:23], v[180:183]
    ds_read_b64_tr_b16 a[208:209], v59 offset:128
    v_mfma_f32_16x16x32_bf16 v[184:187], a[176:179], v[24:27], v[184:187]
    buffer_load_dwordx4 v64, s[20:23], s97 offen offset:1088 lds
    v_mfma_f32_16x16x32_bf16 v[188:191], a[176:179], v[28:31], v[188:191]
    ds_read_b64_tr_b16 a[210:211], v59 offset:4480
    v_mfma_f32_16x16x32_bf16 v[192:195], a[176:179], v[32:35], v[192:195]
    ds_read_b64_tr_b16 a[212:213], v59 offset:136
    v_mfma_f32_16x16x32_bf16 v[196:199], a[180:183], v[16:19], v[196:199]
    v_mfma_f32_16x16x32_bf16 v[200:203], a[180:183], v[20:23], v[200:203]
    ds_read_b64_tr_b16 a[214:215], v59 offset:4488
    v_mfma_f32_16x16x32_bf16 v[204:207], a[180:183], v[24:27], v[204:207]
    buffer_load_dwordx4 v65, s[20:23], s97 offen offset:2176 lds
    v_mfma_f32_16x16x32_bf16 v[208:211], a[180:183], v[28:31], v[208:211]
    ds_read_b64_tr_b16 a[216:217], v59 offset:192
    v_mfma_f32_16x16x32_bf16 v[212:215], a[180:183], v[32:35], v[212:215]
    ds_read_b64_tr_b16 a[218:219], v59 offset:4544
    v_mfma_f32_16x16x32_bf16 v[216:219], a[184:187], v[16:19], v[216:219]
    ds_read_b64_tr_b16 a[220:221], v59 offset:200
    v_mfma_f32_16x16x32_bf16 v[220:223], a[184:187], v[20:23], v[220:223]
    ds_read_b64_tr_b16 a[222:223], v59 offset:4552
    v_mfma_f32_16x16x32_bf16 v[224:227], a[184:187], v[24:27], v[224:227]
    buffer_load_dwordx4 v66, s[20:23], s97 offen offset:3264 lds
    v_mfma_f32_16x16x32_bf16 v[228:231], a[184:187], v[28:31], v[228:231]
    s_add_u32 s98, s98, 1
    s_cmp_ge_u32 s98, 18
    s_cselect_b32 s98, 0, s98
    v_mfma_f32_16x16x32_bf16 v[232:235], a[184:187], v[32:35], v[232:235]
    v_mfma_f32_16x16x32_bf16 v[236:239], a[188:191], v[16:19], v[236:239]
    v_mfma_f32_16x16x32_bf16 v[240:243], a[188:191], v[20:23], v[240:243]
    s_lshl_b32 s96, s98, 6
    s_add_u32 s96, s96, s40
    v_mfma_f32_16x16x32_bf16 v[244:247], a[188:191], v[24:27], v[244:247]
    v_mfma_f32_16x16x32_bf16 v[248:251], a[188:191], v[28:31], v[248:251]
    v_mfma_f32_16x16x32_bf16 v[252:255], a[188:191], v[32:35], v[252:255]
    s_lshl_b32 s97, s98, 18
    s_add_u32 s97, s97, s42
    s_waitcnt vmcnt(7) lgkmcnt(0)
    s_barrier
    v_mfma_f32_16x16x32_bf16 v[96:99], a[192:195], v[36:39], v[96:99]
    ds_read_b128 v[16:19], v57 offset:0
    v_mfma_f32_16x16x32_bf16 v[100:103], a[192:195], v[40:43], v[100:103]
    s_add_u32 m0, s41, 135168
    v_mfma_f32_16x16x32_bf16 v[104:107], a[192:195], v[44:47], v[104:107]
    buffer_load_dwordx4 v2, s[16:19], s96 offen offset:0 lds
    v_mfma_f32_16x16x32_bf16 v[108:111], a[192:195], v[48:51], v[108:111]
    ds_read_b128 v[20:23], v57 offset:1024
    v_mfma_f32_16x16x32_bf16 v[112:115], a[192:195], v[52:55], v[112:115]
    ds_read_b128 v[24:27], v57 offset:2048
    v_mfma_f32_16x16x32_bf16 v[116:119], a[196:199], v[36:39], v[116:119]
    ds_read_b128 v[28:31], v57 offset:3072
    v_mfma_f32_16x16x32_bf16 v[120:123], a[196:199], v[40:43], v[120:123]
    ds_read_b128 v[32:35], v57 offset:4096
    v_mfma_f32_16x16x32_bf16 v[124:127], a[196:199], v[44:47], v[124:127]
    buffer_load_dwordx4 v62, s[16:19], s96 offen offset:1024 lds
    v_mfma_f32_16x16x32_bf16 v[128:131], a[196:199], v[48:51], v[128:131]
    ds_read_b64_tr_b16 a[160:161], v60 offset:0
    v_mfma_f32_16x16x32_bf16 v[132:135], a[196:199], v[52:55], v[132:135]
    v_mfma_f32_16x16x32_bf16 v[136:139], a[200:203], v[36:39], v[136:139]
    ds_read_b64_tr_b16 a[162:163], v60 offset:4352
    v_mfma_f32_16x16x32_bf16 v[140:143], a[200:203], v[40:43], v[140:143]
    ds_read_b64_tr_b16 a[164:165], v60 offset:8
    v_mfma_f32_16x16x32_bf16 v[144:147], a[200:203], v[44:47], v[144:147]
    buffer_load_dwordx4 v63, s[16:19], s96 offen offset:2048 lds
    v_mfma_f32_16x16x32_bf16 v[148:151], a[200:203], v[48:51], v[148:151]
    ds_read_b64_tr_b16 a[166:167], v60 offset:4360
    v_mfma_f32_16x16x32_bf16 v[152:155], a[200:203], v[52:55], v[152:155]
    ds_read_b64_tr_b16 a[168:169], v60 offset:64
    v_mfma_f32_16x16x32_bf16 v[156:159], a[204:207], v[36:39], v[156:159]
    ds_read_b64_tr_b16 a[170:171], v60 offset:4416
    v_mfma_f32_16x16x32_bf16 v[160:163], a[204:207], v[40:43], v[160:163]
    s_add_u32 m0, s43, 135168
    v_mfma_f32_16x16x32_bf16 v[164:167], a[204:207], v[44:47], v[164:167]
    buffer_load_dwordx4 v3, s[20:23], s97 offen offset:0 lds
    v_mfma_f32_16x16x32_bf16 v[168:171], a[204:207], v[48:51], v[168:171]
    v_mfma_f32_16x16x32_bf16 v[172:175], a[204:207], v[52:55], v[172:175]
    ds_read_b64_tr_b16 a[172:173], v60 offset:72
    v_mfma_f32_16x16x32_bf16 v[176:179], a[208:211], v[36:39], v[176:179]
    ds_read_b64_tr_b16 a[174:175], v60 offset:4424
    v_mfma_f32_16x16x32_bf16 v[180:183], a[208:211], v[40:43], v[180:183]
    ds_read_b64_tr_b16 a[176:177], v60 offset:128
    v_mfma_f32_16x16x32_bf16 v[184:187], a[208:211], v[44:47], v[184:187]
    buffer_load_dwordx4 v64, s[20:23], s97 offen offset:1088 lds
    v_mfma_f32_16x16x32_bf16 v[188:191], a[208:211], v[48:51], v[188:191]
    ds_read_b64_tr_b16 a[178:179], v60 offset:4480
    v_mfma_f32_16x16x32_bf16 v[192:195], a[208:211], v[52:55], v[192:195]
    ds_read_b64_tr_b16 a[180:181], v60 offset:136
    v_mfma_f32_16x16x32_bf16 v[196:199], a[212:215], v[36:39], v[196:199]
    v_mfma_f32_16x16x32_bf16 v[200:203], a[212:215], v[40:43], v[200:203]
    ds_read_b64_tr_b16 a[182:183], v60 offset:4488
    v_mfma_f32_16x16x32_bf16 v[204:207], a[212:215], v[44:47], v[204:207]
    buffer_load_dwordx4 v65, s[20:23], s97 offen offset:2176 lds
    v_mfma_f32_16x16x32_bf16 v[208:211], a[212:215], v[48:51], v[208:211]
    ds_read_b64_tr_b16 a[184:185], v60 offset:192
    v_mfma_f32_16x16x32_bf16 v[212:215], a[212:215], v[52:55], v[212:215]
    ds_read_b64_tr_b16 a[186:187], v60 offset:4544
    v_mfma_f32_16x16x32_bf16 v[216:219], a[216:219], v[36:39], v[216:219]
    ds_read_b64_tr_b16 a[188:189], v60 offset:200
    v_mfma_f32_16x16x32_bf16 v[220:223], a[216:219], v[40:43], v[220:223]
    ds_read_b64_tr_b16 a[190:191], v60 offset:4552
    v_mfma_f32_16x16x32_bf16 v[224:227], a[216:219], v[44:47], v[224:227]
    buffer_load_dwordx4 v66, s[20:23], s97 offen offset:3264 lds
    v_mfma_f32_16x16x32_bf16 v[228:231], a[216:219], v[48:51], v[228:231]
    s_add_u32 s98, s98, 1
    s_cmp_ge_u32 s98, 18
    s_cselect_b32 s98, 0, s98
    v_mfma_f32_16x16x32_bf16 v[232:235], a[216:219], v[52:55], v[232:235]
    v_mfma_f32_16x16x32_bf16 v[236:239], a[220:223], v[36:39], v[236:239]
    v_mfma_f32_16x16x32_bf16 v[240:243], a[220:223], v[40:43], v[240:243]
    s_lshl_b32 s96, s98, 6
    s_add_u32 s96, s96, s40
    v_mfma_f32_16x16x32_bf16 v[244:247], a[220:223], v[44:47], v[244:247]
    v_mfma_f32_16x16x32_bf16 v[248:251], a[220:223], v[48:51], v[248:251]
    v_mfma_f32_16x16x32_bf16 v[252:255], a[220:223], v[52:55], v[252:255]
    s_lshl_b32 s97, s98, 18
    s_add_u32 s97, s97, s42
    s_waitcnt vmcnt(7) lgkmcnt(0)
    s_barrier
    v_mfma_f32_16x16x32_bf16 v[96:99], a[160:163], v[16:19], v[96:99]
    ds_read_b128 v[36:39], v58 offset:0
    v_mfma_f32_16x16x32_bf16 v[100:103], a[160:163], v[20:23], v[100:103]
    s_add_u32 m0, s41, 101376
    v_mfma_f32_16x16x32_bf16 v[104:107], a[160:163], v[24:27], v[104:107]
    buffer_load_dwordx4 v2, s[16:19], s96 offen offset:0 lds
    v_mfma_f32_16x16x32_bf16 v[108:111], a[160:163], v[28:31], v[108:111]
    ds_read_b128 v[40:43], v58 offset:1024
    v_mfma_f32_16x16x32_bf16 v[112:115], a[160:163], v[32:35], v[112:115]
    ds_read_b128 v[44:47], v58 offset:2048
    v_mfma_f32_16x16x32_bf16 v[116:119], a[164:167], v[16:19], v[116:119]
    ds_read_b128 v[48:51], v58 offset:3072
    v_mfma_f32_16x16x32_bf16 v[120:123], a[164:167], v[20:23], v[120:123]
    ds_read_b128 v[52:55], v58 offset:4096
    v_mfma_f32_16x16x32_bf16 v[124:127], a[164:167], v[24:27], v[124:127]
    buffer_load_dwordx4 v62, s[16:19], s96 offen offset:1024 lds
    v_mfma_f32_16x16x32_bf16 v[128:131], a[164:167], v[28:31], v[128:131]
    ds_read_b64_tr_b16 a[192:193], v61 offset:0
    v_mfma_f32_16x16x32_bf16 v[132:135], a[164:167], v[32:35], v[132:135]
    v_mfma_f32_16x16x32_bf16 v[136:139], a[168:171], v[16:19], v[136:139]
    ds_read_b64_tr_b16 a[194:195], v61 offset:4352
    v_mfma_f32_16x16x32_bf16 v[140:143], a[168:171], v[20:23], v[140:143]
    ds_read_b64_tr_b16 a[196:197], v61 offset:8
    v_mfma_f32_16x16x32_bf16 v[144:147], a[168:171], v[24:27], v[144:147]
    buffer_load_dwordx4 v63, s[16:19], s96 offen offset:2048 lds
    v_mfma_f32_16x16x32_bf16 v[148:151], a[168:171], v[28:31], v[148:151]
    ds_read_b64_tr_b16 a[198:199], v61 offset:4360
    v_mfma_f32_16x16x32_bf16 v[152:155], a[168:171], v[32:35], v[152:155]
    ds_read_b64_tr_b16 a[200:201], v61 offset:64
    v_mfma_f32_16x16x32_bf16 v[156:159], a[172:175], v[16:19], v[156:159]
    ds_read_b64_tr_b16 a[202:203], v61 offset:4416
    v_mfma_f32_16x16x32_bf16 v[160:163], a[172:175], v[20:23], v[160:163]
    s_add_u32 m0, s43, 101376
    v_mfma_f32_16x16x32_bf16 v[164:167], a[172:175], v[24:27], v[164:167]
    buffer_load_dwordx4 v3, s[20:23], s97 offen offset:0 lds
    v_mfma_f32_16x16x32_bf16 v[168:171], a[172:175], v[28:31], v[168:171]
    v_mfma_f32_16x16x32_bf16 v[172:175], a[172:175], v[32:35], v[172:175]
    ds_read_b64_tr_b16 a[204:205], v61 offset:72
    v_mfma_f32_16x16x32_bf16 v[176:179], a[176:179], v[16:19], v[176:179]
    ds_read_b64_tr_b16 a[206:207], v61 offset:4424
    v_mfma_f32_16x16x32_bf16 v[180:183], a[176:179], v[20:23], v[180:183]
    ds_read_b64_tr_b16 a[208:209], v61 offset:128
    v_mfma_f32_16x16x32_bf16 v[184:187], a[176:179], v[24:27], v[184:187]
    buffer_load_dwordx4 v64, s[20:23], s97 offen offset:1088 lds
    v_mfma_f32_16x16x32_bf16 v[188:191], a[176:179], v[28:31], v[188:191]
    ds_read_b64_tr_b16 a[210:211], v61 offset:4480
    v_mfma_f32_16x16x32_bf16 v[192:195], a[176:179], v[32:35], v[192:195]
    ds_read_b64_tr_b16 a[212:213], v61 offset:136
    v_mfma_f32_16x16x32_bf16 v[196:199], a[180:183], v[16:19], v[196:199]
    v_mfma_f32_16x16x32_bf16 v[200:203], a[180:183], v[20:23], v[200:203]
    ds_read_b64_tr_b16 a[214:215], v61 offset:4488
    v_mfma_f32_16x16x32_bf16 v[204:207], a[180:183], v[24:27], v[204:207]
    buffer_load_dwordx4 v65, s[20:23], s97 offen offset:2176 lds
    v_mfma_f32_16x16x32_bf16 v[208:211], a[180:183], v[28:31], v[208:211]
    ds_read_b64_tr_b16 a[216:217], v61 offset:192
    v_mfma_f32_16x16x32_bf16 v[212:215], a[180:183], v[32:35], v[212:215]
    ds_read_b64_tr_b16 a[218:219], v61 offset:4544
    v_mfma_f32_16x16x32_bf16 v[216:219], a[184:187], v[16:19], v[216:219]
    ds_read_b64_tr_b16 a[220:221], v61 offset:200
    v_mfma_f32_16x16x32_bf16 v[220:223], a[184:187], v[20:23], v[220:223]
    ds_read_b64_tr_b16 a[222:223], v61 offset:4552
    v_mfma_f32_16x16x32_bf16 v[224:227], a[184:187], v[24:27], v[224:227]
    buffer_load_dwordx4 v66, s[20:23], s97 offen offset:3264 lds
    v_mfma_f32_16x16x32_bf16 v[228:231], a[184:187], v[28:31], v[228:231]
    s_add_u32 s98, s98, 1
    s_cmp_ge_u32 s98, 18
    s_cselect_b32 s98, 0, s98
    v_mfma_f32_16x16x32_bf16 v[232:235], a[184:187], v[32:35], v[232:235]
    v_mfma_f32_16x16x32_bf16 v[236:239], a[188:191], v[16:19], v[236:239]
    v_mfma_f32_16x16x32_bf16 v[240:243], a[188:191], v[20:23], v[240:243]
    s_lshl_b32 s96, s98, 6
    s_add_u32 s96, s96, s40
    v_mfma_f32_16x16x32_bf16 v[244:247], a[188:191], v[24:27], v[244:247]
    v_mfma_f32_16x16x32_bf16 v[248:251], a[188:191], v[28:31], v[248:251]
    v_mfma_f32_16x16x32_bf16 v[252:255], a[188:191], v[32:35], v[252:255]
    s_lshl_b32 s97, s98, 18
    s_add_u32 s97, s97, s42
    s_waitcnt vmcnt(7) lgkmcnt(0)
    s_barrier
    v_mfma_f32_16x16x32_bf16 v[96:99], a[192:195], v[36:39], v[96:99]
    ds_read_b128 v[16:19], v56 offset:0
    v_mfma_f32_16x16x32_bf16 v[100:103], a[192:195], v[40:43], v[100:103]
    s_add_u32 m0, s41, 33792
    v_mfma_f32_16x16x32_bf16 v[104:107], a[192:195], v[44:47], v[104:107]
    buffer_load_dwordx4 v2, s[16:19], s96 offen offset:0 lds
    v_mfma_f32_16x16x32_bf16 v[108:111], a[192:195], v[48:51], v[108:111]
    ds_read_b128 v[20:23], v56 offset:1024
    v_mfma_f32_16x16x32_bf16 v[112:115], a[192:195], v[52:55], v[112:115]
    ds_read_b128 v[24:27], v56 offset:2048
    v_mfma_f32_16x16x32_bf16 v[116:119], a[196:199], v[36:39], v[116:119]
    ds_read_b128 v[28:31], v56 offset:3072
    v_mfma_f32_16x16x32_bf16 v[120:123], a[196:199], v[40:43], v[120:123]
    ds_read_b128 v[32:35], v56 offset:4096
    v_mfma_f32_16x16x32_bf16 v[124:127], a[196:199], v[44:47], v[124:127]
    buffer_load_dwordx4 v62, s[16:19], s96 offen offset:1024 lds
    v_mfma_f32_16x16x32_bf16 v[128:131], a[196:199], v[48:51], v[128:131]
    ds_read_b64_tr_b16 a[160:161], v59 offset:0
    v_mfma_f32_16x16x32_bf16 v[132:135], a[196:199], v[52:55], v[132:135]
    v_mfma_f32_16x16x32_bf16 v[136:139], a[200:203], v[36:39], v[136:139]
    ds_read_b64_tr_b16 a[162:163], v59 offset:4352
    v_mfma_f32_16x16x32_bf16 v[140:143], a[200:203], v[40:43], v[140:143]
    ds_read_b64_tr_b16 a[164:165], v59 offset:8
    v_mfma_f32_16x16x32_bf16 v[144:147], a[200:203], v[44:47], v[144:147]
    buffer_load_dwordx4 v63, s[16:19], s96 offen offset:2048 lds
    v_mfma_f32_16x16x32_bf16 v[148:151], a[200:203], v[48:51], v[148:151]
    ds_read_b64_tr_b16 a[166:167], v59 offset:4360
    v_mfma_f32_16x16x32_bf16 v[152:155], a[200:203], v[52:55], v[152:155]
    ds_read_b64_tr_b16 a[168:169], v59 offset:64
    v_mfma_f32_16x16x32_bf16 v[156:159], a[204:207], v[36:39], v[156:159]
    ds_read_b64_tr_b16 a[170:171], v59 offset:4416
    v_mfma_f32_16x16x32_bf16 v[160:163], a[204:207], v[40:43], v[160:163]
    s_add_u32 m0, s43, 33792
    v_mfma_f32_16x16x32_bf16 v[164:167], a[204:207], v[44:47], v[164:167]
    buffer_load_dwordx4 v3, s[20:23], s97 offen offset:0 lds
    v_mfma_f32_16x16x32_bf16 v[168:171], a[204:207], v[48:51], v[168:171]
    v_mfma_f32_16x16x32_bf16 v[172:175], a[204:207], v[52:55], v[172:175]
    ds_read_b64_tr_b16 a[172:173], v59 offset:72
    v_mfma_f32_16x16x32_bf16 v[176:179], a[208:211], v[36:39], v[176:179]
    ds_read_b64_tr_b16 a[174:175], v59 offset:4424
    v_mfma_f32_16x16x32_bf16 v[180:183], a[208:211], v[40:43], v[180:183]
    ds_read_b64_tr_b16 a[176:177], v59 offset:128
    v_mfma_f32_16x16x32_bf16 v[184:187], a[208:211], v[44:47], v[184:187]
    buffer_load_dwordx4 v64, s[20:23], s97 offen offset:1088 lds
    v_mfma_f32_16x16x32_bf16 v[188:191], a[208:211], v[48:51], v[188:191]
    ds_read_b64_tr_b16 a[178:179], v59 offset:4480
    v_mfma_f32_16x16x32_bf16 v[192:195], a[208:211], v[52:55], v[192:195]
    ds_read_b64_tr_b16 a[180:181], v59 offset:136
    v_mfma_f32_16x16x32_bf16 v[196:199], a[212:215], v[36:39], v[196:199]
    v_mfma_f32_16x16x32_bf16 v[200:203], a[212:215], v[40:43], v[200:203]
    ds_read_b64_tr_b16 a[182:183], v59 offset:4488
    v_mfma_f32_16x16x32_bf16 v[204:207], a[212:215], v[44:47], v[204:207]
    buffer_load_dwordx4 v65, s[20:23], s97 offen offset:2176 lds
    v_mfma_f32_16x16x32_bf16 v[208:211], a[212:215], v[48:51], v[208:211]
    ds_read_b64_tr_b16 a[184:185], v59 offset:192
    v_mfma_f32_16x16x32_bf16 v[212:215], a[212:215], v[52:55], v[212:215]
    ds_read_b64_tr_b16 a[186:187], v59 offset:4544
    v_mfma_f32_16x16x32_bf16 v[216:219], a[216:219], v[36:39], v[216:219]
    ds_read_b64_tr_b16 a[188:189], v59 offset:200
    v_mfma_f32_16x16x32_bf16 v[220:223], a[216:219], v[40:43], v[220:223]
    ds_read_b64_tr_b16 a[190:191], v59 offset:4552
    v_mfma_f32_16x16x32_bf16 v[224:227], a[216:219], v[44:47], v[224:227]
    buffer_load_dwordx4 v66, s[20:23], s97 offen offset:3264 lds
    v_mfma_f32_16x16x32_bf16 v[228:231], a[216:219], v[48:51], v[228:231]
    s_add_u32 s98, s98, 1
    s_cmp_ge_u32 s98, 18
    s_cselect_b32 s98, 0, s98
    v_mfma_f32_16x16x32_bf16 v[232:235], a[216:219], v[52:55], v[232:235]
    v_mfma_f32_16x16x32_bf16 v[236:239], a[220:223], v[36:39], v[236:239]
    v_mfma_f32_16x16x32_bf16 v[240:243], a[220:223], v[40:43], v[240:243]
    s_lshl_b32 s96, s98, 6
    s_add_u32 s96, s96, s40
    v_mfma_f32_16x16x32_bf16 v[244:247], a[220:223], v[44:47], v[244:247]
    v_mfma_f32_16x16x32_bf16 v[248:251], a[220:223], v[48:51], v[248:251]
    v_mfma_f32_16x16x32_bf16 v[252:255], a[220:223], v[52:55], v[252:255]
    s_lshl_b32 s97, s98, 18
    s_add_u32 s97, s97, s42
    s_waitcnt vmcnt(7) lgkmcnt(0)
    s_barrier
    v_mfma_f32_16x16x32_bf16 v[96:99], a[160:163], v[16:19], v[96:99]
    ds_read_b128 v[36:39], v57 offset:0
    v_mfma_f32_16x16x32_bf16 v[100:103], a[160:163], v[20:23], v[100:103]
    s_add_u32 m0, s41, 135168
    v_mfma_f32_16x16x32_bf16 v[104:107], a[160:163], v[24:27], v[104:107]
    buffer_load_dwordx4 v2, s[16:19], s96 offen offset:0 lds
    v_mfma_f32_16x16x32_bf16 v[108:111], a[160:163], v[28:31], v[108:111]
    ds_read_b128 v[40:43], v57 offset:1024
    v_mfma_f32_16x16x32_bf16 v[112:115], a[160:163], v[32:35], v[112:115]
    ds_read_b128 v[44:47], v57 offset:2048
    v_mfma_f32_16x16x32_bf16 v[116:119], a[164:167], v[16:19], v[116:119]
    ds_read_b128 v[48:51], v57 offset:3072
    v_mfma_f32_16x16x32_bf16 v[120:123], a[164:167], v[20:23], v[120:123]
    ds_read_b128 v[52:55], v57 offset:4096
    v_mfma_f32_16x16x32_bf16 v[124:127], a[164:167], v[24:27], v[124:127]
    buffer_load_dwordx4 v62, s[16:19], s96 offen offset:1024 lds
    v_mfma_f32_16x16x32_bf16 v[128:131], a[164:167], v[28:31], v[128:131]
    ds_read_b64_tr_b16 a[192:193], v60 offset:0
    v_mfma_f32_16x16x32_bf16 v[132:135], a[164:167], v[32:35], v[132:135]
    v_mfma_f32_16x16x32_bf16 v[136:139], a[168:171], v[16:19], v[136:139]
    ds_read_b64_tr_b16 a[194:195], v60 offset:4352
    v_mfma_f32_16x16x32_bf16 v[140:143], a[168:171], v[20:23], v[140:143]
    ds_read_b64_tr_b16 a[196:197], v60 offset:8
    v_mfma_f32_16x16x32_bf16 v[144:147], a[168:171], v[24:27], v[144:147]
    buffer_load_dwordx4 v63, s[16:19], s96 offen offset:2048 lds
    v_mfma_f32_16x16x32_bf16 v[148:151], a[168:171], v[28:31], v[148:151]
    ds_read_b64_tr_b16 a[198:199], v60 offset:4360
    v_mfma_f32_16x16x32_bf16 v[152:155], a[168:171], v[32:35], v[152:155]
    ds_read_b64_tr_b16 a[200:201], v60 offset:64
    v_mfma_f32_16x16x32_bf16 v[156:159], a[172:175], v[16:19], v[156:159]
    ds_read_b64_tr_b16 a[202:203], v60 offset:4416
    v_mfma_f32_16x16x32_bf16 v[160:163], a[172:175], v[20:23], v[160:163]
    s_add_u32 m0, s43, 135168
    v_mfma_f32_16x16x32_bf16 v[164:167], a[172:175], v[24:27], v[164:167]
    buffer_load_dwordx4 v3, s[20:23], s97 offen offset:0 lds
    v_mfma_f32_16x16x32_bf16 v[168:171], a[172:175], v[28:31], v[168:171]
    v_mfma_f32_16x16x32_bf16 v[172:175], a[172:175], v[32:35], v[172:175]
    ds_read_b64_tr_b16 a[204:205], v60 offset:72
    v_mfma_f32_16x16x32_bf16 v[176:179], a[176:179], v[16:19], v[176:179]
    ds_read_b64_tr_b16 a[206:207], v60 offset:4424
    v_mfma_f32_16x16x32_bf16 v[180:183], a[176:179], v[20:23], v[180:183]
    ds_read_b64_tr_b16 a[208:209], v60 offset:128
    v_mfma_f32_16x16x32_bf16 v[184:187], a[176:179], v[24:27], v[184:187]
    buffer_load_dwordx4 v64, s[20:23], s97 offen offset:1088 lds
    v_mfma_f32_16x16x32_bf16 v[188:191], a[176:179], v[28:31], v[188:191]
    ds_read_b64_tr_b16 a[210:211], v60 offset:4480
    v_mfma_f32_16x16x32_bf16 v[192:195], a[176:179], v[32:35], v[192:195]
    ds_read_b64_tr_b16 a[212:213], v60 offset:136
    v_mfma_f32_16x16x32_bf16 v[196:199], a[180:183], v[16:19], v[196:199]
    v_mfma_f32_16x16x32_bf16 v[200:203], a[180:183], v[20:23], v[200:203]
    ds_read_b64_tr_b16 a[214:215], v60 offset:4488
    v_mfma_f32_16x16x32_bf16 v[204:207], a[180:183], v[24:27], v[204:207]
    buffer_load_dwordx4 v65, s[20:23], s97 offen offset:2176 lds
    v_mfma_f32_16x16x32_bf16 v[208:211], a[180:183], v[28:31], v[208:211]
    ds_read_b64_tr_b16 a[216:217], v60 offset:192
    v_mfma_f32_16x16x32_bf16 v[212:215], a[180:183], v[32:35], v[212:215]
    ds_read_b64_tr_b16 a[218:219], v60 offset:4544
    v_mfma_f32_16x16x32_bf16 v[216:219], a[184:187], v[16:19], v[216:219]
    ds_read_b64_tr_b16 a[220:221], v60 offset:200
    v_mfma_f32_16x16x32_bf16 v[220:223], a[184:187], v[20:23], v[220:223]
    ds_read_b64_tr_b16 a[222:223], v60 offset:4552
    v_mfma_f32_16x16x32_bf16 v[224:227], a[184:187], v[24:27], v[224:227]
    buffer_load_dwordx4 v66, s[20:23], s97 offen offset:3264 lds
    v_mfma_f32_16x16x32_bf16 v[228:231], a[184:187], v[28:31], v[228:231]
    s_add_u32 s98, s98, 1
    s_cmp_ge_u32 s98, 18
    s_cselect_b32 s98, 0, s98
    v_mfma_f32_16x16x32_bf16 v[232:235], a[184:187], v[32:35], v[232:235]
    v_mfma_f32_16x16x32_bf16 v[236:239], a[188:191], v[16:19], v[236:239]
    v_mfma_f32_16x16x32_bf16 v[240:243], a[188:191], v[20:23], v[240:243]
    s_lshl_b32 s96, s98, 6
    s_add_u32 s96, s96, s40
    v_mfma_f32_16x16x32_bf16 v[244:247], a[188:191], v[24:27], v[244:247]
    v_mfma_f32_16x16x32_bf16 v[248:251], a[188:191], v[28:31], v[248:251]
    v_mfma_f32_16x16x32_bf16 v[252:255], a[188:191], v[32:35], v[252:255]
    s_lshl_b32 s97, s98, 18
    s_add_u32 s97, s97, s42
    s_waitcnt vmcnt(7) lgkmcnt(0)
    s_barrier
    v_mfma_f32_16x16x32_bf16 v[96:99], a[192:195], v[36:39], v[96:99]
    ds_read_b128 v[16:19], v58 offset:0
    v_mfma_f32_16x16x32_bf16 v[100:103], a[192:195], v[40:43], v[100:103]
    s_add_u32 m0, s41, 101376
    v_mfma_f32_16x16x32_bf16 v[104:107], a[192:195], v[44:47], v[104:107]
    buffer_load_dwordx4 v2, s[16:19], s96 offen offset:0 lds
    v_mfma_f32_16x16x32_bf16 v[108:111], a[192:195], v[48:51], v[108:111]
    ds_read_b128 v[20:23], v58 offset:1024
    v_mfma_f32_16x16x32_bf16 v[112:115], a[192:195], v[52:55], v[112:115]
    ds_read_b128 v[24:27], v58 offset:2048
    v_mfma_f32_16x16x32_bf16 v[116:119], a[196:199], v[36:39], v[116:119]
    ds_read_b128 v[28:31], v58 offset:3072
    v_mfma_f32_16x16x32_bf16 v[120:123], a[196:199], v[40:43], v[120:123]
    ds_read_b128 v[32:35], v58 offset:4096
    v_mfma_f32_16x16x32_bf16 v[124:127], a[196:199], v[44:47], v[124:127]
    buffer_load_dwordx4 v62, s[16:19], s96 offen offset:1024 lds
    v_mfma_f32_16x16x32_bf16 v[128:131], a[196:199], v[48:51], v[128:131]
    ds_read_b64_tr_b16 a[160:161], v61 offset:0
    v_mfma_f32_16x16x32_bf16 v[132:135], a[196:199], v[52:55], v[132:135]
    v_mfma_f32_16x16x32_bf16 v[136:139], a[200:203], v[36:39], v[136:139]
    ds_read_b64_tr_b16 a[162:163], v61 offset:4352
    v_mfma_f32_16x16x32_bf16 v[140:143], a[200:203], v[40:43], v[140:143]
    ds_read_b64_tr_b16 a[164:165], v61 offset:8
    v_mfma_f32_16x16x32_bf16 v[144:147], a[200:203], v[44:47], v[144:147]
    buffer_load_dwordx4 v63, s[16:19], s96 offen offset:2048 lds
    v_mfma_f32_16x16x32_bf16 v[148:151], a[200:203], v[48:51], v[148:151]
    ds_read_b64_tr_b16 a[166:167], v61 offset:4360
    v_mfma_f32_16x16x32_bf16 v[152:155], a[200:203], v[52:55], v[152:155]
    ds_read_b64_tr_b16 a[168:169], v61 offset:64
    v_mfma_f32_16x16x32_bf16 v[156:159], a[204:207], v[36:39], v[156:159]
    ds_read_b64_tr_b16 a[170:171], v61 offset:4416
    v_mfma_f32_16x16x32_bf16 v[160:163], a[204:207], v[40:43], v[160:163]
    s_add_u32 m0, s43, 101376
    v_mfma_f32_16x16x32_bf16 v[164:167], a[204:207], v[44:47], v[164:167]
    buffer_load_dwordx4 v3, s[20:23], s97 offen offset:0 lds
    v_mfma_f32_16x16x32_bf16 v[168:171], a[204:207], v[48:51], v[168:171]
    v_mfma_f32_16x16x32_bf16 v[172:175], a[204:207], v[52:55], v[172:175]
    ds_read_b64_tr_b16 a[172:173], v61 offset:72
    v_mfma_f32_16x16x32_bf16 v[176:179], a[208:211], v[36:39], v[176:179]
    ds_read_b64_tr_b16 a[174:175], v61 offset:4424
    v_mfma_f32_16x16x32_bf16 v[180:183], a[208:211], v[40:43], v[180:183]
    ds_read_b64_tr_b16 a[176:177], v61 offset:128
    v_mfma_f32_16x16x32_bf16 v[184:187], a[208:211], v[44:47], v[184:187]
    buffer_load_dwordx4 v64, s[20:23], s97 offen offset:1088 lds
    v_mfma_f32_16x16x32_bf16 v[188:191], a[208:211], v[48:51], v[188:191]
    ds_read_b64_tr_b16 a[178:179], v61 offset:4480
    v_mfma_f32_16x16x32_bf16 v[192:195], a[208:211], v[52:55], v[192:195]
    ds_read_b64_tr_b16 a[180:181], v61 offset:136
    v_mfma_f32_16x16x32_bf16 v[196:199], a[212:215], v[36:39], v[196:199]
    v_mfma_f32_16x16x32_bf16 v[200:203], a[212:215], v[40:43], v[200:203]
    ds_read_b64_tr_b16 a[182:183], v61 offset:4488
    v_mfma_f32_16x16x32_bf16 v[204:207], a[212:215], v[44:47], v[204:207]
    buffer_load_dwordx4 v65, s[20:23], s97 offen offset:2176 lds
    v_mfma_f32_16x16x32_bf16 v[208:211], a[212:215], v[48:51], v[208:211]
    ds_read_b64_tr_b16 a[184:185], v61 offset:192
    v_mfma_f32_16x16x32_bf16 v[212:215], a[212:215], v[52:55], v[212:215]
    ds_read_b64_tr_b16 a[186:187], v61 offset:4544
    v_mfma_f32_16x16x32_bf16 v[216:219], a[216:219], v[36:39], v[216:219]
    ds_read_b64_tr_b16 a[188:189], v61 offset:200
    v_mfma_f32_16x16x32_bf16 v[220:223], a[216:219], v[40:43], v[220:223]
    ds_read_b64_tr_b16 a[190:191], v61 offset:4552
    v_mfma_f32_16x16x32_bf16 v[224:227], a[216:219], v[44:47], v[224:227]
    buffer_load_dwordx4 v66, s[20:23], s97 offen offset:3264 lds
    v_mfma_f32_16x16x32_bf16 v[228:231], a[216:219], v[48:51], v[228:231]
    s_add_u32 s98, s98, 1
    s_cmp_ge_u32 s98, 18
    s_cselect_b32 s98, 0, s98
    v_mfma_f32_16x16x32_bf16 v[232:235], a[216:219], v[52:55], v[232:235]
    v_mfma_f32_16x16x32_bf16 v[236:239], a[220:223], v[36:39], v[236:239]
    v_mfma_f32_16x16x32_bf16 v[240:243], a[220:223], v[40:43], v[240:243]
    s_lshl_b32 s96, s98, 6
    s_add_u32 s96, s96, s40
    v_mfma_f32_16x16x32_bf16 v[244:247], a[220:223], v[44:47], v[244:247]
    v_mfma_f32_16x16x32_bf16 v[248:251], a[220:223], v[48:51], v[248:251]
    v_mfma_f32_16x16x32_bf16 v[252:255], a[220:223], v[52:55], v[252:255]
    s_lshl_b32 s97, s98, 18
    s_add_u32 s97, s97, s42
    s_waitcnt vmcnt(7) lgkmcnt(0)
    s_barrier
    v_mfma_f32_16x16x32_bf16 v[96:99], a[160:163], v[16:19], v[96:99]
    ds_read_b128 v[36:39], v56 offset:0
    v_mfma_f32_16x16x32_bf16 v[100:103], a[160:163], v[20:23], v[100:103]
    s_add_u32 m0, s41, 33792
    v_mfma_f32_16x16x32_bf16 v[104:107], a[160:163], v[24:27], v[104:107]
    buffer_load_dwordx4 v2, s[16:19], s96 offen offset:0 lds
    v_mfma_f32_16x16x32_bf16 v[108:111], a[160:163], v[28:31], v[108:111]
    ds_read_b128 v[40:43], v56 offset:1024
    v_mfma_f32_16x16x32_bf16 v[112:115], a[160:163], v[32:35], v[112:115]
    ds_read_b128 v[44:47], v56 offset:2048
    v_mfma_f32_16x16x32_bf16 v[116:119], a[164:167], v[16:19], v[116:119]
    ds_read_b128 v[48:51], v56 offset:3072
    v_mfma_f32_16x16x32_bf16 v[120:123], a[164:167], v[20:23], v[120:123]
    ds_read_b128 v[52:55], v56 offset:4096
    v_mfma_f32_16x16x32_bf16 v[124:127], a[164:167], v[24:27], v[124:127]
    buffer_load_dwordx4 v62, s[16:19], s96 offen offset:1024 lds
    v_mfma_f32_16x16x32_bf16 v[128:131], a[164:167], v[28:31], v[128:131]
    ds_read_b64_tr_b16 a[192:193], v59 offset:0
    v_mfma_f32_16x16x32_bf16 v[132:135], a[164:167], v[32:35], v[132:135]
    v_mfma_f32_16x16x32_bf16 v[136:139], a[168:171], v[16:19], v[136:139]
    ds_read_b64_tr_b16 a[194:195], v59 offset:4352
    v_mfma_f32_16x16x32_bf16 v[140:143], a[168:171], v[20:23], v[140:143]
    ds_read_b64_tr_b16 a[196:197], v59 offset:8
    v_mfma_f32_16x16x32_bf16 v[144:147], a[168:171], v[24:27], v[144:147]
    buffer_load_dwordx4 v63, s[16:19], s96 offen offset:2048 lds
    v_mfma_f32_16x16x32_bf16 v[148:151], a[168:171], v[28:31], v[148:151]
    ds_read_b64_tr_b16 a[198:199], v59 offset:4360
    v_mfma_f32_16x16x32_bf16 v[152:155], a[168:171], v[32:35], v[152:155]
    ds_read_b64_tr_b16 a[200:201], v59 offset:64
    v_mfma_f32_16x16x32_bf16 v[156:159], a[172:175], v[16:19], v[156:159]
    ds_read_b64_tr_b16 a[202:203], v59 offset:4416
    v_mfma_f32_16x16x32_bf16 v[160:163], a[172:175], v[20:23], v[160:163]
    s_add_u32 m0, s43, 33792
    v_mfma_f32_16x16x32_bf16 v[164:167], a[172:175], v[24:27], v[164:167]
    buffer_load_dwordx4 v3, s[20:23], s97 offen offset:0 lds
    v_mfma_f32_16x16x32_bf16 v[168:171], a[172:175], v[28:31], v[168:171]
    v_mfma_f32_16x16x32_bf16 v[172:175], a[172:175], v[32:35], v[172:175]
    ds_read_b64_tr_b16 a[204:205], v59 offset:72
    v_mfma_f32_16x16x32_bf16 v[176:179], a[176:179], v[16:19], v[176:179]
    ds_read_b64_tr_b16 a[206:207], v59 offset:4424
    v_mfma_f32_16x16x32_bf16 v[180:183], a[176:179], v[20:23], v[180:183]
    ds_read_b64_tr_b16 a[208:209], v59 offset:128
    v_mfma_f32_16x16x32_bf16 v[184:187], a[176:179], v[24:27], v[184:187]
    buffer_load_dwordx4 v64, s[20:23], s97 offen offset:1088 lds
    v_mfma_f32_16x16x32_bf16 v[188:191], a[176:179], v[28:31], v[188:191]
    ds_read_b64_tr_b16 a[210:211], v59 offset:4480
    v_mfma_f32_16x16x32_bf16 v[192:195], a[176:179], v[32:35], v[192:195]
    ds_read_b64_tr_b16 a[212:213], v59 offset:136
    v_mfma_f32_16x16x32_bf16 v[196:199], a[180:183], v[16:19], v[196:199]
    v_mfma_f32_16x16x32_bf16 v[200:203], a[180:183], v[20:23], v[200:203]
    ds_read_b64_tr_b16 a[214:215], v59 offset:4488
    v_mfma_f32_16x16x32_bf16 v[204:207], a[180:183], v[24:27], v[204:207]
    buffer_load_dwordx4 v65, s[20:23], s97 offen offset:2176 lds
    v_mfma_f32_16x16x32_bf16 v[208:211], a[180:183], v[28:31], v[208:211]
    ds_read_b64_tr_b16 a[216:217], v59 offset:192
    v_mfma_f32_16x16x32_bf16 v[212:215], a[180:183], v[32:35], v[212:215]
    ds_read_b64_tr_b16 a[218:219], v59 offset:4544
    v_mfma_f32_16x16x32_bf16 v[216:219], a[184:187], v[16:19], v[216:219]
    ds_read_b64_tr_b16 a[220:221], v59 offset:200
    v_mfma_f32_16x16x32_bf16 v[220:223], a[184:187], v[20:23], v[220:223]
    ds_read_b64_tr_b16 a[222:223], v59 offset:4552
    v_mfma_f32_16x16x32_bf16 v[224:227], a[184:187], v[24:27], v[224:227]
    buffer_load_dwordx4 v66, s[20:23], s97 offen offset:3264 lds
    v_mfma_f32_16x16x32_bf16 v[228:231], a[184:187], v[28:31], v[228:231]
    s_add_u32 s98, s98, 1
    s_cmp_ge_u32 s98, 18
    s_cselect_b32 s98, 0, s98
    v_mfma_f32_16x16x32_bf16 v[232:235], a[184:187], v[32:35], v[232:235]
    v_mfma_f32_16x16x32_bf16 v[236:239], a[188:191], v[16:19], v[236:239]
    v_mfma_f32_16x16x32_bf16 v[240:243], a[188:191], v[20:23], v[240:243]
    s_lshl_b32 s96, s98, 6
    s_add_u32 s96, s96, s40
    v_mfma_f32_16x16x32_bf16 v[244:247], a[188:191], v[24:27], v[244:247]
    v_mfma_f32_16x16x32_bf16 v[248:251], a[188:191], v[28:31], v[248:251]
    v_mfma_f32_16x16x32_bf16 v[252:255], a[188:191], v[32:35], v[252:255]
    s_lshl_b32 s97, s98, 18
    s_add_u32 s97, s97, s42
    s_waitcnt vmcnt(7) lgkmcnt(0)
    s_barrier
    v_mfma_f32_16x16x32_bf16 v[96:99], a[192:195], v[36:39], v[96:99]
    ds_read_b128 v[16:19], v57 offset:0
    v_mfma_f32_16x16x32_bf16 v[100:103], a[192:195], v[40:43], v[100:103]
    s_add_u32 m0, s41, 135168
    v_mfma_f32_16x16x32_bf16 v[104:107], a[192:195], v[44:47], v[104:107]
    buffer_load_dwordx4 v2, s[16:19], s96 offen offset:0 lds
    v_mfma_f32_16x16x32_bf16 v[108:111], a[192:195], v[48:51], v[108:111]
    ds_read_b128 v[20:23], v57 offset:1024
    v_mfma_f32_16x16x32_bf16 v[112:115], a[192:195], v[52:55], v[112:115]
    ds_read_b128 v[24:27], v57 offset:2048
    v_mfma_f32_16x16x32_bf16 v[116:119], a[196:199], v[36:39], v[116:119]
    ds_read_b128 v[28:31], v57 offset:3072
    v_mfma_f32_16x16x32_bf16 v[120:123], a[196:199], v[40:43], v[120:123]
    ds_read_b128 v[32:35], v57 offset:4096
    v_mfma_f32_16x16x32_bf16 v[124:127], a[196:199], v[44:47], v[124:127]
    buffer_load_dwordx4 v62, s[16:19], s96 offen offset:1024 lds
    v_mfma_f32_16x16x32_bf16 v[128:131], a[196:199], v[48:51], v[128:131]
    ds_read_b64_tr_b16 a[160:161], v60 offset:0
    v_mfma_f32_16x16x32_bf16 v[132:135], a[196:199], v[52:55], v[132:135]
    v_mfma_f32_16x16x32_bf16 v[136:139], a[200:203], v[36:39], v[136:139]
    ds_read_b64_tr_b16 a[162:163], v60 offset:4352
    v_mfma_f32_16x16x32_bf16 v[140:143], a[200:203], v[40:43], v[140:143]
    ds_read_b64_tr_b16 a[164:165], v60 offset:8
    v_mfma_f32_16x16x32_bf16 v[144:147], a[200:203], v[44:47], v[144:147]
    buffer_load_dwordx4 v63, s[16:19], s96 offen offset:2048 lds
    v_mfma_f32_16x16x32_bf16 v[148:151], a[200:203], v[48:51], v[148:151]
    ds_read_b64_tr_b16 a[166:167], v60 offset:4360
    v_mfma_f32_16x16x32_bf16 v[152:155], a[200:203], v[52:55], v[152:155]
    ds_read_b64_tr_b16 a[168:169], v60 offset:64
    v_mfma_f32_16x16x32_bf16 v[156:159], a[204:207], v[36:39], v[156:159]
    ds_read_b64_tr_b16 a[170:171], v60 offset:4416
    v_mfma_f32_16x16x32_bf16 v[160:163], a[204:207], v[40:43], v[160:163]
    s_add_u32 m0, s43, 135168
    v_mfma_f32_16x16x32_bf16 v[164:167], a[204:207], v[44:47], v[164:167]
    buffer_load_dwordx4 v3, s[20:23], s97 offen offset:0 lds
    v_mfma_f32_16x16x32_bf16 v[168:171], a[204:207], v[48:51], v[168:171]
    v_mfma_f32_16x16x32_bf16 v[172:175], a[204:207], v[52:55], v[172:175]
    ds_read_b64_tr_b16 a[172:173], v60 offset:72
    v_mfma_f32_16x16x32_bf16 v[176:179], a[208:211], v[36:39], v[176:179]
    ds_read_b64_tr_b16 a[174:175], v60 offset:4424
    v_mfma_f32_16x16x32_bf16 v[180:183], a[208:211], v[40:43], v[180:183]
    ds_read_b64_tr_b16 a[176:177], v60 offset:128
    v_mfma_f32_16x16x32_bf16 v[184:187], a[208:211], v[44:47], v[184:187]
    buffer_load_dwordx4 v64, s[20:23], s97 offen offset:1088 lds
    v_mfma_f32_16x16x32_bf16 v[188:191], a[208:211], v[48:51], v[188:191]
    ds_read_b64_tr_b16 a[178:179], v60 offset:4480
    v_mfma_f32_16x16x32_bf16 v[192:195], a[208:211], v[52:55], v[192:195]
    ds_read_b64_tr_b16 a[180:181], v60 offset:136
    v_mfma_f32_16x16x32_bf16 v[196:199], a[212:215], v[36:39], v[196:199]
    v_mfma_f32_16x16x32_bf16 v[200:203], a[212:215], v[40:43], v[200:203]
    ds_read_b64_tr_b16 a[182:183], v60 offset:4488
    v_mfma_f32_16x16x32_bf16 v[204:207], a[212:215], v[44:47], v[204:207]
    buffer_load_dwordx4 v65, s[20:23], s97 offen offset:2176 lds
    v_mfma_f32_16x16x32_bf16 v[208:211], a[212:215], v[48:51], v[208:211]
    ds_read_b64_tr_b16 a[184:185], v60 offset:192
    v_mfma_f32_16x16x32_bf16 v[212:215], a[212:215], v[52:55], v[212:215]
    ds_read_b64_tr_b16 a[186:187], v60 offset:4544
    v_mfma_f32_16x16x32_bf16 v[216:219], a[216:219], v[36:39], v[216:219]
    ds_read_b64_tr_b16 a[188:189], v60 offset:200
    v_mfma_f32_16x16x32_bf16 v[220:223], a[216:219], v[40:43], v[220:223]
    ds_read_b64_tr_b16 a[190:191], v60 offset:4552
    v_mfma_f32_16x16x32_bf16 v[224:227], a[216:219], v[44:47], v[224:227]
    buffer_load_dwordx4 v66, s[20:23], s97 offen offset:3264 lds
    v_mfma_f32_16x16x32_bf16 v[228:231], a[216:219], v[48:51], v[228:231]
    s_add_u32 s98, s98, 1
    s_cmp_ge_u32 s98, 18
    s_cselect_b32 s98, 0, s98
    v_mfma_f32_16x16x32_bf16 v[232:235], a[216:219], v[52:55], v[232:235]
    v_mfma_f32_16x16x32_bf16 v[236:239], a[220:223], v[36:39], v[236:239]
    v_mfma_f32_16x16x32_bf16 v[240:243], a[220:223], v[40:43], v[240:243]
    s_lshl_b32 s96, s98, 6
    s_add_u32 s96, s96, s40
    v_mfma_f32_16x16x32_bf16 v[244:247], a[220:223], v[44:47], v[244:247]
    v_mfma_f32_16x16x32_bf16 v[248:251], a[220:223], v[48:51], v[248:251]
    v_mfma_f32_16x16x32_bf16 v[252:255], a[220:223], v[52:55], v[252:255]
    s_lshl_b32 s97, s98, 18
    s_add_u32 s97, s97, s42
    s_waitcnt vmcnt(7) lgkmcnt(0)
    s_barrier
    v_mfma_f32_16x16x32_bf16 v[96:99], a[160:163], v[16:19], v[96:99]
    ds_read_b128 v[36:39], v58 offset:0
    v_mfma_f32_16x16x32_bf16 v[100:103], a[160:163], v[20:23], v[100:103]
    s_add_u32 m0, s41, 101376
    v_mfma_f32_16x16x32_bf16 v[104:107], a[160:163], v[24:27], v[104:107]
    buffer_load_dwordx4 v2, s[16:19], s96 offen offset:0 lds
    v_mfma_f32_16x16x32_bf16 v[108:111], a[160:163], v[28:31], v[108:111]
    ds_read_b128 v[40:43], v58 offset:1024
    v_mfma_f32_16x16x32_bf16 v[112:115], a[160:163], v[32:35], v[112:115]
    ds_read_b128 v[44:47], v58 offset:2048
    v_mfma_f32_16x16x32_bf16 v[116:119], a[164:167], v[16:19], v[116:119]
    ds_read_b128 v[48:51], v58 offset:3072
    v_mfma_f32_16x16x32_bf16 v[120:123], a[164:167], v[20:23], v[120:123]
    ds_read_b128 v[52:55], v58 offset:4096
    v_mfma_f32_16x16x32_bf16 v[124:127], a[164:167], v[24:27], v[124:127]
    buffer_load_dwordx4 v62, s[16:19], s96 offen offset:1024 lds
    v_mfma_f32_16x16x32_bf16 v[128:131], a[164:167], v[28:31], v[128:131]
    ds_read_b64_tr_b16 a[192:193], v61 offset:0
    v_mfma_f32_16x16x32_bf16 v[132:135], a[164:167], v[32:35], v[132:135]
    v_mfma_f32_16x16x32_bf16 v[136:139], a[168:171], v[16:19], v[136:139]
    ds_read_b64_tr_b16 a[194:195], v61 offset:4352
    v_mfma_f32_16x16x32_bf16 v[140:143], a[168:171], v[20:23], v[140:143]
    ds_read_b64_tr_b16 a[196:197], v61 offset:8
    v_mfma_f32_16x16x32_bf16 v[144:147], a[168:171], v[24:27], v[144:147]
    buffer_load_dwordx4 v63, s[16:19], s96 offen offset:2048 lds
    v_mfma_f32_16x16x32_bf16 v[148:151], a[168:171], v[28:31], v[148:151]
    ds_read_b64_tr_b16 a[198:199], v61 offset:4360
    v_mfma_f32_16x16x32_bf16 v[152:155], a[168:171], v[32:35], v[152:155]
    ds_read_b64_tr_b16 a[200:201], v61 offset:64
    v_mfma_f32_16x16x32_bf16 v[156:159], a[172:175], v[16:19], v[156:159]
    ds_read_b64_tr_b16 a[202:203], v61 offset:4416
    v_mfma_f32_16x16x32_bf16 v[160:163], a[172:175], v[20:23], v[160:163]
    s_add_u32 m0, s43, 101376
    v_mfma_f32_16x16x32_bf16 v[164:167], a[172:175], v[24:27], v[164:167]
    buffer_load_dwordx4 v3, s[20:23], s97 offen offset:0 lds
    v_mfma_f32_16x16x32_bf16 v[168:171], a[172:175], v[28:31], v[168:171]
    v_mfma_f32_16x16x32_bf16 v[172:175], a[172:175], v[32:35], v[172:175]
    ds_read_b64_tr_b16 a[204:205], v61 offset:72
    v_mfma_f32_16x16x32_bf16 v[176:179], a[176:179], v[16:19], v[176:179]
    ds_read_b64_tr_b16 a[206:207], v61 offset:4424
    v_mfma_f32_16x16x32_bf16 v[180:183], a[176:179], v[20:23], v[180:183]
    ds_read_b64_tr_b16 a[208:209], v61 offset:128
    v_mfma_f32_16x16x32_bf16 v[184:187], a[176:179], v[24:27], v[184:187]
    buffer_load_dwordx4 v64, s[20:23], s97 offen offset:1088 lds
    v_mfma_f32_16x16x32_bf16 v[188:191], a[176:179], v[28:31], v[188:191]
    ds_read_b64_tr_b16 a[210:211], v61 offset:4480
    v_mfma_f32_16x16x32_bf16 v[192:195], a[176:179], v[32:35], v[192:195]
    ds_read_b64_tr_b16 a[212:213], v61 offset:136
    v_mfma_f32_16x16x32_bf16 v[196:199], a[180:183], v[16:19], v[196:199]
    v_mfma_f32_16x16x32_bf16 v[200:203], a[180:183], v[20:23], v[200:203]
    ds_read_b64_tr_b16 a[214:215], v61 offset:4488
    v_mfma_f32_16x16x32_bf16 v[204:207], a[180:183], v[24:27], v[204:207]
    buffer_load_dwordx4 v65, s[20:23], s97 offen offset:2176 lds
    v_mfma_f32_16x16x32_bf16 v[208:211], a[180:183], v[28:31], v[208:211]
    ds_read_b64_tr_b16 a[216:217], v61 offset:192
    v_mfma_f32_16x16x32_bf16 v[212:215], a[180:183], v[32:35], v[212:215]
    ds_read_b64_tr_b16 a[218:219], v61 offset:4544
    v_mfma_f32_16x16x32_bf16 v[216:219], a[184:187], v[16:19], v[216:219]
    ds_read_b64_tr_b16 a[220:221], v61 offset:200
    v_mfma_f32_16x16x32_bf16 v[220:223], a[184:187], v[20:23], v[220:223]
    ds_read_b64_tr_b16 a[222:223], v61 offset:4552
    v_mfma_f32_16x16x32_bf16 v[224:227], a[184:187], v[24:27], v[224:227]
    buffer_load_dwordx4 v66, s[20:23], s97 offen offset:3264 lds
    v_mfma_f32_16x16x32_bf16 v[228:231], a[184:187], v[28:31], v[228:231]
    s_add_u32 s98, s98, 1
    s_cmp_ge_u32 s98, 18
    s_cselect_b32 s98, 0, s98
    v_mfma_f32_16x16x32_bf16 v[232:235], a[184:187], v[32:35], v[232:235]
    v_mfma_f32_16x16x32_bf16 v[236:239], a[188:191], v[16:19], v[236:239]
    v_mfma_f32_16x16x32_bf16 v[240:243], a[188:191], v[20:23], v[240:243]
    s_lshl_b32 s96, s98, 6
    s_add_u32 s96, s96, s40
    v_mfma_f32_16x16x32_bf16 v[244:247], a[188:191], v[24:27], v[244:247]
    v_mfma_f32_16x16x32_bf16 v[248:251], a[188:191], v[28:31], v[248:251]
    v_mfma_f32_16x16x32_bf16 v[252:255], a[188:191], v[32:35], v[252:255]
    s_lshl_b32 s97, s98, 18
    s_add_u32 s97, s97, s42
    s_waitcnt vmcnt(7) lgkmcnt(0)
    s_barrier
    v_mfma_f32_16x16x32_bf16 v[96:99], a[192:195], v[36:39], v[96:99]
    ds_read_b128 v[16:19], v56 offset:0
    v_mfma_f32_16x16x32_bf16 v[100:103], a[192:195], v[40:43], v[100:103]
    s_add_u32 m0, s41, 33792
    v_mfma_f32_16x16x32_bf16 v[104:107], a[192:195], v[44:47], v[104:107]
    buffer_load_dwordx4 v2, s[16:19], s96 offen offset:0 lds
    v_mfma_f32_16x16x32_bf16 v[108:111], a[192:195], v[48:51], v[108:111]
    ds_read_b128 v[20:23], v56 offset:1024
    v_mfma_f32_16x16x32_bf16 v[112:115], a[192:195], v[52:55], v[112:115]
    ds_read_b128 v[24:27], v56 offset:2048
    v_mfma_f32_16x16x32_bf16 v[116:119], a[196:199], v[36:39], v[116:119]
    ds_read_b128 v[28:31], v56 offset:3072
    v_mfma_f32_16x16x32_bf16 v[120:123], a[196:199], v[40:43], v[120:123]
    ds_read_b128 v[32:35], v56 offset:4096
    v_mfma_f32_16x16x32_bf16 v[124:127], a[196:199], v[44:47], v[124:127]
    buffer_load_dwordx4 v62, s[16:19], s96 offen offset:1024 lds
    v_mfma_f32_16x16x32_bf16 v[128:131], a[196:199], v[48:51], v[128:131]
    ds_read_b64_tr_b16 a[160:161], v59 offset:0
    v_mfma_f32_16x16x32_bf16 v[132:135], a[196:199], v[52:55], v[132:135]
    v_mfma_f32_16x16x32_bf16 v[136:139], a[200:203], v[36:39], v[136:139]
    ds_read_b64_tr_b16 a[162:163], v59 offset:4352
    v_mfma_f32_16x16x32_bf16 v[140:143], a[200:203], v[40:43], v[140:143]
    ds_read_b64_tr_b16 a[164:165], v59 offset:8
    v_mfma_f32_16x16x32_bf16 v[144:147], a[200:203], v[44:47], v[144:147]
    buffer_load_dwordx4 v63, s[16:19], s96 offen offset:2048 lds
    v_mfma_f32_16x16x32_bf16 v[148:151], a[200:203], v[48:51], v[148:151]
    ds_read_b64_tr_b16 a[166:167], v59 offset:4360
    v_mfma_f32_16x16x32_bf16 v[152:155], a[200:203], v[52:55], v[152:155]
    ds_read_b64_tr_b16 a[168:169], v59 offset:64
    v_mfma_f32_16x16x32_bf16 v[156:159], a[204:207], v[36:39], v[156:159]
    ds_read_b64_tr_b16 a[170:171], v59 offset:4416
    v_mfma_f32_16x16x32_bf16 v[160:163], a[204:207], v[40:43], v[160:163]
    s_add_u32 m0, s43, 33792
    v_mfma_f32_16x16x32_bf16 v[164:167], a[204:207], v[44:47], v[164:167]
    buffer_load_dwordx4 v3, s[20:23], s97 offen offset:0 lds
    v_mfma_f32_16x16x32_bf16 v[168:171], a[204:207], v[48:51], v[168:171]
    v_mfma_f32_16x16x32_bf16 v[172:175], a[204:207], v[52:55], v[172:175]
    ds_read_b64_tr_b16 a[172:173], v59 offset:72
    v_mfma_f32_16x16x32_bf16 v[176:179], a[208:211], v[36:39], v[176:179]
    ds_read_b64_tr_b16 a[174:175], v59 offset:4424
    v_mfma_f32_16x16x32_bf16 v[180:183], a[208:211], v[40:43], v[180:183]
    ds_read_b64_tr_b16 a[176:177], v59 offset:128
    v_mfma_f32_16x16x32_bf16 v[184:187], a[208:211], v[44:47], v[184:187]
    buffer_load_dwordx4 v64, s[20:23], s97 offen offset:1088 lds
    v_mfma_f32_16x16x32_bf16 v[188:191], a[208:211], v[48:51], v[188:191]
    ds_read_b64_tr_b16 a[178:179], v59 offset:4480
    v_mfma_f32_16x16x32_bf16 v[192:195], a[208:211], v[52:55], v[192:195]
    ds_read_b64_tr_b16 a[180:181], v59 offset:136
    v_mfma_f32_16x16x32_bf16 v[196:199], a[212:215], v[36:39], v[196:199]
    v_mfma_f32_16x16x32_bf16 v[200:203], a[212:215], v[40:43], v[200:203]
    ds_read_b64_tr_b16 a[182:183], v59 offset:4488
    v_mfma_f32_16x16x32_bf16 v[204:207], a[212:215], v[44:47], v[204:207]
    buffer_load_dwordx4 v65, s[20:23], s97 offen offset:2176 lds
    v_mfma_f32_16x16x32_bf16 v[208:211], a[212:215], v[48:51], v[208:211]
    ds_read_b64_tr_b16 a[184:185], v59 offset:192
    v_mfma_f32_16x16x32_bf16 v[212:215], a[212:215], v[52:55], v[212:215]
    ds_read_b64_tr_b16 a[186:187], v59 offset:4544
    v_mfma_f32_16x16x32_bf16 v[216:219], a[216:219], v[36:39], v[216:219]
    ds_read_b64_tr_b16 a[188:189], v59 offset:200
    v_mfma_f32_16x16x32_bf16 v[220:223], a[216:219], v[40:43], v[220:223]
    ds_read_b64_tr_b16 a[190:191], v59 offset:4552
    v_mfma_f32_16x16x32_bf16 v[224:227], a[216:219], v[44:47], v[224:227]
    buffer_load_dwordx4 v66, s[20:23], s97 offen offset:3264 lds
    v_mfma_f32_16x16x32_bf16 v[228:231], a[216:219], v[48:51], v[228:231]
    s_add_u32 s98, s98, 1
    s_cmp_ge_u32 s98, 18
    s_cselect_b32 s98, 0, s98
    v_mfma_f32_16x16x32_bf16 v[232:235], a[216:219], v[52:55], v[232:235]
    v_mfma_f32_16x16x32_bf16 v[236:239], a[220:223], v[36:39], v[236:239]
    v_mfma_f32_16x16x32_bf16 v[240:243], a[220:223], v[40:43], v[240:243]
    s_lshl_b32 s96, s98, 6
    s_add_u32 s96, s96, s40
    v_mfma_f32_16x16x32_bf16 v[244:247], a[220:223], v[44:47], v[244:247]
    v_mfma_f32_16x16x32_bf16 v[248:251], a[220:223], v[48:51], v[248:251]
    v_mfma_f32_16x16x32_bf16 v[252:255], a[220:223], v[52:55], v[252:255]
    s_lshl_b32 s97, s98, 18
    s_add_u32 s97, s97, s42
    s_waitcnt vmcnt(7) lgkmcnt(0)
    s_barrier
    v_mfma_f32_16x16x32_bf16 v[96:99], a[160:163], v[16:19], v[96:99]
    ds_read_b128 v[36:39], v57 offset:0
    v_mfma_f32_16x16x32_bf16 v[100:103], a[160:163], v[20:23], v[100:103]
    s_add_u32 m0, s41, 135168
    v_mfma_f32_16x16x32_bf16 v[104:107], a[160:163], v[24:27], v[104:107]
    buffer_load_dwordx4 v2, s[16:19], s96 offen offset:0 lds
    v_mfma_f32_16x16x32_bf16 v[108:111], a[160:163], v[28:31], v[108:111]
    ds_read_b128 v[40:43], v57 offset:1024
    v_mfma_f32_16x16x32_bf16 v[112:115], a[160:163], v[32:35], v[112:115]
    ds_read_b128 v[44:47], v57 offset:2048
    v_mfma_f32_16x16x32_bf16 v[116:119], a[164:167], v[16:19], v[116:119]
    ds_read_b128 v[48:51], v57 offset:3072
    v_mfma_f32_16x16x32_bf16 v[120:123], a[164:167], v[20:23], v[120:123]
    ds_read_b128 v[52:55], v57 offset:4096
    v_mfma_f32_16x16x32_bf16 v[124:127], a[164:167], v[24:27], v[124:127]
    buffer_load_dwordx4 v62, s[16:19], s96 offen offset:1024 lds
    v_mfma_f32_16x16x32_bf16 v[128:131], a[164:167], v[28:31], v[128:131]
    ds_read_b64_tr_b16 a[192:193], v60 offset:0
    v_mfma_f32_16x16x32_bf16 v[132:135], a[164:167], v[32:35], v[132:135]
    v_mfma_f32_16x16x32_bf16 v[136:139], a[168:171], v[16:19], v[136:139]
    ds_read_b64_tr_b16 a[194:195], v60 offset:4352
    v_mfma_f32_16x16x32_bf16 v[140:143], a[168:171], v[20:23], v[140:143]
    ds_read_b64_tr_b16 a[196:197], v60 offset:8
    v_mfma_f32_16x16x32_bf16 v[144:147], a[168:171], v[24:27], v[144:147]
    buffer_load_dwordx4 v63, s[16:19], s96 offen offset:2048 lds
    v_mfma_f32_16x16x32_bf16 v[148:151], a[168:171], v[28:31], v[148:151]
    ds_read_b64_tr_b16 a[198:199], v60 offset:4360
    v_mfma_f32_16x16x32_bf16 v[152:155], a[168:171], v[32:35], v[152:155]
    ds_read_b64_tr_b16 a[200:201], v60 offset:64
    v_mfma_f32_16x16x32_bf16 v[156:159], a[172:175], v[16:19], v[156:159]
    ds_read_b64_tr_b16 a[202:203], v60 offset:4416
    v_mfma_f32_16x16x32_bf16 v[160:163], a[172:175], v[20:23], v[160:163]
    s_add_u32 m0, s43, 135168
    v_mfma_f32_16x16x32_bf16 v[164:167], a[172:175], v[24:27], v[164:167]
    buffer_load_dwordx4 v3, s[20:23], s97 offen offset:0 lds
    v_mfma_f32_16x16x32_bf16 v[168:171], a[172:175], v[28:31], v[168:171]
    v_mfma_f32_16x16x32_bf16 v[172:175], a[172:175], v[32:35], v[172:175]
    ds_read_b64_tr_b16 a[204:205], v60 offset:72
    v_mfma_f32_16x16x32_bf16 v[176:179], a[176:179], v[16:19], v[176:179]
    ds_read_b64_tr_b16 a[206:207], v60 offset:4424
    v_mfma_f32_16x16x32_bf16 v[180:183], a[176:179], v[20:23], v[180:183]
    ds_read_b64_tr_b16 a[208:209], v60 offset:128
    v_mfma_f32_16x16x32_bf16 v[184:187], a[176:179], v[24:27], v[184:187]
    buffer_load_dwordx4 v64, s[20:23], s97 offen offset:1088 lds
    v_mfma_f32_16x16x32_bf16 v[188:191], a[176:179], v[28:31], v[188:191]
    ds_read_b64_tr_b16 a[210:211], v60 offset:4480
    v_mfma_f32_16x16x32_bf16 v[192:195], a[176:179], v[32:35], v[192:195]
    ds_read_b64_tr_b16 a[212:213], v60 offset:136
    v_mfma_f32_16x16x32_bf16 v[196:199], a[180:183], v[16:19], v[196:199]
    v_mfma_f32_16x16x32_bf16 v[200:203], a[180:183], v[20:23], v[200:203]
    ds_read_b64_tr_b16 a[214:215], v60 offset:4488
    v_mfma_f32_16x16x32_bf16 v[204:207], a[180:183], v[24:27], v[204:207]
    buffer_load_dwordx4 v65, s[20:23], s97 offen offset:2176 lds
    v_mfma_f32_16x16x32_bf16 v[208:211], a[180:183], v[28:31], v[208:211]
    ds_read_b64_tr_b16 a[216:217], v60 offset:192
    v_mfma_f32_16x16x32_bf16 v[212:215], a[180:183], v[32:35], v[212:215]
    ds_read_b64_tr_b16 a[218:219], v60 offset:4544
    v_mfma_f32_16x16x32_bf16 v[216:219], a[184:187], v[16:19], v[216:219]
    ds_read_b64_tr_b16 a[220:221], v60 offset:200
    v_mfma_f32_16x16x32_bf16 v[220:223], a[184:187], v[20:23], v[220:223]
    ds_read_b64_tr_b16 a[222:223], v60 offset:4552
    v_mfma_f32_16x16x32_bf16 v[224:227], a[184:187], v[24:27], v[224:227]
    buffer_load_dwordx4 v66, s[20:23], s97 offen offset:3264 lds
    v_mfma_f32_16x16x32_bf16 v[228:231], a[184:187], v[28:31], v[228:231]
    s_add_u32 s98, s98, 1
    s_cmp_ge_u32 s98, 18
    s_cselect_b32 s98, 0, s98
    v_mfma_f32_16x16x32_bf16 v[232:235], a[184:187], v[32:35], v[232:235]
    v_mfma_f32_16x16x32_bf16 v[236:239], a[188:191], v[16:19], v[236:239]
    v_mfma_f32_16x16x32_bf16 v[240:243], a[188:191], v[20:23], v[240:243]
    s_lshl_b32 s96, s98, 6
    s_add_u32 s96, s96, s40
    v_mfma_f32_16x16x32_bf16 v[244:247], a[188:191], v[24:27], v[244:247]
    v_mfma_f32_16x16x32_bf16 v[248:251], a[188:191], v[28:31], v[248:251]
    v_mfma_f32_16x16x32_bf16 v[252:255], a[188:191], v[32:35], v[252:255]
    s_lshl_b32 s97, s98, 18
    s_add_u32 s97, s97, s42
    s_waitcnt vmcnt(7) lgkmcnt(0)
    s_barrier
    v_mfma_f32_16x16x32_bf16 v[96:99], a[192:195], v[36:39], v[96:99]
    ds_read_b128 v[16:19], v58 offset:0
    v_mfma_f32_16x16x32_bf16 v[100:103], a[192:195], v[40:43], v[100:103]
    s_add_u32 m0, s41, 101376
    v_mfma_f32_16x16x32_bf16 v[104:107], a[192:195], v[44:47], v[104:107]
    buffer_load_dwordx4 v2, s[16:19], s96 offen offset:0 lds
    v_mfma_f32_16x16x32_bf16 v[108:111], a[192:195], v[48:51], v[108:111]
    ds_read_b128 v[20:23], v58 offset:1024
    v_mfma_f32_16x16x32_bf16 v[112:115], a[192:195], v[52:55], v[112:115]
    ds_read_b128 v[24:27], v58 offset:2048
    v_mfma_f32_16x16x32_bf16 v[116:119], a[196:199], v[36:39], v[116:119]
    ds_read_b128 v[28:31], v58 offset:3072
    v_mfma_f32_16x16x32_bf16 v[120:123], a[196:199], v[40:43], v[120:123]
    ds_read_b128 v[32:35], v58 offset:4096
    v_mfma_f32_16x16x32_bf16 v[124:127], a[196:199], v[44:47], v[124:127]
    buffer_load_dwordx4 v62, s[16:19], s96 offen offset:1024 lds
    v_mfma_f32_16x16x32_bf16 v[128:131], a[196:199], v[48:51], v[128:131]
    ds_read_b64_tr_b16 a[160:161], v61 offset:0
    v_mfma_f32_16x16x32_bf16 v[132:135], a[196:199], v[52:55], v[132:135]
    v_mfma_f32_16x16x32_bf16 v[136:139], a[200:203], v[36:39], v[136:139]
    ds_read_b64_tr_b16 a[162:163], v61 offset:4352
    v_mfma_f32_16x16x32_bf16 v[140:143], a[200:203], v[40:43], v[140:143]
    ds_read_b64_tr_b16 a[164:165], v61 offset:8
    v_mfma_f32_16x16x32_bf16 v[144:147], a[200:203], v[44:47], v[144:147]
    buffer_load_dwordx4 v63, s[16:19], s96 offen offset:2048 lds
    v_mfma_f32_16x16x32_bf16 v[148:151], a[200:203], v[48:51], v[148:151]
    ds_read_b64_tr_b16 a[166:167], v61 offset:4360
    v_mfma_f32_16x16x32_bf16 v[152:155], a[200:203], v[52:55], v[152:155]
    ds_read_b64_tr_b16 a[168:169], v61 offset:64
    v_mfma_f32_16x16x32_bf16 v[156:159], a[204:207], v[36:39], v[156:159]
    ds_read_b64_tr_b16 a[170:171], v61 offset:4416
    v_mfma_f32_16x16x32_bf16 v[160:163], a[204:207], v[40:43], v[160:163]
    s_add_u32 m0, s43, 101376
    v_mfma_f32_16x16x32_bf16 v[164:167], a[204:207], v[44:47], v[164:167]
    buffer_load_dwordx4 v3, s[20:23], s97 offen offset:0 lds
    v_mfma_f32_16x16x32_bf16 v[168:171], a[204:207], v[48:51], v[168:171]
    v_mfma_f32_16x16x32_bf16 v[172:175], a[204:207], v[52:55], v[172:175]
    ds_read_b64_tr_b16 a[172:173], v61 offset:72
    v_mfma_f32_16x16x32_bf16 v[176:179], a[208:211], v[36:39], v[176:179]
    ds_read_b64_tr_b16 a[174:175], v61 offset:4424
    v_mfma_f32_16x16x32_bf16 v[180:183], a[208:211], v[40:43], v[180:183]
    ds_read_b64_tr_b16 a[176:177], v61 offset:128
    v_mfma_f32_16x16x32_bf16 v[184:187], a[208:211], v[44:47], v[184:187]
    buffer_load_dwordx4 v64, s[20:23], s97 offen offset:1088 lds
    v_mfma_f32_16x16x32_bf16 v[188:191], a[208:211], v[48:51], v[188:191]
    ds_read_b64_tr_b16 a[178:179], v61 offset:4480
    v_mfma_f32_16x16x32_bf16 v[192:195], a[208:211], v[52:55], v[192:195]
    ds_read_b64_tr_b16 a[180:181], v61 offset:136
    v_mfma_f32_16x16x32_bf16 v[196:199], a[212:215], v[36:39], v[196:199]
    v_mfma_f32_16x16x32_bf16 v[200:203], a[212:215], v[40:43], v[200:203]
    ds_read_b64_tr_b16 a[182:183], v61 offset:4488
    v_mfma_f32_16x16x32_bf16 v[204:207], a[212:215], v[44:47], v[204:207]
    buffer_load_dwordx4 v65, s[20:23], s97 offen offset:2176 lds
    v_mfma_f32_16x16x32_bf16 v[208:211], a[212:215], v[48:51], v[208:211]
    ds_read_b64_tr_b16 a[184:185], v61 offset:192
    v_mfma_f32_16x16x32_bf16 v[212:215], a[212:215], v[52:55], v[212:215]
    ds_read_b64_tr_b16 a[186:187], v61 offset:4544
    v_mfma_f32_16x16x32_bf16 v[216:219], a[216:219], v[36:39], v[216:219]
    ds_read_b64_tr_b16 a[188:189], v61 offset:200
    v_mfma_f32_16x16x32_bf16 v[220:223], a[216:219], v[40:43], v[220:223]
    ds_read_b64_tr_b16 a[190:191], v61 offset:4552
    v_mfma_f32_16x16x32_bf16 v[224:227], a[216:219], v[44:47], v[224:227]
    buffer_load_dwordx4 v66, s[20:23], s97 offen offset:3264 lds
    v_mfma_f32_16x16x32_bf16 v[228:231], a[216:219], v[48:51], v[228:231]
    s_add_u32 s98, s98, 1
    s_cmp_ge_u32 s98, 18
    s_cselect_b32 s98, 0, s98
    v_mfma_f32_16x16x32_bf16 v[232:235], a[216:219], v[52:55], v[232:235]
    v_mfma_f32_16x16x32_bf16 v[236:239], a[220:223], v[36:39], v[236:239]
    v_mfma_f32_16x16x32_bf16 v[240:243], a[220:223], v[40:43], v[240:243]
    s_lshl_b32 s96, s98, 6
    s_add_u32 s96, s96, s40
    v_mfma_f32_16x16x32_bf16 v[244:247], a[220:223], v[44:47], v[244:247]
    v_mfma_f32_16x16x32_bf16 v[248:251], a[220:223], v[48:51], v[248:251]
    v_mfma_f32_16x16x32_bf16 v[252:255], a[220:223], v[52:55], v[252:255]
    s_lshl_b32 s97, s98, 18
    s_add_u32 s97, s97, s42
    s_waitcnt vmcnt(7) lgkmcnt(0)
    s_barrier
    v_mfma_f32_16x16x32_bf16 v[96:99], a[160:163], v[16:19], v[96:99]
    ds_read_b128 v[36:39], v56 offset:0
    v_mfma_f32_16x16x32_bf16 v[100:103], a[160:163], v[20:23], v[100:103]
    s_add_u32 m0, s41, 33792
    v_mfma_f32_16x16x32_bf16 v[104:107], a[160:163], v[24:27], v[104:107]
    buffer_load_dwordx4 v2, s[16:19], s96 offen offset:0 lds
    v_mfma_f32_16x16x32_bf16 v[108:111], a[160:163], v[28:31], v[108:111]
    ds_read_b128 v[40:43], v56 offset:1024
    v_mfma_f32_16x16x32_bf16 v[112:115], a[160:163], v[32:35], v[112:115]
    ds_read_b128 v[44:47], v56 offset:2048
    v_mfma_f32_16x16x32_bf16 v[116:119], a[164:167], v[16:19], v[116:119]
    ds_read_b128 v[48:51], v56 offset:3072
    v_mfma_f32_16x16x32_bf16 v[120:123], a[164:167], v[20:23], v[120:123]
    ds_read_b128 v[52:55], v56 offset:4096
    v_mfma_f32_16x16x32_bf16 v[124:127], a[164:167], v[24:27], v[124:127]
    buffer_load_dwordx4 v62, s[16:19], s96 offen offset:1024 lds
    v_mfma_f32_16x16x32_bf16 v[128:131], a[164:167], v[28:31], v[128:131]
    ds_read_b64_tr_b16 a[192:193], v59 offset:0
    v_mfma_f32_16x16x32_bf16 v[132:135], a[164:167], v[32:35], v[132:135]
    v_mfma_f32_16x16x32_bf16 v[136:139], a[168:171], v[16:19], v[136:139]
    ds_read_b64_tr_b16 a[194:195], v59 offset:4352
    v_mfma_f32_16x16x32_bf16 v[140:143], a[168:171], v[20:23], v[140:143]
    ds_read_b64_tr_b16 a[196:197], v59 offset:8
    v_mfma_f32_16x16x32_bf16 v[144:147], a[168:171], v[24:27], v[144:147]
    buffer_load_dwordx4 v63, s[16:19], s96 offen offset:2048 lds
    v_mfma_f32_16x16x32_bf16 v[148:151], a[168:171], v[28:31], v[148:151]
    ds_read_b64_tr_b16 a[198:199], v59 offset:4360
    v_mfma_f32_16x16x32_bf16 v[152:155], a[168:171], v[32:35], v[152:155]
    ds_read_b64_tr_b16 a[200:201], v59 offset:64
    v_mfma_f32_16x16x32_bf16 v[156:159], a[172:175], v[16:19], v[156:159]
    ds_read_b64_tr_b16 a[202:203], v59 offset:4416
    v_mfma_f32_16x16x32_bf16 v[160:163], a[172:175], v[20:23], v[160:163]
    s_add_u32 m0, s43, 33792
    v_mfma_f32_16x16x32_bf16 v[164:167], a[172:175], v[24:27], v[164:167]
    buffer_load_dwordx4 v3, s[20:23], s97 offen offset:0 lds
    v_mfma_f32_16x16x32_bf16 v[168:171], a[172:175], v[28:31], v[168:171]
    v_mfma_f32_16x16x32_bf16 v[172:175], a[172:175], v[32:35], v[172:175]
    ds_read_b64_tr_b16 a[204:205], v59 offset:72
    v_mfma_f32_16x16x32_bf16 v[176:179], a[176:179], v[16:19], v[176:179]
    ds_read_b64_tr_b16 a[206:207], v59 offset:4424
    v_mfma_f32_16x16x32_bf16 v[180:183], a[176:179], v[20:23], v[180:183]
    ds_read_b64_tr_b16 a[208:209], v59 offset:128
    v_mfma_f32_16x16x32_bf16 v[184:187], a[176:179], v[24:27], v[184:187]
    buffer_load_dwordx4 v64, s[20:23], s97 offen offset:1088 lds
    v_mfma_f32_16x16x32_bf16 v[188:191], a[176:179], v[28:31], v[188:191]
    ds_read_b64_tr_b16 a[210:211], v59 offset:4480
    v_mfma_f32_16x16x32_bf16 v[192:195], a[176:179], v[32:35], v[192:195]
    ds_read_b64_tr_b16 a[212:213], v59 offset:136
    v_mfma_f32_16x16x32_bf16 v[196:199], a[180:183], v[16:19], v[196:199]
    v_mfma_f32_16x16x32_bf16 v[200:203], a[180:183], v[20:23], v[200:203]
    ds_read_b64_tr_b16 a[214:215], v59 offset:4488
    v_mfma_f32_16x16x32_bf16 v[204:207], a[180:183], v[24:27], v[204:207]
    buffer_load_dwordx4 v65, s[20:23], s97 offen offset:2176 lds
    v_mfma_f32_16x16x32_bf16 v[208:211], a[180:183], v[28:31], v[208:211]
    ds_read_b64_tr_b16 a[216:217], v59 offset:192
    v_mfma_f32_16x16x32_bf16 v[212:215], a[180:183], v[32:35], v[212:215]
    ds_read_b64_tr_b16 a[218:219], v59 offset:4544
    v_mfma_f32_16x16x32_bf16 v[216:219], a[184:187], v[16:19], v[216:219]
    ds_read_b64_tr_b16 a[220:221], v59 offset:200
    v_mfma_f32_16x16x32_bf16 v[220:223], a[184:187], v[20:23], v[220:223]
    ds_read_b64_tr_b16 a[222:223], v59 offset:4552
    v_mfma_f32_16x16x32_bf16 v[224:227], a[184:187], v[24:27], v[224:227]
    buffer_load_dwordx4 v66, s[20:23], s97 offen offset:3264 lds
    v_mfma_f32_16x16x32_bf16 v[228:231], a[184:187], v[28:31], v[228:231]
    s_add_u32 s98, s98, 1
    s_cmp_ge_u32 s98, 18
    s_cselect_b32 s98, 0, s98
    v_mfma_f32_16x16x32_bf16 v[232:235], a[184:187], v[32:35], v[232:235]
    v_mfma_f32_16x16x32_bf16 v[236:239], a[188:191], v[16:19], v[236:239]
    v_mfma_f32_16x16x32_bf16 v[240:243], a[188:191], v[20:23], v[240:243]
    s_lshl_b32 s96, s98, 6
    s_add_u32 s96, s96, s40
    v_mfma_f32_16x16x32_bf16 v[244:247], a[188:191], v[24:27], v[244:247]
    v_mfma_f32_16x16x32_bf16 v[248:251], a[188:191], v[28:31], v[248:251]
    v_mfma_f32_16x16x32_bf16 v[252:255], a[188:191], v[32:35], v[252:255]
    s_lshl_b32 s97, s98, 18
    s_add_u32 s97, s97, s42
    s_waitcnt vmcnt(7) lgkmcnt(0)
    s_barrier
    v_mfma_f32_16x16x32_bf16 v[96:99], a[192:195], v[36:39], v[96:99]
    ds_read_b128 v[16:19], v57 offset:0
    v_mfma_f32_16x16x32_bf16 v[100:103], a[192:195], v[40:43], v[100:103]
    ds_read_b128 v[20:23], v57 offset:1024
    v_mfma_f32_16x16x32_bf16 v[104:107], a[192:195], v[44:47], v[104:107]
    ds_read_b128 v[24:27], v57 offset:2048
    v_mfma_f32_16x16x32_bf16 v[108:111], a[192:195], v[48:51], v[108:111]
    ds_read_b128 v[28:31], v57 offset:3072
    v_mfma_f32_16x16x32_bf16 v[112:115], a[192:195], v[52:55], v[112:115]
    s_add_u32 m0, s47, 0
    s_mov_b32 s46, 0
    v_mfma_f32_16x16x32_bf16 v[116:119], a[196:199], v[36:39], v[116:119]
    buffer_load_dwordx4 v6, s[24:27], s46 offen offset:0 nt lds
    v_mfma_f32_16x16x32_bf16 v[120:123], a[196:199], v[40:43], v[120:123]
    ds_read_b128 v[32:35], v57 offset:4096
    v_mfma_f32_16x16x32_bf16 v[124:127], a[196:199], v[44:47], v[124:127]
    v_mfma_f32_16x16x32_bf16 v[128:131], a[196:199], v[48:51], v[128:131]
    ds_read_b64_tr_b16 a[160:161], v60 offset:0
    v_mfma_f32_16x16x32_bf16 v[132:135], a[196:199], v[52:55], v[132:135]
    ds_read_b64_tr_b16 a[162:163], v60 offset:4352
    v_mfma_f32_16x16x32_bf16 v[136:139], a[200:203], v[36:39], v[136:139]
    ds_read_b64_tr_b16 a[164:165], v60 offset:8
    v_mfma_f32_16x16x32_bf16 v[140:143], a[200:203], v[40:43], v[140:143]
    ds_read_b64_tr_b16 a[166:167], v60 offset:4360
    v_mfma_f32_16x16x32_bf16 v[144:147], a[200:203], v[44:47], v[144:147]
    v_mfma_f32_16x16x32_bf16 v[148:151], a[200:203], v[48:51], v[148:151]
    s_add_u32 m0, s47, 0
    s_mov_b32 s46, 0
    v_mfma_f32_16x16x32_bf16 v[152:155], a[200:203], v[52:55], v[152:155]
    buffer_load_dwordx4 v7, s[24:27], s46 offen offset:1056 nt lds
    v_mfma_f32_16x16x32_bf16 v[156:159], a[204:207], v[36:39], v[156:159]
    ds_read_b64_tr_b16 a[168:169], v60 offset:64
    v_mfma_f32_16x16x32_bf16 v[160:163], a[204:207], v[40:43], v[160:163]
    ds_read_b64_tr_b16 a[170:171], v60 offset:4416
    v_mfma_f32_16x16x32_bf16 v[164:167], a[204:207], v[44:47], v[164:167]
    ds_read_b64_tr_b16 a[172:173], v60 offset:72
    v_mfma_f32_16x16x32_bf16 v[168:171], a[204:207], v[48:51], v[168:171]
    ds_read_b64_tr_b16 a[174:175], v60 offset:4424
    v_mfma_f32_16x16x32_bf16 v[172:175], a[204:207], v[52:55], v[172:175]
    v_mfma_f32_16x16x32_bf16 v[176:179], a[208:211], v[36:39], v[176:179]
    ds_read_b64_tr_b16 a[176:177], v60 offset:128
    v_mfma_f32_16x16x32_bf16 v[180:183], a[208:211], v[40:43], v[180:183]
    ds_read_b64_tr_b16 a[178:179], v60 offset:4480
    v_mfma_f32_16x16x32_bf16 v[184:187], a[208:211], v[44:47], v[184:187]
    s_add_u32 m0, s47, 0
    s_mov_b32 s46, 0
    v_mfma_f32_16x16x32_bf16 v[188:191], a[208:211], v[48:51], v[188:191]
    buffer_load_dwordx4 v8, s[24:27], s46 offen offset:2112 nt lds
    v_mfma_f32_16x16x32_bf16 v[192:195], a[208:211], v[52:55], v[192:195]
    ds_read_b64_tr_b16 a[180:181], v60 offset:136
    v_mfma_f32_16x16x32_bf16 v[196:199], a[212:215], v[36:39], v[196:199]
    ds_read_b64_tr_b16 a[182:183], v60 offset:4488
    v_mfma_f32_16x16x32_bf16 v[200:203], a[212:215], v[40:43], v[200:203]
    v_mfma_f32_16x16x32_bf16 v[204:207], a[212:215], v[44:47], v[204:207]
    ds_read_b64_tr_b16 a[184:185], v60 offset:192
    v_mfma_f32_16x16x32_bf16 v[208:211], a[212:215], v[48:51], v[208:211]
    ds_read_b64_tr_b16 a[186:187], v60 offset:4544
    v_mfma_f32_16x16x32_bf16 v[212:215], a[212:215], v[52:55], v[212:215]
    ds_read_b64_tr_b16 a[188:189], v60 offset:200
    v_mfma_f32_16x16x32_bf16 v[216:219], a[216:219], v[36:39], v[216:219]
    ds_read_b64_tr_b16 a[190:191], v60 offset:4552
    v_mfma_f32_16x16x32_bf16 v[220:223], a[216:219], v[40:43], v[220:223]
    s_add_u32 m0, s47, 0
    s_mov_b32 s46, 0
    v_mfma_f32_16x16x32_bf16 v[224:227], a[216:219], v[44:47], v[224:227]
    buffer_load_dwordx4 v9, s[24:27], s46 offen offset:3168 nt lds
    v_mfma_f32_16x16x32_bf16 v[228:231], a[216:219], v[48:51], v[228:231]
    v_mfma_f32_16x16x32_bf16 v[232:235], a[216:219], v[52:55], v[232:235]
    v_mfma_f32_16x16x32_bf16 v[236:239], a[220:223], v[36:39], v[236:239]
    v_mfma_f32_16x16x32_bf16 v[240:243], a[220:223], v[40:43], v[240:243]
    v_mfma_f32_16x16x32_bf16 v[244:247], a[220:223], v[44:47], v[244:247]
    v_mfma_f32_16x16x32_bf16 v[248:251], a[220:223], v[48:51], v[248:251]
    v_mfma_f32_16x16x32_bf16 v[252:255], a[220:223], v[52:55], v[252:255]
    s_waitcnt vmcnt(4) lgkmcnt(0)
    s_barrier
    v_mfma_f32_16x16x32_bf16 v[96:99], a[160:163], v[16:19], v[96:99]
    ds_read_b128 v[36:39], v58 offset:0
    v_mfma_f32_16x16x32_bf16 v[100:103], a[160:163], v[20:23], v[100:103]
    ds_read_b128 v[40:43], v58 offset:1024
    v_mfma_f32_16x16x32_bf16 v[104:107], a[160:163], v[24:27], v[104:107]
    ds_read_b128 v[44:47], v58 offset:2048
    v_mfma_f32_16x16x32_bf16 v[108:111], a[160:163], v[28:31], v[108:111]
    ds_read_b128 v[48:51], v58 offset:3072
    v_mfma_f32_16x16x32_bf16 v[112:115], a[160:163], v[32:35], v[112:115]
    s_add_u32 m0, s47, 16896
    s_mov_b32 s46, 16384
    v_mfma_f32_16x16x32_bf16 v[116:119], a[164:167], v[16:19], v[116:119]
    buffer_load_dwordx4 v6, s[24:27], s46 offen offset:0 nt lds
    v_mfma_f32_16x16x32_bf16 v[120:123], a[164:167], v[20:23], v[120:123]
    ds_read_b128 v[52:55], v58 offset:4096
    v_mfma_f32_16x16x32_bf16 v[124:127], a[164:167], v[24:27], v[124:127]
    v_mfma_f32_16x16x32_bf16 v[128:131], a[164:167], v[28:31], v[128:131]
    ds_read_b64_tr_b16 a[192:193], v61 offset:0
    v_mfma_f32_16x16x32_bf16 v[132:135], a[164:167], v[32:35], v[132:135]
    ds_read_b64_tr_b16 a[194:195], v61 offset:4352
    v_mfma_f32_16x16x32_bf16 v[136:139], a[168:171], v[16:19], v[136:139]
    ds_read_b64_tr_b16 a[196:197], v61 offset:8
    v_mfma_f32_16x16x32_bf16 v[140:143], a[168:171], v[20:23], v[140:143]
    ds_read_b64_tr_b16 a[198:199], v61 offset:4360
    v_mfma_f32_16x16x32_bf16 v[144:147], a[168:171], v[24:27], v[144:147]
    v_mfma_f32_16x16x32_bf16 v[148:151], a[168:171], v[28:31], v[148:151]
    s_add_u32 m0, s47, 16896
    s_mov_b32 s46, 16384
    v_mfma_f32_16x16x32_bf16 v[152:155], a[168:171], v[32:35], v[152:155]
    buffer_load_dwordx4 v7, s[24:27], s46 offen offset:1056 nt lds
    v_mfma_f32_16x16x32_bf16 v[156:159], a[172:175], v[16:19], v[156:159]
    ds_read_b64_tr_b16 a[200:201], v61 offset:64
    v_mfma_f32_16x16x32_bf16 v[160:163], a[172:175], v[20:23], v[160:163]
    ds_read_b64_tr_b16 a[202:203], v61 offset:4416
    v_mfma_f32_16x16x32_bf16 v[164:167], a[172:175], v[24:27], v[164:167]
    ds_read_b64_tr_b16 a[204:205], v61 offset:72
    v_mfma_f32_16x16x32_bf16 v[168:171], a[172:175], v[28:31], v[168:171]
    ds_read_b64_tr_b16 a[206:207], v61 offset:4424
    v_mfma_f32_16x16x32_bf16 v[172:175], a[172:175], v[32:35], v[172:175]
    v_mfma_f32_16x16x32_bf16 v[176:179], a[176:179], v[16:19], v[176:179]
    ds_read_b64_tr_b16 a[208:209], v61 offset:128
    v_mfma_f32_16x16x32_bf16 v[180:183], a[176:179], v[20:23], v[180:183]
    ds_read_b64_tr_b16 a[210:211], v61 offset:4480
    v_mfma_f32_16x16x32_bf16 v[184:187], a[176:179], v[24:27], v[184:187]
    s_add_u32 m0, s47, 16896
    s_mov_b32 s46, 16384
    v_mfma_f32_16x16x32_bf16 v[188:191], a[176:179], v[28:31], v[188:191]
    buffer_load_dwordx4 v8, s[24:27], s46 offen offset:2112 nt lds
    v_mfma_f32_16x16x32_bf16 v[192:195], a[176:179], v[32:35], v[192:195]
    ds_read_b64_tr_b16 a[212:213], v61 offset:136
    v_mfma_f32_16x16x32_bf16 v[196:199], a[180:183], v[16:19], v[196:199]
    ds_read_b64_tr_b16 a[214:215], v61 offset:4488
    v_mfma_f32_16x16x32_bf16 v[200:203], a[180:183], v[20:23], v[200:203]
    v_mfma_f32_16x16x32_bf16 v[204:207], a[180:183], v[24:27], v[204:207]
    ds_read_b64_tr_b16 a[216:217], v61 offset:192
    v_mfma_f32_16x16x32_bf16 v[208:211], a[180:183], v[28:31], v[208:211]
    ds_read_b64_tr_b16 a[218:219], v61 offset:4544
    v_mfma_f32_16x16x32_bf16 v[212:215], a[180:183], v[32:35], v[212:215]
    ds_read_b64_tr_b16 a[220:221], v61 offset:200
    v_mfma_f32_16x16x32_bf16 v[216:219], a[184:187], v[16:19], v[216:219]
    ds_read_b64_tr_b16 a[222:223], v61 offset:4552
    v_mfma_f32_16x16x32_bf16 v[220:223], a[184:187], v[20:23], v[220:223]
    s_add_u32 m0, s47, 16896
    s_mov_b32 s46, 16384
    v_mfma_f32_16x16x32_bf16 v[224:227], a[184:187], v[24:27], v[224:227]
    buffer_load_dwordx4 v9, s[24:27], s46 offen offset:3168 nt lds
    v_mfma_f32_16x16x32_bf16 v[228:231], a[184:187], v[28:31], v[228:231]
    v_mfma_f32_16x16x32_bf16 v[232:235], a[184:187], v[32:35], v[232:235]
    v_mfma_f32_16x16x32_bf16 v[236:239], a[188:191], v[16:19], v[236:239]
    v_mfma_f32_16x16x32_bf16 v[240:243], a[188:191], v[20:23], v[240:243]
    v_mfma_f32_16x16x32_bf16 v[244:247], a[188:191], v[24:27], v[244:247]
    v_mfma_f32_16x16x32_bf16 v[248:251], a[188:191], v[28:31], v[248:251]
    v_mfma_f32_16x16x32_bf16 v[252:255], a[188:191], v[32:35], v[252:255]
    s_waitcnt lgkmcnt(0)
    s_barrier
    v_mfma_f32_16x16x32_bf16 v[96:99], a[192:195], v[36:39], v[96:99]
    v_mfma_f32_16x16x32_bf16 v[100:103], a[192:195], v[40:43], v[100:103]
    v_mfma_f32_16x16x32_bf16 v[104:107], a[192:195], v[44:47], v[104:107]
    v_mfma_f32_16x16x32_bf16 v[108:111], a[192:195], v[48:51], v[108:111]
    v_mfma_f32_16x16x32_bf16 v[112:115], a[192:195], v[52:55], v[112:115]
    s_add_u32 m0, s47, 67584
    s_mov_b32 s46, 0
    v_mfma_f32_16x16x32_bf16 v[116:119], a[196:199], v[36:39], v[116:119]
    buffer_load_dwordx4 v10, s[28:31], s46 offen offset:0 nt lds
    v_mfma_f32_16x16x32_bf16 v[120:123], a[196:199], v[40:43], v[120:123]
    v_mfma_f32_16x16x32_bf16 v[124:127], a[196:199], v[44:47], v[124:127]
    v_mfma_f32_16x16x32_bf16 v[128:131], a[196:199], v[48:51], v[128:131]
    v_mfma_f32_16x16x32_bf16 v[132:135], a[196:199], v[52:55], v[132:135]
    v_mfma_f32_16x16x32_bf16 v[136:139], a[200:203], v[36:39], v[136:139]
    v_mfma_f32_16x16x32_bf16 v[140:143], a[200:203], v[40:43], v[140:143]
    v_mfma_f32_16x16x32_bf16 v[144:147], a[200:203], v[44:47], v[144:147]
    v_mfma_f32_16x16x32_bf16 v[148:151], a[200:203], v[48:51], v[148:151]
    s_add_u32 m0, s47, 67584
    s_mov_b32 s46, 0
    v_mfma_f32_16x16x32_bf16 v[152:155], a[200:203], v[52:55], v[152:155]
    buffer_load_dwordx4 v11, s[28:31], s46 offen offset:1056 nt lds
    v_mfma_f32_16x16x32_bf16 v[156:159], a[204:207], v[36:39], v[156:159]
    v_mfma_f32_16x16x32_bf16 v[160:163], a[204:207], v[40:43], v[160:163]
    v_mfma_f32_16x16x32_bf16 v[164:167], a[204:207], v[44:47], v[164:167]
    v_mfma_f32_16x16x32_bf16 v[168:171], a[204:207], v[48:51], v[168:171]
    v_mfma_f32_16x16x32_bf16 v[172:175], a[204:207], v[52:55], v[172:175]
    v_mfma_f32_16x16x32_bf16 v[176:179], a[208:211], v[36:39], v[176:179]
    v_mfma_f32_16x16x32_bf16 v[180:183], a[208:211], v[40:43], v[180:183]
    v_mfma_f32_16x16x32_bf16 v[184:187], a[208:211], v[44:47], v[184:187]
    s_add_u32 m0, s47, 67584
    s_mov_b32 s46, 0
    v_mfma_f32_16x16x32_bf16 v[188:191], a[208:211], v[48:51], v[188:191]
    buffer_load_dwordx4 v12, s[28:31], s46 offen offset:2112 nt lds
    v_mfma_f32_16x16x32_bf16 v[192:195], a[208:211], v[52:55], v[192:195]
    v_mfma_f32_16x16x32_bf16 v[196:199], a[212:215], v[36:39], v[196:199]
    v_mfma_f32_16x16x32_bf16 v[200:203], a[212:215], v[40:43], v[200:203]
    v_mfma_f32_16x16x32_bf16 v[204:207], a[212:215], v[44:47], v[204:207]
    v_mfma_f32_16x16x32_bf16 v[208:211], a[212:215], v[48:51], v[208:211]
    v_mfma_f32_16x16x32_bf16 v[212:215], a[212:215], v[52:55], v[212:215]
    v_mfma_f32_16x16x32_bf16 v[216:219], a[216:219], v[36:39], v[216:219]
    v_mfma_f32_16x16x32_bf16 v[220:223], a[216:219], v[40:43], v[220:223]
    s_add_u32 m0, s47, 67584
    s_mov_b32 s46, 0
    v_mfma_f32_16x16x32_bf16 v[224:227], a[216:219], v[44:47], v[224:227]
    buffer_load_dwordx4 v13, s[28:31], s46 offen offset:3168 nt lds
    v_mfma_f32_16x16x32_bf16 v[228:231], a[216:219], v[48:51], v[228:231]
    v_mfma_f32_16x16x32_bf16 v[232:235], a[216:219], v[52:55], v[232:235]
    v_mfma_f32_16x16x32_bf16 v[236:239], a[220:223], v[36:39], v[236:239]
    v_mfma_f32_16x16x32_bf16 v[240:243], a[220:223], v[40:43], v[240:243]
    v_mfma_f32_16x16x32_bf16 v[244:247], a[220:223], v[44:47], v[244:247]
    v_mfma_f32_16x16x32_bf16 v[248:251], a[220:223], v[48:51], v[248:251]
    v_mfma_f32_16x16x32_bf16 v[252:255], a[220:223], v[52:55], v[252:255]
    s_mov_b32 s56, 0x3e0293ee
    s_mov_b32 s57, 0x3e0293ee
    s_waitcnt vmcnt(8)
    s_barrier
    ds_read_b128 a[160:163], v14 offset:0
    ds_read_b128 a[164:167], v14 offset:64
    ds_read_b128 a[168:171], v14 offset:128
    ds_read_b128 a[172:175], v14 offset:192
    ds_read_b128 a[176:179], v14 offset:256
    ds_read_b128 a[180:183], v14 offset:320
    ds_read_b128 a[184:187], v14 offset:384
    ds_read_b128 a[188:191], v14 offset:448
    v_pk_mul_f32 v[96:97], v[96:97], s[56:57]
    v_pk_mul_f32 v[98:99], v[98:99], s[56:57]
    v_cvt_pk_bf16_f32 v16, v96, v97
    v_cvt_pk_bf16_f32 v17, v98, v99
    v_pk_mul_f32 v[116:117], v[116:117], s[56:57]
    v_pk_mul_f32 v[118:119], v[118:119], s[56:57]
    v_cvt_pk_bf16_f32 v18, v116, v117
    v_cvt_pk_bf16_f32 v19, v118, v119
    v_pk_mul_f32 v[100:101], v[100:101], s[56:57]
    v_pk_mul_f32 v[102:103], v[102:103], s[56:57]
    v_cvt_pk_bf16_f32 v32, v100, v101
    v_cvt_pk_bf16_f32 v33, v102, v103
    v_pk_mul_f32 v[120:121], v[120:121], s[56:57]
    v_pk_mul_f32 v[122:123], v[122:123], s[56:57]
    v_cvt_pk_bf16_f32 v34, v120, v121
    v_cvt_pk_bf16_f32 v35, v122, v123
    v_pk_mul_f32 v[104:105], v[104:105], s[56:57]
    v_pk_mul_f32 v[106:107], v[106:107], s[56:57]
    v_cvt_pk_bf16_f32 v48, v104, v105
    v_cvt_pk_bf16_f32 v49, v106, v107
    v_pk_mul_f32 v[124:125], v[124:125], s[56:57]
    v_pk_mul_f32 v[126:127], v[126:127], s[56:57]
    v_cvt_pk_bf16_f32 v50, v124, v125
    v_cvt_pk_bf16_f32 v51, v126, v127
    v_pk_mul_f32 v[108:109], v[108:109], s[56:57]
    v_pk_mul_f32 v[110:111], v[110:111], s[56:57]
    v_cvt_pk_bf16_f32 v64, v108, v109
    v_cvt_pk_bf16_f32 v65, v110, v111
    v_pk_mul_f32 v[128:129], v[128:129], s[56:57]
    v_pk_mul_f32 v[130:131], v[130:131], s[56:57]
    v_cvt_pk_bf16_f32 v66, v128, v129
    v_cvt_pk_bf16_f32 v67, v130, v131
    v_pk_mul_f32 v[112:113], v[112:113], s[56:57]
    v_pk_mul_f32 v[114:115], v[114:115], s[56:57]
    v_cvt_pk_bf16_f32 v80, v112, v113
    v_cvt_pk_bf16_f32 v81, v114, v115
    v_pk_mul_f32 v[132:133], v[132:133], s[56:57]
    v_pk_mul_f32 v[134:135], v[134:135], s[56:57]
    v_cvt_pk_bf16_f32 v82, v132, v133
    v_cvt_pk_bf16_f32 v83, v134, v135
    s_add_u32 m0, s47, 33792
    s_mov_b32 s46, 32768
    buffer_load_dwordx4 v6, s[24:27], s46 offen offset:0 nt lds
    buffer_load_dwordx4 v7, s[24:27], s46 offen offset:1056 nt lds
    buffer_load_dwordx4 v8, s[24:27], s46 offen offset:2112 nt lds
    buffer_load_dwordx4 v9, s[24:27], s46 offen offset:3168 nt lds
    s_waitcnt lgkmcnt(0)
    v_mfma_f32_16x16x32_bf16 v[96:99], a[160:163], v[16:19], 0
    v_mul_f32 v136, s56, v136
    v_mul_f32 v137, s56, v137
    v_mul_f32 v138, s56, v138
    v_mul_f32 v139, s56, v139
    v_cvt_pk_bf16_f32 v20, v136, v137
    v_cvt_pk_bf16_f32 v21, v138, v139
    v_mfma_f32_16x16x32_bf16 v[104:107], a[160:163], v[32:35], 0
    v_mul_f32 v156, s56, v156
    v_mul_f32 v157, s56, v157
    v_mul_f32 v158, s56, v158
    v_mul_f32 v159, s56, v159
    v_cvt_pk_bf16_f32 v22, v156, v157
    v_cvt_pk_bf16_f32 v23, v158, v159
    v_mfma_f32_16x16x32_bf16 v[112:115], a[160:163], v[48:51], 0
    v_mul_f32 v140, s56, v140
    v_mul_f32 v141, s56, v141
    v_mul_f32 v142, s56, v142
    v_mul_f32 v143, s56, v143
    v_cvt_pk_bf16_f32 v36, v140, v141
    v_cvt_pk_bf16_f32 v37, v142, v143
    v_mfma_f32_16x16x32_bf16 v[120:123], a[160:163], v[64:67], 0
    v_mul_f32 v160, s56, v160
    v_mul_f32 v161, s56, v161
    v_mul_f32 v162, s56, v162
    v_mul_f32 v163, s56, v163
    v_cvt_pk_bf16_f32 v38, v160, v161
    v_cvt_pk_bf16_f32 v39, v162, v163
    v_mfma_f32_16x16x32_bf16 v[128:131], a[160:163], v[80:83], 0
    v_mul_f32 v144, s56, v144
    v_mul_f32 v145, s56, v145
    v_mul_f32 v146, s56, v146
    v_mul_f32 v147, s56, v147
    v_cvt_pk_bf16_f32 v52, v144, v145
    v_cvt_pk_bf16_f32 v53, v146, v147
    v_mfma_f32_16x16x32_bf16 v[100:103], a[176:179], v[16:19], 0
    v_mul_f32 v164, s56, v164
    v_mul_f32 v165, s56, v165
    v_mul_f32 v166, s56, v166
    v_mul_f32 v167, s56, v167
    v_cvt_pk_bf16_f32 v54, v164, v165
    v_cvt_pk_bf16_f32 v55, v166, v167
    v_mfma_f32_16x16x32_bf16 v[108:111], a[176:179], v[32:35], 0
    v_mul_f32 v148, s56, v148
    v_mul_f32 v149, s56, v149
    v_mul_f32 v150, s56, v150
    v_mul_f32 v151, s56, v151
    v_cvt_pk_bf16_f32 v68, v148, v149
    v_cvt_pk_bf16_f32 v69, v150, v151
    v_mfma_f32_16x16x32_bf16 v[116:119], a[176:179], v[48:51], 0
    v_mul_f32 v168, s56, v168
    v_mul_f32 v169, s56, v169
    v_mul_f32 v170, s56, v170
    v_mul_f32 v171, s56, v171
    v_cvt_pk_bf16_f32 v70, v168, v169
    v_cvt_pk_bf16_f32 v71, v170, v171
    v_mfma_f32_16x16x32_bf16 v[124:127], a[176:179], v[64:67], 0
    v_mul_f32 v152, s56, v152
    v_mul_f32 v153, s56, v153
    v_mul_f32 v154, s56, v154
    v_mul_f32 v155, s56, v155
    v_cvt_pk_bf16_f32 v84, v152, v153
    v_cvt_pk_bf16_f32 v85, v154, v155
    v_mfma_f32_16x16x32_bf16 v[132:135], a[176:179], v[80:83], 0
    v_mul_f32 v172, s56, v172
    v_mul_f32 v173, s56, v173
    v_mul_f32 v174, s56, v174
    v_mul_f32 v175, s56, v175
    v_cvt_pk_bf16_f32 v86, v172, v173
    v_cvt_pk_bf16_f32 v87, v174, v175
    s_add_u32 m0, s47, 84480
    s_mov_b32 s46, 16384
    buffer_load_dwordx4 v10, s[28:31], s46 offen offset:0 nt lds
    buffer_load_dwordx4 v11, s[28:31], s46 offen offset:1056 nt lds
    buffer_load_dwordx4 v12, s[28:31], s46 offen offset:2112 nt lds
    buffer_load_dwordx4 v13, s[28:31], s46 offen offset:3168 nt lds
    v_mfma_f32_16x16x32_bf16 v[96:99], a[164:167], v[20:23], v[96:99]
    v_mul_f32 v176, s56, v176
    v_mul_f32 v177, s56, v177
    v_mul_f32 v178, s56, v178
    v_mul_f32 v179, s56, v179
    v_cvt_pk_bf16_f32 v24, v176, v177
    v_cvt_pk_bf16_f32 v25, v178, v179
    v_mfma_f32_16x16x32_bf16 v[104:107], a[164:167], v[36:39], v[104:107]
    v_mul_f32 v196, s56, v196
    v_mul_f32 v197, s56, v197
    v_mul_f32 v198, s56, v198
    v_mul_f32 v199, s56, v199
    v_cvt_pk_bf16_f32 v26, v196, v197
    v_cvt_pk_bf16_f32 v27, v198, v199
    v_mfma_f32_16x16x32_bf16 v[112:115], a[164:167], v[52:55], v[112:115]
    v_mul_f32 v180, s56, v180
    v_mul_f32 v181, s56, v181
    v_mul_f32 v182, s56, v182
    v_mul_f32 v183, s56, v183
    v_cvt_pk_bf16_f32 v40, v180, v181
    v_cvt_pk_bf16_f32 v41, v182, v183
    v_mfma_f32_16x16x32_bf16 v[120:123], a[164:167], v[68:71], v[120:123]
    v_mul_f32 v200, s56, v200
    v_mul_f32 v201, s56, v201
    v_mul_f32 v202, s56, v202
    v_mul_f32 v203, s56, v203
    v_cvt_pk_bf16_f32 v42, v200, v201
    v_cvt_pk_bf16_f32 v43, v202, v203
    v_mfma_f32_16x16x32_bf16 v[128:131], a[164:167], v[84:87], v[128:131]
    v_mul_f32 v184, s56, v184
    v_mul_f32 v185, s56, v185
    v_mul_f32 v186, s56, v186
    v_mul_f32 v187, s56, v187
    v_cvt_pk_bf16_f32 v56, v184, v185
    v_cvt_pk_bf16_f32 v57, v186, v187
    v_mfma_f32_16x16x32_bf16 v[100:103], a[180:183], v[20:23], v[100:103]
    v_mul_f32 v204, s56, v204
    v_mul_f32 v205, s56, v205
    v_mul_f32 v206, s56, v206
    v_mul_f32 v207, s56, v207
    v_cvt_pk_bf16_f32 v58, v204, v205
    v_cvt_pk_bf16_f32 v59, v206, v207
    v_mfma_f32_16x16x32_bf16 v[108:111], a[180:183], v[36:39], v[108:111]
    v_mul_f32 v188, s56, v188
    v_mul_f32 v189, s56, v189
    v_mul_f32 v190, s56, v190
    v_mul_f32 v191, s56, v191
    v_cvt_pk_bf16_f32 v72, v188, v189
    v_cvt_pk_bf16_f32 v73, v190, v191
    v_mfma_f32_16x16x32_bf16 v[116:119], a[180:183], v[52:55], v[116:119]
    v_mul_f32 v208, s56, v208
    v_mul_f32 v209, s56, v209
    v_mul_f32 v210, s56, v210
    v_mul_f32 v211, s56, v211
    v_cvt_pk_bf16_f32 v74, v208, v209
    v_cvt_pk_bf16_f32 v75, v210, v211
    v_mfma_f32_16x16x32_bf16 v[124:127], a[180:183], v[68:71], v[124:127]
    v_mul_f32 v192, s56, v192
    v_mul_f32 v193, s56, v193
    v_mul_f32 v194, s56, v194
    v_mul_f32 v195, s56, v195
    v_cvt_pk_bf16_f32 v88, v192, v193
    v_cvt_pk_bf16_f32 v89, v194, v195
    v_mfma_f32_16x16x32_bf16 v[132:135], a[180:183], v[84:87], v[132:135]
    v_mul_f32 v212, s56, v212
    v_mul_f32 v213, s56, v213
    v_mul_f32 v214, s56, v214
    v_mul_f32 v215, s56, v215
    v_cvt_pk_bf16_f32 v90, v212, v213
    v_cvt_pk_bf16_f32 v91, v214, v215
    v_mfma_f32_16x16x32_bf16 v[96:99], a[168:171], v[24:27], v[96:99]
    v_mul_f32 v216, s56, v216
    v_mul_f32 v217, s56, v217
    v_mul_f32 v218, s56, v218
    v_mul_f32 v219, s56, v219
    v_cvt_pk_bf16_f32 v28, v216, v217
    v_cvt_pk_bf16_f32 v29, v218, v219
    v_mfma_f32_16x16x32_bf16 v[104:107], a[168:171], v[40:43], v[104:107]
    v_mul_f32 v236, s56, v236
    v_mul_f32 v237, s56, v237
    v_mul_f32 v238, s56, v238
    v_mul_f32 v239, s56, v239
    v_cvt_pk_bf16_f32 v30, v236, v237
    v_cvt_pk_bf16_f32 v31, v238, v239
    v_mfma_f32_16x16x32_bf16 v[112:115], a[168:171], v[56:59], v[112:115]
    v_mul_f32 v220, s56, v220
    v_mul_f32 v221, s56, v221
    v_mul_f32 v222, s56, v222
    v_mul_f32 v223, s56, v223
    v_cvt_pk_bf16_f32 v44, v220, v221
    v_cvt_pk_bf16_f32 v45, v222, v223
    v_mfma_f32_16x16x32_bf16 v[120:123], a[168:171], v[72:75], v[120:123]
    v_mul_f32 v240, s56, v240
    v_mul_f32 v241, s56, v241
    v_mul_f32 v242, s56, v242
    v_mul_f32 v243, s56, v243
    v_cvt_pk_bf16_f32 v46, v240, v241
    v_cvt_pk_bf16_f32 v47, v242, v243
    v_mfma_f32_16x16x32_bf16 v[128:131], a[168:171], v[88:91], v[128:131]
    v_mul_f32 v224, s56, v224
    v_mul_f32 v225, s56, v225
    v_mul_f32 v226, s56, v226
    v_mul_f32 v227, s56, v227
    v_cvt_pk_bf16_f32 v60, v224, v225
    v_cvt_pk_bf16_f32 v61, v226, v227
    v_mfma_f32_16x16x32_bf16 v[100:103], a[184:187], v[24:27], v[100:103]
    v_mul_f32 v244, s56, v244
    v_mul_f32 v245, s56, v245
    v_mul_f32 v246, s56, v246
    v_mul_f32 v247, s56, v247
    v_cvt_pk_bf16_f32 v62, v244, v245
    v_cvt_pk_bf16_f32 v63, v246, v247
    v_mfma_f32_16x16x32_bf16 v[108:111], a[184:187], v[40:43], v[108:111]
    v_mul_f32 v228, s56, v228
    v_mul_f32 v229, s56, v229
    v_mul_f32 v230, s56, v230
    v_mul_f32 v231, s56, v231
    v_cvt_pk_bf16_f32 v76, v228, v229
    v_cvt_pk_bf16_f32 v77, v230, v231
    v_mfma_f32_16x16x32_bf16 v[116:119], a[184:187], v[56:59], v[116:119]
    v_mul_f32 v248, s56, v248
    v_mul_f32 v249, s56, v249
    v_mul_f32 v250, s56, v250
    v_mul_f32 v251, s56, v251
    v_cvt_pk_bf16_f32 v78, v248, v249
    v_cvt_pk_bf16_f32 v79, v250, v251
    v_mfma_f32_16x16x32_bf16 v[124:127], a[184:187], v[72:75], v[124:127]
    v_mul_f32 v232, s56, v232
    v_mul_f32 v233, s56, v233
    v_mul_f32 v234, s56, v234
    v_mul_f32 v235, s56, v235
    v_cvt_pk_bf16_f32 v92, v232, v233
    v_cvt_pk_bf16_f32 v93, v234, v235
    v_mfma_f32_16x16x32_bf16 v[132:135], a[184:187], v[88:91], v[132:135]
    v_mul_f32 v252, s56, v252
    v_mul_f32 v253, s56, v253
    v_mul_f32 v254, s56, v254
    v_mul_f32 v255, s56, v255
    v_cvt_pk_bf16_f32 v94, v252, v253
    v_cvt_pk_bf16_f32 v95, v254, v255
    v_mfma_f32_16x16x32_bf16 v[96:99], a[172:175], v[28:31], v[96:99]
    v_mfma_f32_16x16x32_bf16 v[104:107], a[172:175], v[44:47], v[104:107]
    v_mfma_f32_16x16x32_bf16 v[112:115], a[172:175], v[60:63], v[112:115]
    v_mfma_f32_16x16x32_bf16 v[120:123], a[172:175], v[76:79], v[120:123]
    v_mfma_f32_16x16x32_bf16 v[128:131], a[172:175], v[92:95], v[128:131]
    v_mfma_f32_16x16x32_bf16 v[100:103], a[188:191], v[28:31], v[100:103]
    v_mfma_f32_16x16x32_bf16 v[108:111], a[188:191], v[44:47], v[108:111]
    v_mfma_f32_16x16x32_bf16 v[116:119], a[188:191], v[60:63], v[116:119]
    v_mfma_f32_16x16x32_bf16 v[124:127], a[188:191], v[76:79], v[124:127]
    v_mfma_f32_16x16x32_bf16 v[132:135], a[188:191], v[92:95], v[132:135]
    v_mov_b32 v201, 0x3f803f80
    v_mov_b32 v202, 0
    v_accvgpr_write_b32 a240, v201
    v_accvgpr_write_b32 a236, v202
    v_accvgpr_write_b32 a241, v201
    v_accvgpr_write_b32 a237, v202
    v_accvgpr_write_b32 a242, v201
    v_accvgpr_write_b32 a238, v202
    v_accvgpr_write_b32 a243, v201
    v_accvgpr_write_b32 a239, v202
    v_add_u32 v217, 67584, v15
    ds_read_b128 a[160:163], v14 offset:512
    ds_read_b128 a[164:167], v14 offset:576
    ds_read_b128 a[168:171], v14 offset:640
    ds_read_b128 a[172:175], v14 offset:704
    ds_read_b128 a[176:179], v14 offset:768
    ds_read_b128 a[180:183], v14 offset:832
    ds_read_b128 a[184:187], v14 offset:896
    ds_read_b128 a[188:191], v14 offset:960
    v_mov_b32 v196, 0
    v_mov_b32 v197, 0
    v_mov_b32 v198, 0
    v_mov_b32 v199, 0
    v_mov_b32 v200, 0
    s_nop 4
    v_max3_f32 v201, v96, v97, v98
    v_max3_f32 v201, v201, v99, v100
    v_max3_f32 v201, v201, v101, v102
    v_max_f32 v201, v201, v103
    v_max3_f32 v202, v104, v105, v106
    v_max3_f32 v202, v202, v107, v108
    v_max3_f32 v202, v202, v109, v110
    v_max_f32 v202, v202, v111
    v_max3_f32 v203, v112, v113, v114
    v_max3_f32 v203, v203, v115, v116
    v_max3_f32 v203, v203, v117, v118
    v_max_f32 v203, v203, v119
    v_max3_f32 v204, v120, v121, v122
    v_max3_f32 v204, v204, v123, v124
    v_max3_f32 v204, v204, v125, v126
    v_max_f32 v204, v204, v127
    v_max3_f32 v205, v128, v129, v130
    v_max3_f32 v205, v205, v131, v132
    v_max3_f32 v205, v205, v133, v134
    v_max_f32 v205, v205, v135
    v_mov_b32 v206, v201
    v_mov_b32 v207, v202
    v_mov_b32 v208, v203
    v_mov_b32 v209, v204
    v_mov_b32 v210, v205
    s_nop 1
    v_permlane32_swap_b32 v201, v206
    v_permlane32_swap_b32 v202, v207
    v_permlane32_swap_b32 v203, v208
    v_permlane32_swap_b32 v204, v209
    v_permlane32_swap_b32 v205, v210
    s_nop 1
    v_max_f32 v201, v201, v206
    v_max_f32 v202, v202, v207
    v_max_f32 v203, v203, v208
    v_max_f32 v204, v204, v209
    v_max_f32 v205, v205, v210
    v_mov_b32 v206, v201
    v_mov_b32 v207, v202
    v_mov_b32 v208, v203
    v_mov_b32 v209, v204
    v_mov_b32 v210, v205
    s_nop 1
    v_permlane16_swap_b32 v201, v206
    v_permlane16_swap_b32 v202, v207
    v_permlane16_swap_b32 v203, v208
    v_permlane16_swap_b32 v204, v209
    v_permlane16_swap_b32 v205, v210
    s_nop 1
    v_max_f32 v201, v201, v206
    v_max_f32 v202, v202, v207
    v_max_f32 v203, v203, v208
    v_max_f32 v204, v204, v209
    v_max_f32 v205, v205, v210
    v_sub_f32 v176, 0, v201
    v_sub_f32 v177, 0, v201
    v_sub_f32 v178, 0, v201
    v_sub_f32 v179, 0, v201
    v_pk_add_f32 v[96:97], v[96:97], v[176:177]
    v_pk_add_f32 v[98:99], v[98:99], v[176:177]
    v_pk_add_f32 v[100:101], v[100:101], v[176:177]
    v_pk_add_f32 v[102:103], v[102:103], v[176:177]
    v_sub_f32 v180, 0, v202
    v_sub_f32 v181, 0, v202
    v_sub_f32 v182, 0, v202
    v_sub_f32 v183, 0, v202
    v_pk_add_f32 v[104:105], v[104:105], v[180:181]
    v_pk_add_f32 v[106:107], v[106:107], v[180:181]
    v_pk_add_f32 v[108:109], v[108:109], v[180:181]
    v_pk_add_f32 v[110:111], v[110:111], v[180:181]
    v_sub_f32 v184, 0, v203
    v_sub_f32 v185, 0, v203
    v_sub_f32 v186, 0, v203
    v_sub_f32 v187, 0, v203
    v_pk_add_f32 v[112:113], v[112:113], v[184:185]
    v_pk_add_f32 v[114:115], v[114:115], v[184:185]
    v_pk_add_f32 v[116:117], v[116:117], v[184:185]
    v_pk_add_f32 v[118:119], v[118:119], v[184:185]
    v_sub_f32 v188, 0, v204
    v_sub_f32 v189, 0, v204
    v_sub_f32 v190, 0, v204
    v_sub_f32 v191, 0, v204
    v_pk_add_f32 v[120:121], v[120:121], v[188:189]
    v_pk_add_f32 v[122:123], v[122:123], v[188:189]
    v_pk_add_f32 v[124:125], v[124:125], v[188:189]
    v_pk_add_f32 v[126:127], v[126:127], v[188:189]
    v_sub_f32 v192, 0, v205
    v_sub_f32 v193, 0, v205
    v_sub_f32 v194, 0, v205
    v_sub_f32 v195, 0, v205
    v_pk_add_f32 v[128:129], v[128:129], v[192:193]
    v_pk_add_f32 v[130:131], v[130:131], v[192:193]
    v_pk_add_f32 v[132:133], v[132:133], v[192:193]
    v_pk_add_f32 v[134:135], v[134:135], v[192:193]
    v_exp_f32 v96, v96
    v_exp_f32 v97, v97
    s_nop 0
    v_add_f32 v196, v196, v96
    v_exp_f32 v98, v98
    s_nop 0
    v_cvt_pk_bf16_f32 v96, v96, v97
    v_exp_f32 v99, v99
    s_nop 0
    v_add_f32 v196, v196, v97
    v_exp_f32 v104, v104
    s_nop 0
    v_cvt_pk_bf16_f32 v97, v98, v99
    v_add_f32 v196, v196, v98
    v_exp_f32 v105, v105
    s_nop 0
    v_add_f32 v196, v196, v99
    v_exp_f32 v106, v106
    s_nop 0
    v_add_f32 v197, v197, v104
    v_exp_f32 v107, v107
    s_nop 0
    v_cvt_pk_bf16_f32 v104, v104, v105
    v_add_f32 v197, v197, v105
    v_exp_f32 v112, v112
    s_nop 0
    v_cvt_pk_bf16_f32 v105, v106, v107
    v_exp_f32 v113, v113
    s_nop 0
    v_add_f32 v197, v197, v106
    v_exp_f32 v114, v114
    v_exp_f32 v115, v115
    s_nop 0
    v_add_f32 v197, v197, v107
    v_exp_f32 v120, v120
    s_nop 0
    v_add_f32 v198, v198, v112
    v_cvt_pk_bf16_f32 v112, v112, v113
    v_exp_f32 v121, v121
    s_nop 0
    v_add_f32 v198, v198, v113
    v_cvt_pk_bf16_f32 v113, v114, v115
    v_exp_f32 v122, v122
    s_nop 0
    v_add_f32 v198, v198, v114
    v_add_f32 v198, v198, v115
    v_exp_f32 v123, v123
    s_nop 0
    v_add_f32 v199, v199, v120
    v_cvt_pk_bf16_f32 v120, v120, v121
    v_exp_f32 v128, v128
    s_nop 0
    v_add_f32 v199, v199, v121
    v_cvt_pk_bf16_f32 v121, v122, v123
    v_exp_f32 v129, v129
    s_nop 0
    v_cvt_pk_bf16_f32 v128, v128, v129
    v_add_f32 v199, v199, v122
    v_exp_f32 v130, v130
    v_exp_f32 v131, v131
    s_nop 0
    v_cvt_pk_bf16_f32 v129, v130, v131
    v_add_f32 v199, v199, v123
    v_exp_f32 v100, v100
    v_exp_f32 v101, v101
    s_nop 0
    v_cvt_pk_bf16_f32 v98, v100, v101
    v_add_f32 v196, v196, v100
    v_exp_f32 v102, v102
    v_mov_b32 v219, 0
    global_load_dword v218, v219, s[100:101] sc1
    s_mov_b32 s52, 65536
    s_mov_b32 s53, 49152
    s_mov_b32 s54, 4
    s_add_u32 m0, s47, 50688
    s_mov_b32 s46, 49152
    buffer_load_dwordx4 v6, s[24:27], s46 offen offset:0 nt lds
    buffer_load_dwordx4 v7, s[24:27], s46 offen offset:1056 nt lds
    buffer_load_dwordx4 v8, s[24:27], s46 offen offset:2112 nt lds
    buffer_load_dwordx4 v9, s[24:27], s46 offen offset:3168 nt lds
    s_add_u32 m0, s47, 101376
    s_mov_b32 s46, 32768
    buffer_load_dwordx4 v10, s[28:31], s46 offen offset:0 nt lds
    buffer_load_dwordx4 v11, s[28:31], s46 offen offset:1056 nt lds
    buffer_load_dwordx4 v12, s[28:31], s46 offen offset:2112 nt lds
    buffer_load_dwordx4 v13, s[28:31], s46 offen offset:3168 nt lds
    s_waitcnt vmcnt(16) lgkmcnt(0)
    s_barrier
.p2align 6
K1_LOOP:
    v_mfma_f32_16x16x32_bf16 v[136:139], a[160:163], v[16:19], v[176:179]
    s_add_u32 m0, s47, 0
    ds_read_b64_tr_b16 a[192:193], v217 offset:0
    v_add_f32 v196, v196, v101
    v_mfma_f32_16x16x32_bf16 v[144:147], a[160:163], v[32:35], v[180:183]
    buffer_load_dwordx4 v6, s[24:27], s52 offen offset:0 nt lds
    v_mfma_f32_16x16x32_bf16 v[152:155], a[160:163], v[48:51], v[184:187]
    v_exp_f32 v103, v103
    v_mfma_f32_16x16x32_bf16 v[160:163], a[160:163], v[64:67], v[188:191]
    ds_read_b64_tr_b16 a[194:195], v217 offset:512
    v_cvt_pk_bf16_f32 v99, v102, v103
    v_mfma_f32_16x16x32_bf16 v[168:171], a[160:163], v[80:83], v[192:195]
    v_exp_f32 v108, v108
    v_mfma_f32_16x16x32_bf16 v[136:139], a[164:167], v[20:23], v[136:139]
    ds_read_b64_tr_b16 a[196:197], v217 offset:32
    v_add_f32 v196, v196, v102
    v_mfma_f32_16x16x32_bf16 v[144:147], a[164:167], v[36:39], v[144:147]
    v_exp_f32 v109, v109
    v_mfma_f32_16x16x32_bf16 v[152:155], a[164:167], v[52:55], v[152:155]
    ds_read_b64_tr_b16 a[198:199], v217 offset:544
    v_cvt_pk_bf16_f32 v106, v108, v109
    v_mfma_f32_16x16x32_bf16 v[160:163], a[164:167], v[68:71], v[160:163]
    v_exp_f32 v110, v110
    v_mfma_f32_16x16x32_bf16 v[168:171], a[164:167], v[84:87], v[168:171]
    ds_read_b64_tr_b16 a[200:201], v217 offset:64
    v_add_f32 v196, v196, v103
    v_mfma_f32_16x16x32_bf16 v[136:139], a[168:171], v[24:27], v[136:139]
    v_exp_f32 v111, v111
    v_mfma_f32_16x16x32_bf16 v[144:147], a[168:171], v[40:43], v[144:147]
    buffer_load_dwordx4 v7, s[24:27], s52 offen offset:1056 nt lds
    v_mfma_f32_16x16x32_bf16 v[152:155], a[168:171], v[56:59], v[152:155]
    ds_read_b64_tr_b16 a[202:203], v217 offset:576
    v_exp_f32 v116, v116
    v_mfma_f32_16x16x32_bf16 v[160:163], a[168:171], v[72:75], v[160:163]
    ds_read_b64_tr_b16 a[204:205], v217 offset:96
    v_cvt_pk_bf16_f32 v107, v110, v111
    v_mfma_f32_16x16x32_bf16 v[168:171], a[168:171], v[88:91], v[168:171]
    v_exp_f32 v117, v117
    v_mfma_f32_16x16x32_bf16 v[136:139], a[172:175], v[28:31], v[136:139]
    ds_read_b64_tr_b16 a[206:207], v217 offset:608
    v_cvt_pk_bf16_f32 v114, v116, v117
    v_mfma_f32_16x16x32_bf16 v[144:147], a[172:175], v[44:47], v[144:147]
    v_exp_f32 v118, v118
    v_mfma_f32_16x16x32_bf16 v[152:155], a[172:175], v[60:63], v[152:155]
    v_exp_f32 v119, v119
    v_mfma_f32_16x16x32_bf16 v[160:163], a[172:175], v[76:79], v[160:163]
    ds_read_b64_tr_b16 a[208:209], v217 offset:128
    v_cvt_pk_bf16_f32 v115, v118, v119
    v_mfma_f32_16x16x32_bf16 v[168:171], a[172:175], v[92:95], v[168:171]
    v_exp_f32 v124, v124
    v_mfma_f32_16x16x32_bf16 v[140:143], a[176:179], v[16:19], v[176:179]
    ds_read_b64_tr_b16 a[210:211], v217 offset:640
    v_add_f32 v197, v197, v108
    v_mfma_f32_16x16x32_bf16 v[148:151], a[176:179], v[32:35], v[180:183]
    buffer_load_dwordx4 v8, s[24:27], s52 offen offset:2112 nt lds
    v_mfma_f32_16x16x32_bf16 v[156:159], a[176:179], v[48:51], v[184:187]
    ds_read_b64_tr_b16 a[212:213], v217 offset:160
    v_exp_f32 v125, v125
    v_mfma_f32_16x16x32_bf16 v[164:167], a[176:179], v[64:67], v[188:191]
    v_exp_f32 v126, v126
    v_mfma_f32_16x16x32_bf16 v[172:175], a[176:179], v[80:83], v[192:195]
    ds_read_b64_tr_b16 a[214:215], v217 offset:672
    v_cvt_pk_bf16_f32 v122, v124, v125
    v_mfma_f32_16x16x32_bf16 v[140:143], a[180:183], v[20:23], v[140:143]
    v_exp_f32 v127, v127
    v_mfma_f32_16x16x32_bf16 v[148:151], a[180:183], v[36:39], v[148:151]
    ds_read_b64_tr_b16 a[216:217], v217 offset:192
    v_cvt_pk_bf16_f32 v123, v126, v127
    v_mfma_f32_16x16x32_bf16 v[156:159], a[180:183], v[52:55], v[156:159]
    v_exp_f32 v132, v132
    v_mfma_f32_16x16x32_bf16 v[164:167], a[180:183], v[68:71], v[164:167]
    ds_read_b64_tr_b16 a[218:219], v217 offset:704
    v_add_f32 v197, v197, v109
    v_mfma_f32_16x16x32_bf16 v[172:175], a[180:183], v[84:87], v[172:175]
    v_exp_f32 v133, v133
    v_mfma_f32_16x16x32_bf16 v[140:143], a[184:187], v[24:27], v[140:143]
    ds_read_b64_tr_b16 a[220:221], v217 offset:224
    v_cvt_pk_bf16_f32 v130, v132, v133
    v_mfma_f32_16x16x32_bf16 v[148:151], a[184:187], v[40:43], v[148:151]
    buffer_load_dwordx4 v9, s[24:27], s52 offen offset:3168 nt lds
    v_mfma_f32_16x16x32_bf16 v[156:159], a[184:187], v[56:59], v[156:159]
    v_exp_f32 v134, v134
    v_mfma_f32_16x16x32_bf16 v[164:167], a[184:187], v[72:75], v[164:167]
    v_exp_f32 v135, v135
    v_mfma_f32_16x16x32_bf16 v[172:175], a[184:187], v[88:91], v[172:175]
    ds_read_b64_tr_b16 a[222:223], v217 offset:736
    v_cvt_pk_bf16_f32 v131, v134, v135
    v_mfma_f32_16x16x32_bf16 v[140:143], a[188:191], v[28:31], v[140:143]
    v_add_f32 v197, v197, v110
    v_add_f32 v197, v197, v111
    v_mfma_f32_16x16x32_bf16 v[148:151], a[188:191], v[44:47], v[148:151]
    v_add_f32 v198, v198, v116
    v_add_f32 v198, v198, v117
    v_mfma_f32_16x16x32_bf16 v[156:159], a[188:191], v[60:63], v[156:159]
    v_add_f32 v198, v198, v118
    v_add_f32 v198, v198, v119
    v_mfma_f32_16x16x32_bf16 v[164:167], a[188:191], v[76:79], v[164:167]
    s_waitcnt lgkmcnt(0)
    v_add_f32 v199, v199, v124
    v_add_f32 v199, v199, v125
    v_mfma_f32_16x16x32_bf16 v[172:175], a[188:191], v[92:95], v[172:175]
    s_add_u32 s52, s52, 16384
    v_add_f32 v199, v199, v126
    v_add_f32 v199, v199, v127
    v_mfma_f32_16x16x32_bf16 a[0:3], a[192:195], v[96:99], a[0:3]
    v_exp_f32 v136, v136
    v_mfma_f32_16x16x32_bf16 a[4:7], a[192:195], v[104:107], a[4:7]
    v_exp_f32 v137, v137
    v_mfma_f32_16x16x32_bf16 a[8:11], a[192:195], v[112:115], a[8:11]
    ds_read_b128 a[160:163], v14 offset:16896
    v_add_f32 v196, v196, v136
    v_mfma_f32_16x16x32_bf16 a[12:15], a[192:195], v[120:123], a[12:15]
    v_exp_f32 v138, v138
    v_mfma_f32_16x16x32_bf16 a[16:19], a[192:195], v[128:131], a[16:19]
    ds_read_b128 a[164:167], v14 offset:16960
    v_cvt_pk_bf16_f32 v136, v136, v137
    v_mfma_f32_16x16x32_bf16 a[20:23], a[196:199], v[96:99], a[20:23]
    v_exp_f32 v139, v139
    v_mfma_f32_16x16x32_bf16 a[24:27], a[196:199], v[104:107], a[24:27]
    ds_read_b128 a[168:171], v14 offset:17024
    v_add_f32 v196, v196, v137
    v_mfma_f32_16x16x32_bf16 a[28:31], a[196:199], v[112:115], a[28:31]
    v_exp_f32 v144, v144
    v_mfma_f32_16x16x32_bf16 a[32:35], a[196:199], v[120:123], a[32:35]
    v_cvt_pk_bf16_f32 v137, v138, v139
    v_add_f32 v196, v196, v138
    v_mfma_f32_16x16x32_bf16 a[36:39], a[196:199], v[128:131], a[36:39]
    v_exp_f32 v145, v145
    v_mfma_f32_16x16x32_bf16 a[40:43], a[200:203], v[96:99], a[40:43]
    ds_read_b128 a[172:175], v14 offset:17088
    v_add_f32 v196, v196, v139
    v_mfma_f32_16x16x32_bf16 a[44:47], a[200:203], v[104:107], a[44:47]
    v_exp_f32 v146, v146
    v_mfma_f32_16x16x32_bf16 a[48:51], a[200:203], v[112:115], a[48:51]
    ds_read_b128 a[176:179], v14 offset:17152
    v_add_f32 v197, v197, v144
    v_mfma_f32_16x16x32_bf16 a[52:55], a[200:203], v[120:123], a[52:55]
    v_exp_f32 v147, v147
    v_mfma_f32_16x16x32_bf16 a[56:59], a[200:203], v[128:131], a[56:59]
    v_cvt_pk_bf16_f32 v144, v144, v145
    v_add_f32 v197, v197, v145
    v_mfma_f32_16x16x32_bf16 a[60:63], a[204:207], v[96:99], a[60:63]
    v_exp_f32 v152, v152
    v_mfma_f32_16x16x32_bf16 a[64:67], a[204:207], v[104:107], a[64:67]
    ds_read_b128 a[180:183], v14 offset:17216
    v_cvt_pk_bf16_f32 v145, v146, v147
    v_mfma_f32_16x16x32_bf16 a[68:71], a[204:207], v[112:115], a[68:71]
    v_exp_f32 v153, v153
    v_mfma_f32_16x16x32_bf16 a[72:75], a[204:207], v[120:123], a[72:75]
    ds_read_b128 a[184:187], v14 offset:17280
    v_add_f32 v197, v197, v146
    v_mfma_f32_16x16x32_bf16 a[76:79], a[204:207], v[128:131], a[76:79]
    v_exp_f32 v154, v154
    v_mfma_f32_16x16x32_bf16 a[80:83], a[208:211], v[96:99], a[80:83]
    v_exp_f32 v155, v155
    v_mfma_f32_16x16x32_bf16 a[84:87], a[208:211], v[104:107], a[84:87]
    ds_read_b128 a[188:191], v14 offset:17344
    v_add_f32 v197, v197, v147
    v_mfma_f32_16x16x32_bf16 a[88:91], a[208:211], v[112:115], a[88:91]
    v_exp_f32 v160, v160
    v_mfma_f32_16x16x32_bf16 a[92:95], a[208:211], v[120:123], a[92:95]
    v_add_f32 v198, v198, v152
    v_cvt_pk_bf16_f32 v152, v152, v153
    v_mfma_f32_16x16x32_bf16 a[96:99], a[208:211], v[128:131], a[96:99]
    v_exp_f32 v161, v161
    v_mfma_f32_16x16x32_bf16 a[100:103], a[212:215], v[96:99], a[100:103]
    v_add_f32 v198, v198, v153
    v_cvt_pk_bf16_f32 v153, v154, v155
    v_mfma_f32_16x16x32_bf16 a[104:107], a[212:215], v[104:107], a[104:107]
    v_exp_f32 v162, v162
    v_mfma_f32_16x16x32_bf16 a[108:111], a[212:215], v[112:115], a[108:111]
    v_add_f32 v198, v198, v154
    v_add_f32 v198, v198, v155
    v_mfma_f32_16x16x32_bf16 a[112:115], a[212:215], v[120:123], a[112:115]
    v_exp_f32 v163, v163
    v_mfma_f32_16x16x32_bf16 a[116:119], a[212:215], v[128:131], a[116:119]
    v_add_f32 v199, v199, v160
    v_cvt_pk_bf16_f32 v160, v160, v161
    v_mfma_f32_16x16x32_bf16 a[120:123], a[216:219], v[96:99], a[120:123]
    v_exp_f32 v168, v168
    v_mfma_f32_16x16x32_bf16 a[124:127], a[216:219], v[104:107], a[124:127]
    v_add_f32 v199, v199, v161
    v_cvt_pk_bf16_f32 v161, v162, v163
    v_mfma_f32_16x16x32_bf16 a[128:131], a[216:219], v[112:115], a[128:131]
    v_exp_f32 v169, v169
    v_mfma_f32_16x16x32_bf16 a[132:135], a[216:219], v[120:123], a[132:135]
    v_cvt_pk_bf16_f32 v168, v168, v169
    v_add_f32 v199, v199, v162
    v_mfma_f32_16x16x32_bf16 a[136:139], a[216:219], v[128:131], a[136:139]
    v_exp_f32 v170, v170
    v_mfma_f32_16x16x32_bf16 a[140:143], a[220:223], v[96:99], a[140:143]
    v_exp_f32 v171, v171
    v_mfma_f32_16x16x32_bf16 a[144:147], a[220:223], v[104:107], a[144:147]
    v_cvt_pk_bf16_f32 v169, v170, v171
    v_add_f32 v199, v199, v163
    v_mfma_f32_16x16x32_bf16 a[148:151], a[220:223], v[112:115], a[148:151]
    v_exp_f32 v140, v140
    v_mfma_f32_16x16x32_bf16 a[152:155], a[220:223], v[120:123], a[152:155]
    v_exp_f32 v141, v141
    v_mfma_f32_16x16x32_bf16 a[156:159], a[220:223], v[128:131], a[156:159]
    s_waitcnt lgkmcnt(0)
    v_cvt_pk_bf16_f32 v138, v140, v141
    v_add_f32 v196, v196, v140
    v_mfma_f32_16x16x32_bf16 a[236:239], a[240:243], v[128:131], a[236:239]
    v_exp_f32 v142, v142
    v_mfma_f32_16x16x32_bf16 v[96:99], a[160:163], v[16:19], v[176:179]
    s_add_u32 m0, s47, 118272
    ds_read_b64_tr_b16 a[192:193], v217 offset:8448
    v_add_f32 v196, v196, v141
    v_mfma_f32_16x16x32_bf16 v[104:107], a[160:163], v[32:35], v[180:183]
    buffer_load_dwordx4 v10, s[28:31], s53 offen offset:0 nt lds
    v_mfma_f32_16x16x32_bf16 v[112:115], a[160:163], v[48:51], v[184:187]
    v_exp_f32 v143, v143
    v_mfma_f32_16x16x32_bf16 v[120:123], a[160:163], v[64:67], v[188:191]
    ds_read_b64_tr_b16 a[194:195], v217 offset:8960
    v_cvt_pk_bf16_f32 v139, v142, v143
    v_mfma_f32_16x16x32_bf16 v[128:131], a[160:163], v[80:83], v[192:195]
    v_exp_f32 v148, v148
    v_mfma_f32_16x16x32_bf16 v[96:99], a[164:167], v[20:23], v[96:99]
    ds_read_b64_tr_b16 a[196:197], v217 offset:8480
    v_add_f32 v196, v196, v142
    v_mfma_f32_16x16x32_bf16 v[104:107], a[164:167], v[36:39], v[104:107]
    v_exp_f32 v149, v149
    v_mfma_f32_16x16x32_bf16 v[112:115], a[164:167], v[52:55], v[112:115]
    ds_read_b64_tr_b16 a[198:199], v217 offset:8992
    v_cvt_pk_bf16_f32 v146, v148, v149
    v_mfma_f32_16x16x32_bf16 v[120:123], a[164:167], v[68:71], v[120:123]
    v_exp_f32 v150, v150
    v_mfma_f32_16x16x32_bf16 v[128:131], a[164:167], v[84:87], v[128:131]
    ds_read_b64_tr_b16 a[200:201], v217 offset:8512
    v_add_f32 v196, v196, v143
    v_mfma_f32_16x16x32_bf16 v[96:99], a[168:171], v[24:27], v[96:99]
    v_exp_f32 v151, v151
    v_mfma_f32_16x16x32_bf16 v[104:107], a[168:171], v[40:43], v[104:107]
    buffer_load_dwordx4 v11, s[28:31], s53 offen offset:1056 nt lds
    v_mfma_f32_16x16x32_bf16 v[112:115], a[168:171], v[56:59], v[112:115]
    ds_read_b64_tr_b16 a[202:203], v217 offset:9024
    v_exp_f32 v156, v156
    v_mfma_f32_16x16x32_bf16 v[120:123], a[168:171], v[72:75], v[120:123]
    ds_read_b64_tr_b16 a[204:205], v217 offset:8544
    v_cvt_pk_bf16_f32 v147, v150, v151
    v_mfma_f32_16x16x32_bf16 v[128:131], a[168:171], v[88:91], v[128:131]
    v_exp_f32 v157, v157
    v_mfma_f32_16x16x32_bf16 v[96:99], a[172:175], v[28:31], v[96:99]
    ds_read_b64_tr_b16 a[206:207], v217 offset:9056
    v_cvt_pk_bf16_f32 v154, v156, v157
    v_mfma_f32_16x16x32_bf16 v[104:107], a[172:175], v[44:47], v[104:107]
    v_exp_f32 v158, v158
    v_mfma_f32_16x16x32_bf16 v[112:115], a[172:175], v[60:63], v[112:115]
    v_exp_f32 v159, v159
    v_mfma_f32_16x16x32_bf16 v[120:123], a[172:175], v[76:79], v[120:123]
    ds_read_b64_tr_b16 a[208:209], v217 offset:8576
    v_cvt_pk_bf16_f32 v155, v158, v159
    v_mfma_f32_16x16x32_bf16 v[128:131], a[172:175], v[92:95], v[128:131]
    v_exp_f32 v164, v164
    v_mfma_f32_16x16x32_bf16 v[100:103], a[176:179], v[16:19], v[176:179]
    ds_read_b64_tr_b16 a[210:211], v217 offset:9088
    v_add_f32 v197, v197, v148
    v_mfma_f32_16x16x32_bf16 v[108:111], a[176:179], v[32:35], v[180:183]
    buffer_load_dwordx4 v12, s[28:31], s53 offen offset:2112 nt lds
    v_mfma_f32_16x16x32_bf16 v[116:119], a[176:179], v[48:51], v[184:187]
    ds_read_b64_tr_b16 a[212:213], v217 offset:8608
    v_exp_f32 v165, v165
    v_mfma_f32_16x16x32_bf16 v[124:127], a[176:179], v[64:67], v[188:191]
    v_exp_f32 v166, v166
    v_mfma_f32_16x16x32_bf16 v[132:135], a[176:179], v[80:83], v[192:195]
    ds_read_b64_tr_b16 a[214:215], v217 offset:9120
    v_cvt_pk_bf16_f32 v162, v164, v165
    v_mfma_f32_16x16x32_bf16 v[100:103], a[180:183], v[20:23], v[100:103]
    v_exp_f32 v167, v167
    v_mfma_f32_16x16x32_bf16 v[108:111], a[180:183], v[36:39], v[108:111]
    ds_read_b64_tr_b16 a[216:217], v217 offset:8640
    v_cvt_pk_bf16_f32 v163, v166, v167
    v_mfma_f32_16x16x32_bf16 v[116:119], a[180:183], v[52:55], v[116:119]
    v_exp_f32 v172, v172
    v_mfma_f32_16x16x32_bf16 v[124:127], a[180:183], v[68:71], v[124:127]
    ds_read_b64_tr_b16 a[218:219], v217 offset:9152
    v_add_f32 v197, v197, v149
    v_mfma_f32_16x16x32_bf16 v[132:135], a[180:183], v[84:87], v[132:135]
    v_exp_f32 v173, v173
    v_mfma_f32_16x16x32_bf16 v[100:103], a[184:187], v[24:27], v[100:103]
    ds_read_b64_tr_b16 a[220:221], v217 offset:8672
    v_cvt_pk_bf16_f32 v170, v172, v173
    v_mfma_f32_16x16x32_bf16 v[108:111], a[184:187], v[40:43], v[108:111]
    buffer_load_dwordx4 v13, s[28:31], s53 offen offset:3168 nt lds
    v_mfma_f32_16x16x32_bf16 v[116:119], a[184:187], v[56:59], v[116:119]
    v_exp_f32 v174, v174
    v_mfma_f32_16x16x32_bf16 v[124:127], a[184:187], v[72:75], v[124:127]
    v_exp_f32 v175, v175
    v_mfma_f32_16x16x32_bf16 v[132:135], a[184:187], v[88:91], v[132:135]
    ds_read_b64_tr_b16 a[222:223], v217 offset:9184
    v_cvt_pk_bf16_f32 v171, v174, v175
    v_mfma_f32_16x16x32_bf16 v[100:103], a[188:191], v[28:31], v[100:103]
    v_add_f32 v197, v197, v150
    v_add_f32 v197, v197, v151
    v_mfma_f32_16x16x32_bf16 v[108:111], a[188:191], v[44:47], v[108:111]
    v_add_f32 v198, v198, v156
    v_add_f32 v198, v198, v157
    v_mfma_f32_16x16x32_bf16 v[116:119], a[188:191], v[60:63], v[116:119]
    v_add_f32 v198, v198, v158
    v_add_f32 v198, v198, v159
    v_mfma_f32_16x16x32_bf16 v[124:127], a[188:191], v[76:79], v[124:127]
    s_waitcnt lgkmcnt(0)
    v_add_f32 v199, v199, v164
    v_add_f32 v199, v199, v165
    v_mfma_f32_16x16x32_bf16 v[132:135], a[188:191], v[92:95], v[132:135]
    s_add_u32 s53, s53, 16384
    v_add_f32 v199, v199, v166
    v_add_f32 v199, v199, v167
    v_mfma_f32_16x16x32_bf16 a[0:3], a[192:195], v[136:139], a[0:3]
    v_exp_f32 v96, v96
    v_mfma_f32_16x16x32_bf16 a[4:7], a[192:195], v[144:147], a[4:7]
    v_exp_f32 v97, v97
    v_mfma_f32_16x16x32_bf16 a[8:11], a[192:195], v[152:155], a[8:11]
    ds_read_b128 a[160:163], v14 offset:17408
    v_add_f32 v196, v196, v96
    v_mfma_f32_16x16x32_bf16 a[12:15], a[192:195], v[160:163], a[12:15]
    v_exp_f32 v98, v98
    v_mfma_f32_16x16x32_bf16 a[16:19], a[192:195], v[168:171], a[16:19]
    ds_read_b128 a[164:167], v14 offset:17472
    v_cvt_pk_bf16_f32 v96, v96, v97
    v_mfma_f32_16x16x32_bf16 a[20:23], a[196:199], v[136:139], a[20:23]
    v_exp_f32 v99, v99
    v_mfma_f32_16x16x32_bf16 a[24:27], a[196:199], v[144:147], a[24:27]
    ds_read_b128 a[168:171], v14 offset:17536
    v_add_f32 v196, v196, v97
    v_mfma_f32_16x16x32_bf16 a[28:31], a[196:199], v[152:155], a[28:31]
    v_exp_f32 v104, v104
    v_mfma_f32_16x16x32_bf16 a[32:35], a[196:199], v[160:163], a[32:35]
    v_cvt_pk_bf16_f32 v97, v98, v99
    v_add_f32 v196, v196, v98
    v_mfma_f32_16x16x32_bf16 a[36:39], a[196:199], v[168:171], a[36:39]
    v_exp_f32 v105, v105
    v_mfma_f32_16x16x32_bf16 a[40:43], a[200:203], v[136:139], a[40:43]
    ds_read_b128 a[172:175], v14 offset:17600
    v_add_f32 v196, v196, v99
    v_mfma_f32_16x16x32_bf16 a[44:47], a[200:203], v[144:147], a[44:47]
    v_exp_f32 v106, v106
    v_mfma_f32_16x16x32_bf16 a[48:51], a[200:203], v[152:155], a[48:51]
    ds_read_b128 a[176:179], v14 offset:17664
    v_add_f32 v197, v197, v104
    v_mfma_f32_16x16x32_bf16 a[52:55], a[200:203], v[160:163], a[52:55]
    v_exp_f32 v107, v107
    v_mfma_f32_16x16x32_bf16 a[56:59], a[200:203], v[168:171], a[56:59]
    v_cvt_pk_bf16_f32 v104, v104, v105
    v_add_f32 v197, v197, v105
    v_mfma_f32_16x16x32_bf16 a[60:63], a[204:207], v[136:139], a[60:63]
    v_exp_f32 v112, v112
    v_mfma_f32_16x16x32_bf16 a[64:67], a[204:207], v[144:147], a[64:67]
    ds_read_b128 a[180:183], v14 offset:17728
    v_cvt_pk_bf16_f32 v105, v106, v107
    v_mfma_f32_16x16x32_bf16 a[68:71], a[204:207], v[152:155], a[68:71]
    v_exp_f32 v113, v113
    v_mfma_f32_16x16x32_bf16 a[72:75], a[204:207], v[160:163], a[72:75]
    ds_read_b128 a[184:187], v14 offset:17792
    v_add_f32 v197, v197, v106
    v_mfma_f32_16x16x32_bf16 a[76:79], a[204:207], v[168:171], a[76:79]
    v_exp_f32 v114, v114
    v_mfma_f32_16x16x32_bf16 a[80:83], a[208:211], v[136:139], a[80:83]
    v_exp_f32 v115, v115
    v_mfma_f32_16x16x32_bf16 a[84:87], a[208:211], v[144:147], a[84:87]
    ds_read_b128 a[188:191], v14 offset:17856
    v_add_f32 v197, v197, v107
    v_mfma_f32_16x16x32_bf16 a[88:91], a[208:211], v[152:155], a[88:91]
    v_exp_f32 v120, v120
    v_mfma_f32_16x16x32_bf16 a[92:95], a[208:211], v[160:163], a[92:95]
    v_add_f32 v198, v198, v112
    v_cvt_pk_bf16_f32 v112, v112, v113
    v_mfma_f32_16x16x32_bf16 a[96:99], a[208:211], v[168:171], a[96:99]
    v_exp_f32 v121, v121
    v_mfma_f32_16x16x32_bf16 a[100:103], a[212:215], v[136:139], a[100:103]
    v_add_f32 v198, v198, v113
    v_cvt_pk_bf16_f32 v113, v114, v115
    v_mfma_f32_16x16x32_bf16 a[104:107], a[212:215], v[144:147], a[104:107]
    v_exp_f32 v122, v122
    v_mfma_f32_16x16x32_bf16 a[108:111], a[212:215], v[152:155], a[108:111]
    v_add_f32 v198, v198, v114
    v_add_f32 v198, v198, v115
    v_mfma_f32_16x16x32_bf16 a[112:115], a[212:215], v[160:163], a[112:115]
    v_exp_f32 v123, v123
    v_mfma_f32_16x16x32_bf16 a[116:119], a[212:215], v[168:171], a[116:119]
    v_add_f32 v199, v199, v120
    v_cvt_pk_bf16_f32 v120, v120, v121
    v_mfma_f32_16x16x32_bf16 a[120:123], a[216:219], v[136:139], a[120:123]
    v_exp_f32 v128, v128
    v_mfma_f32_16x16x32_bf16 a[124:127], a[216:219], v[144:147], a[124:127]
    v_add_f32 v199, v199, v121
    v_cvt_pk_bf16_f32 v121, v122, v123
    v_mfma_f32_16x16x32_bf16 a[128:131], a[216:219], v[152:155], a[128:131]
    v_exp_f32 v129, v129
    v_mfma_f32_16x16x32_bf16 a[132:135], a[216:219], v[160:163], a[132:135]
    v_cvt_pk_bf16_f32 v128, v128, v129
    v_add_f32 v199, v199, v122
    v_mfma_f32_16x16x32_bf16 a[136:139], a[216:219], v[168:171], a[136:139]
    v_exp_f32 v130, v130
    v_mfma_f32_16x16x32_bf16 a[140:143], a[220:223], v[136:139], a[140:143]
    v_exp_f32 v131, v131
    v_mfma_f32_16x16x32_bf16 a[144:147], a[220:223], v[144:147], a[144:147]
    v_cvt_pk_bf16_f32 v129, v130, v131
    v_add_f32 v199, v199, v123
    v_mfma_f32_16x16x32_bf16 a[148:151], a[220:223], v[152:155], a[148:151]
    v_exp_f32 v100, v100
    v_mfma_f32_16x16x32_bf16 a[152:155], a[220:223], v[160:163], a[152:155]
    v_exp_f32 v101, v101
    v_mfma_f32_16x16x32_bf16 a[156:159], a[220:223], v[168:171], a[156:159]
    s_waitcnt vmcnt(16) lgkmcnt(0)
    v_cvt_pk_bf16_f32 v98, v100, v101
    v_add_f32 v196, v196, v100
    v_mfma_f32_16x16x32_bf16 a[236:239], a[240:243], v[168:171], a[236:239]
    s_barrier
    v_exp_f32 v102, v102
    s_cmp_eq_u32 s54, 1
    s_cbranch_scc1 K1_WARM
K1_WARMRET:
    v_mfma_f32_16x16x32_bf16 v[136:139], a[160:163], v[16:19], v[176:179]
    s_add_u32 m0, s47, 16896
    ds_read_b64_tr_b16 a[192:193], v217 offset:16896
    v_add_f32 v196, v196, v101
    v_mfma_f32_16x16x32_bf16 v[144:147], a[160:163], v[32:35], v[180:183]
    buffer_load_dwordx4 v6, s[24:27], s52 offen offset:0 nt lds
    v_mfma_f32_16x16x32_bf16 v[152:155], a[160:163], v[48:51], v[184:187]
    v_exp_f32 v103, v103
    v_mfma_f32_16x16x32_bf16 v[160:163], a[160:163], v[64:67], v[188:191]
    ds_read_b64_tr_b16 a[194:195], v217 offset:17408
    v_cvt_pk_bf16_f32 v99, v102, v103
    v_mfma_f32_16x16x32_bf16 v[168:171], a[160:163], v[80:83], v[192:195]
    v_exp_f32 v108, v108
    v_mfma_f32_16x16x32_bf16 v[136:139], a[164:167], v[20:23], v[136:139]
    ds_read_b64_tr_b16 a[196:197], v217 offset:16928
    v_add_f32 v196, v196, v102
    v_mfma_f32_16x16x32_bf16 v[144:147], a[164:167], v[36:39], v[144:147]
    v_exp_f32 v109, v109
    v_mfma_f32_16x16x32_bf16 v[152:155], a[164:167], v[52:55], v[152:155]
    ds_read_b64_tr_b16 a[198:199], v217 offset:17440
    v_cvt_pk_bf16_f32 v106, v108, v109
    v_mfma_f32_16x16x32_bf16 v[160:163], a[164:167], v[68:71], v[160:163]
    v_exp_f32 v110, v110
    v_mfma_f32_16x16x32_bf16 v[168:171], a[164:167], v[84:87], v[168:171]
    ds_read_b64_tr_b16 a[200:201], v217 offset:16960
    v_add_f32 v196, v196, v103
    v_mfma_f32_16x16x32_bf16 v[136:139], a[168:171], v[24:27], v[136:139]
    v_exp_f32 v111, v111
    v_mfma_f32_16x16x32_bf16 v[144:147], a[168:171], v[40:43], v[144:147]
    buffer_load_dwordx4 v7, s[24:27], s52 offen offset:1056 nt lds
    v_mfma_f32_16x16x32_bf16 v[152:155], a[168:171], v[56:59], v[152:155]
    ds_read_b64_tr_b16 a[202:203], v217 offset:17472
    v_exp_f32 v116, v116
    v_mfma_f32_16x16x32_bf16 v[160:163], a[168:171], v[72:75], v[160:163]
    ds_read_b64_tr_b16 a[204:205], v217 offset:16992
    v_cvt_pk_bf16_f32 v107, v110, v111
    v_mfma_f32_16x16x32_bf16 v[168:171], a[168:171], v[88:91], v[168:171]
    v_exp_f32 v117, v117
    v_mfma_f32_16x16x32_bf16 v[136:139], a[172:175], v[28:31], v[136:139]
    ds_read_b64_tr_b16 a[206:207], v217 offset:17504
    v_cvt_pk_bf16_f32 v114, v116, v117
    v_mfma_f32_16x16x32_bf16 v[144:147], a[172:175], v[44:47], v[144:147]
    v_exp_f32 v118, v118
    v_mfma_f32_16x16x32_bf16 v[152:155], a[172:175], v[60:63], v[152:155]
    v_exp_f32 v119, v119
    v_mfma_f32_16x16x32_bf16 v[160:163], a[172:175], v[76:79], v[160:163]
    ds_read_b64_tr_b16 a[208:209], v217 offset:17024
    v_cvt_pk_bf16_f32 v115, v118, v119
    v_mfma_f32_16x16x32_bf16 v[168:171], a[172:175], v[92:95], v[168:171]
    v_exp_f32 v124, v124
    v_mfma_f32_16x16x32_bf16 v[140:143], a[176:179], v[16:19], v[176:179]
    ds_read_b64_tr_b16 a[210:211], v217 offset:17536
    v_add_f32 v197, v197, v108
    v_mfma_f32_16x16x32_bf16 v[148:151], a[176:179], v[32:35], v[180:183]
    buffer_load_dwordx4 v8, s[24:27], s52 offen offset:2112 nt lds
    v_mfma_f32_16x16x32_bf16 v[156:159], a[176:179], v[48:51], v[184:187]
    ds_read_b64_tr_b16 a[212:213], v217 offset:17056
    v_exp_f32 v125, v125
    v_mfma_f32_16x16x32_bf16 v[164:167], a[176:179], v[64:67], v[188:191]
    v_exp_f32 v126, v126
    v_mfma_f32_16x16x32_bf16 v[172:175], a[176:179], v[80:83], v[192:195]
    ds_read_b64_tr_b16 a[214:215], v217 offset:17568
    v_cvt_pk_bf16_f32 v122, v124, v125
    v_mfma_f32_16x16x32_bf16 v[140:143], a[180:183], v[20:23], v[140:143]
    v_exp_f32 v127, v127
    v_mfma_f32_16x16x32_bf16 v[148:151], a[180:183], v[36:39], v[148:151]
    ds_read_b64_tr_b16 a[216:217], v217 offset:17088
    v_cvt_pk_bf16_f32 v123, v126, v127
    v_mfma_f32_16x16x32_bf16 v[156:159], a[180:183], v[52:55], v[156:159]
    v_exp_f32 v132, v132
    v_mfma_f32_16x16x32_bf16 v[164:167], a[180:183], v[68:71], v[164:167]
    ds_read_b64_tr_b16 a[218:219], v217 offset:17600
    v_add_f32 v197, v197, v109
    v_mfma_f32_16x16x32_bf16 v[172:175], a[180:183], v[84:87], v[172:175]
    v_exp_f32 v133, v133
    v_mfma_f32_16x16x32_bf16 v[140:143], a[184:187], v[24:27], v[140:143]
    ds_read_b64_tr_b16 a[220:221], v217 offset:17120
    v_cvt_pk_bf16_f32 v130, v132, v133
    v_mfma_f32_16x16x32_bf16 v[148:151], a[184:187], v[40:43], v[148:151]
    buffer_load_dwordx4 v9, s[24:27], s52 offen offset:3168 nt lds
    v_mfma_f32_16x16x32_bf16 v[156:159], a[184:187], v[56:59], v[156:159]
    v_exp_f32 v134, v134
    v_mfma_f32_16x16x32_bf16 v[164:167], a[184:187], v[72:75], v[164:167]
    v_exp_f32 v135, v135
    v_mfma_f32_16x16x32_bf16 v[172:175], a[184:187], v[88:91], v[172:175]
    ds_read_b64_tr_b16 a[222:223], v217 offset:17632
    v_cvt_pk_bf16_f32 v131, v134, v135
    v_mfma_f32_16x16x32_bf16 v[140:143], a[188:191], v[28:31], v[140:143]
    v_add_f32 v197, v197, v110
    v_add_f32 v197, v197, v111
    v_mfma_f32_16x16x32_bf16 v[148:151], a[188:191], v[44:47], v[148:151]
    v_add_f32 v198, v198, v116
    v_add_f32 v198, v198, v117
    v_mfma_f32_16x16x32_bf16 v[156:159], a[188:191], v[60:63], v[156:159]
    v_add_f32 v198, v198, v118
    v_add_f32 v198, v198, v119
    v_mfma_f32_16x16x32_bf16 v[164:167], a[188:191], v[76:79], v[164:167]
    s_waitcnt lgkmcnt(0)
    v_add_f32 v199, v199, v124
    v_add_f32 v199, v199, v125
    v_mfma_f32_16x16x32_bf16 v[172:175], a[188:191], v[92:95], v[172:175]
    s_add_u32 s52, s52, 16384
    v_add_f32 v199, v199, v126
    v_add_f32 v199, v199, v127
    v_mfma_f32_16x16x32_bf16 a[0:3], a[192:195], v[96:99], a[0:3]
    v_exp_f32 v136, v136
    v_mfma_f32_16x16x32_bf16 a[4:7], a[192:195], v[104:107], a[4:7]
    v_exp_f32 v137, v137
    v_mfma_f32_16x16x32_bf16 a[8:11], a[192:195], v[112:115], a[8:11]
    ds_read_b128 a[160:163], v14 offset:33792
    v_add_f32 v196, v196, v136
    v_mfma_f32_16x16x32_bf16 a[12:15], a[192:195], v[120:123], a[12:15]
    v_exp_f32 v138, v138
    v_mfma_f32_16x16x32_bf16 a[16:19], a[192:195], v[128:131], a[16:19]
    ds_read_b128 a[164:167], v14 offset:33856
    v_cvt_pk_bf16_f32 v136, v136, v137
    v_mfma_f32_16x16x32_bf16 a[20:23], a[196:199], v[96:99], a[20:23]
    v_exp_f32 v139, v139
    v_mfma_f32_16x16x32_bf16 a[24:27], a[196:199], v[104:107], a[24:27]
    ds_read_b128 a[168:171], v14 offset:33920
    v_add_f32 v196, v196, v137
    v_mfma_f32_16x16x32_bf16 a[28:31], a[196:199], v[112:115], a[28:31]
    v_exp_f32 v144, v144
    v_mfma_f32_16x16x32_bf16 a[32:35], a[196:199], v[120:123], a[32:35]
    v_cvt_pk_bf16_f32 v137, v138, v139
    v_add_f32 v196, v196, v138
    v_mfma_f32_16x16x32_bf16 a[36:39], a[196:199], v[128:131], a[36:39]
    v_exp_f32 v145, v145
    v_mfma_f32_16x16x32_bf16 a[40:43], a[200:203], v[96:99], a[40:43]
    ds_read_b128 a[172:175], v14 offset:33984
    v_add_f32 v196, v196, v139
    v_mfma_f32_16x16x32_bf16 a[44:47], a[200:203], v[104:107], a[44:47]
    v_exp_f32 v146, v146
    v_mfma_f32_16x16x32_bf16 a[48:51], a[200:203], v[112:115], a[48:51]
    ds_read_b128 a[176:179], v14 offset:34048
    v_add_f32 v197, v197, v144
    v_mfma_f32_16x16x32_bf16 a[52:55], a[200:203], v[120:123], a[52:55]
    v_exp_f32 v147, v147
    v_mfma_f32_16x16x32_bf16 a[56:59], a[200:203], v[128:131], a[56:59]
    v_cvt_pk_bf16_f32 v144, v144, v145
    v_add_f32 v197, v197, v145
    v_mfma_f32_16x16x32_bf16 a[60:63], a[204:207], v[96:99], a[60:63]
    v_exp_f32 v152, v152
    v_mfma_f32_16x16x32_bf16 a[64:67], a[204:207], v[104:107], a[64:67]
    ds_read_b128 a[180:183], v14 offset:34112
    v_cvt_pk_bf16_f32 v145, v146, v147
    v_mfma_f32_16x16x32_bf16 a[68:71], a[204:207], v[112:115], a[68:71]
    v_exp_f32 v153, v153
    v_mfma_f32_16x16x32_bf16 a[72:75], a[204:207], v[120:123], a[72:75]
    ds_read_b128 a[184:187], v14 offset:34176
    v_add_f32 v197, v197, v146
    v_mfma_f32_16x16x32_bf16 a[76:79], a[204:207], v[128:131], a[76:79]
    v_exp_f32 v154, v154
    v_mfma_f32_16x16x32_bf16 a[80:83], a[208:211], v[96:99], a[80:83]
    v_exp_f32 v155, v155
    v_mfma_f32_16x16x32_bf16 a[84:87], a[208:211], v[104:107], a[84:87]
    ds_read_b128 a[188:191], v14 offset:34240
    v_add_f32 v197, v197, v147
    v_mfma_f32_16x16x32_bf16 a[88:91], a[208:211], v[112:115], a[88:91]
    v_exp_f32 v160, v160
    v_mfma_f32_16x16x32_bf16 a[92:95], a[208:211], v[120:123], a[92:95]
    v_add_f32 v198, v198, v152
    v_cvt_pk_bf16_f32 v152, v152, v153
    v_mfma_f32_16x16x32_bf16 a[96:99], a[208:211], v[128:131], a[96:99]
    v_exp_f32 v161, v161
    v_mfma_f32_16x16x32_bf16 a[100:103], a[212:215], v[96:99], a[100:103]
    v_add_f32 v198, v198, v153
    v_cvt_pk_bf16_f32 v153, v154, v155
    v_mfma_f32_16x16x32_bf16 a[104:107], a[212:215], v[104:107], a[104:107]
    v_exp_f32 v162, v162
    v_mfma_f32_16x16x32_bf16 a[108:111], a[212:215], v[112:115], a[108:111]
    v_add_f32 v198, v198, v154
    v_add_f32 v198, v198, v155
    v_mfma_f32_16x16x32_bf16 a[112:115], a[212:215], v[120:123], a[112:115]
    v_exp_f32 v163, v163
    v_mfma_f32_16x16x32_bf16 a[116:119], a[212:215], v[128:131], a[116:119]
    v_add_f32 v199, v199, v160
    v_cvt_pk_bf16_f32 v160, v160, v161
    v_mfma_f32_16x16x32_bf16 a[120:123], a[216:219], v[96:99], a[120:123]
    v_exp_f32 v168, v168
    v_mfma_f32_16x16x32_bf16 a[124:127], a[216:219], v[104:107], a[124:127]
    v_add_f32 v199, v199, v161
    v_cvt_pk_bf16_f32 v161, v162, v163
    v_mfma_f32_16x16x32_bf16 a[128:131], a[216:219], v[112:115], a[128:131]
    v_exp_f32 v169, v169
    v_mfma_f32_16x16x32_bf16 a[132:135], a[216:219], v[120:123], a[132:135]
    v_cvt_pk_bf16_f32 v168, v168, v169
    v_add_f32 v199, v199, v162
    v_mfma_f32_16x16x32_bf16 a[136:139], a[216:219], v[128:131], a[136:139]
    v_exp_f32 v170, v170
    v_mfma_f32_16x16x32_bf16 a[140:143], a[220:223], v[96:99], a[140:143]
    v_exp_f32 v171, v171
    v_mfma_f32_16x16x32_bf16 a[144:147], a[220:223], v[104:107], a[144:147]
    v_cvt_pk_bf16_f32 v169, v170, v171
    v_add_f32 v199, v199, v163
    v_mfma_f32_16x16x32_bf16 a[148:151], a[220:223], v[112:115], a[148:151]
    v_exp_f32 v140, v140
    v_mfma_f32_16x16x32_bf16 a[152:155], a[220:223], v[120:123], a[152:155]
    v_exp_f32 v141, v141
    v_mfma_f32_16x16x32_bf16 a[156:159], a[220:223], v[128:131], a[156:159]
    s_waitcnt lgkmcnt(0)
    v_cvt_pk_bf16_f32 v138, v140, v141
    v_add_f32 v196, v196, v140
    v_mfma_f32_16x16x32_bf16 a[236:239], a[240:243], v[128:131], a[236:239]
    v_exp_f32 v142, v142
    v_mfma_f32_16x16x32_bf16 v[96:99], a[160:163], v[16:19], v[176:179]
    s_add_u32 m0, s47, 67584
    ds_read_b64_tr_b16 a[192:193], v217 offset:25344
    v_add_f32 v196, v196, v141
    v_mfma_f32_16x16x32_bf16 v[104:107], a[160:163], v[32:35], v[180:183]
    buffer_load_dwordx4 v10, s[28:31], s53 offen offset:0 nt lds
    v_mfma_f32_16x16x32_bf16 v[112:115], a[160:163], v[48:51], v[184:187]
    v_exp_f32 v143, v143
    v_mfma_f32_16x16x32_bf16 v[120:123], a[160:163], v[64:67], v[188:191]
    ds_read_b64_tr_b16 a[194:195], v217 offset:25856
    v_cvt_pk_bf16_f32 v139, v142, v143
    v_mfma_f32_16x16x32_bf16 v[128:131], a[160:163], v[80:83], v[192:195]
    v_exp_f32 v148, v148
    v_mfma_f32_16x16x32_bf16 v[96:99], a[164:167], v[20:23], v[96:99]
    ds_read_b64_tr_b16 a[196:197], v217 offset:25376
    v_add_f32 v196, v196, v142
    v_mfma_f32_16x16x32_bf16 v[104:107], a[164:167], v[36:39], v[104:107]
    v_exp_f32 v149, v149
    v_mfma_f32_16x16x32_bf16 v[112:115], a[164:167], v[52:55], v[112:115]
    ds_read_b64_tr_b16 a[198:199], v217 offset:25888
    v_cvt_pk_bf16_f32 v146, v148, v149
    v_mfma_f32_16x16x32_bf16 v[120:123], a[164:167], v[68:71], v[120:123]
    v_exp_f32 v150, v150
    v_mfma_f32_16x16x32_bf16 v[128:131], a[164:167], v[84:87], v[128:131]
    ds_read_b64_tr_b16 a[200:201], v217 offset:25408
    v_add_f32 v196, v196, v143
    v_mfma_f32_16x16x32_bf16 v[96:99], a[168:171], v[24:27], v[96:99]
    v_exp_f32 v151, v151
    v_mfma_f32_16x16x32_bf16 v[104:107], a[168:171], v[40:43], v[104:107]
    buffer_load_dwordx4 v11, s[28:31], s53 offen offset:1056 nt lds
    v_mfma_f32_16x16x32_bf16 v[112:115], a[168:171], v[56:59], v[112:115]
    ds_read_b64_tr_b16 a[202:203], v217 offset:25920
    v_exp_f32 v156, v156
    v_mfma_f32_16x16x32_bf16 v[120:123], a[168:171], v[72:75], v[120:123]
    ds_read_b64_tr_b16 a[204:205], v217 offset:25440
    v_cvt_pk_bf16_f32 v147, v150, v151
    v_mfma_f32_16x16x32_bf16 v[128:131], a[168:171], v[88:91], v[128:131]
    v_exp_f32 v157, v157
    v_mfma_f32_16x16x32_bf16 v[96:99], a[172:175], v[28:31], v[96:99]
    ds_read_b64_tr_b16 a[206:207], v217 offset:25952
    v_cvt_pk_bf16_f32 v154, v156, v157
    v_mfma_f32_16x16x32_bf16 v[104:107], a[172:175], v[44:47], v[104:107]
    v_exp_f32 v158, v158
    v_mfma_f32_16x16x32_bf16 v[112:115], a[172:175], v[60:63], v[112:115]
    v_exp_f32 v159, v159
    v_mfma_f32_16x16x32_bf16 v[120:123], a[172:175], v[76:79], v[120:123]
    ds_read_b64_tr_b16 a[208:209], v217 offset:25472
    v_cvt_pk_bf16_f32 v155, v158, v159
    v_mfma_f32_16x16x32_bf16 v[128:131], a[172:175], v[92:95], v[128:131]
    v_exp_f32 v164, v164
    v_mfma_f32_16x16x32_bf16 v[100:103], a[176:179], v[16:19], v[176:179]
    ds_read_b64_tr_b16 a[210:211], v217 offset:25984
    v_add_f32 v197, v197, v148
    v_mfma_f32_16x16x32_bf16 v[108:111], a[176:179], v[32:35], v[180:183]
    buffer_load_dwordx4 v12, s[28:31], s53 offen offset:2112 nt lds
    v_mfma_f32_16x16x32_bf16 v[116:119], a[176:179], v[48:51], v[184:187]
    ds_read_b64_tr_b16 a[212:213], v217 offset:25504
    v_exp_f32 v165, v165
    v_mfma_f32_16x16x32_bf16 v[124:127], a[176:179], v[64:67], v[188:191]
    v_exp_f32 v166, v166
    v_mfma_f32_16x16x32_bf16 v[132:135], a[176:179], v[80:83], v[192:195]
    ds_read_b64_tr_b16 a[214:215], v217 offset:26016
    v_cvt_pk_bf16_f32 v162, v164, v165
    v_mfma_f32_16x16x32_bf16 v[100:103], a[180:183], v[20:23], v[100:103]
    v_exp_f32 v167, v167
    v_mfma_f32_16x16x32_bf16 v[108:111], a[180:183], v[36:39], v[108:111]
    ds_read_b64_tr_b16 a[216:217], v217 offset:25536
    v_cvt_pk_bf16_f32 v163, v166, v167
    v_mfma_f32_16x16x32_bf16 v[116:119], a[180:183], v[52:55], v[116:119]
    v_exp_f32 v172, v172
    v_mfma_f32_16x16x32_bf16 v[124:127], a[180:183], v[68:71], v[124:127]
    ds_read_b64_tr_b16 a[218:219], v217 offset:26048
    v_add_f32 v197, v197, v149
    v_mfma_f32_16x16x32_bf16 v[132:135], a[180:183], v[84:87], v[132:135]
    v_exp_f32 v173, v173
    v_mfma_f32_16x16x32_bf16 v[100:103], a[184:187], v[24:27], v[100:103]
    ds_read_b64_tr_b16 a[220:221], v217 offset:25568
    v_cvt_pk_bf16_f32 v170, v172, v173
    v_mfma_f32_16x16x32_bf16 v[108:111], a[184:187], v[40:43], v[108:111]
    buffer_load_dwordx4 v13, s[28:31], s53 offen offset:3168 nt lds
    v_mfma_f32_16x16x32_bf16 v[116:119], a[184:187], v[56:59], v[116:119]
    v_exp_f32 v174, v174
    v_mfma_f32_16x16x32_bf16 v[124:127], a[184:187], v[72:75], v[124:127]
    v_exp_f32 v175, v175
    v_mfma_f32_16x16x32_bf16 v[132:135], a[184:187], v[88:91], v[132:135]
    ds_read_b64_tr_b16 a[222:223], v217 offset:26080
    v_cvt_pk_bf16_f32 v171, v174, v175
    v_mfma_f32_16x16x32_bf16 v[100:103], a[188:191], v[28:31], v[100:103]
    v_add_f32 v197, v197, v150
    v_add_f32 v197, v197, v151
    v_mfma_f32_16x16x32_bf16 v[108:111], a[188:191], v[44:47], v[108:111]
    v_add_f32 v198, v198, v156
    v_add_f32 v198, v198, v157
    v_mfma_f32_16x16x32_bf16 v[116:119], a[188:191], v[60:63], v[116:119]
    v_add_f32 v198, v198, v158
    v_add_f32 v198, v198, v159
    v_mfma_f32_16x16x32_bf16 v[124:127], a[188:191], v[76:79], v[124:127]
    s_waitcnt lgkmcnt(0)
    v_add_f32 v199, v199, v164
    v_add_f32 v199, v199, v165
    v_mfma_f32_16x16x32_bf16 v[132:135], a[188:191], v[92:95], v[132:135]
    s_add_u32 s53, s53, 16384
    v_add_f32 v199, v199, v166
    v_add_f32 v199, v199, v167
    v_mfma_f32_16x16x32_bf16 a[0:3], a[192:195], v[136:139], a[0:3]
    v_exp_f32 v96, v96
    v_mfma_f32_16x16x32_bf16 a[4:7], a[192:195], v[144:147], a[4:7]
    v_exp_f32 v97, v97
    v_mfma_f32_16x16x32_bf16 a[8:11], a[192:195], v[152:155], a[8:11]
    ds_read_b128 a[160:163], v14 offset:34304
    v_add_f32 v196, v196, v96
    v_mfma_f32_16x16x32_bf16 a[12:15], a[192:195], v[160:163], a[12:15]
    v_exp_f32 v98, v98
    v_mfma_f32_16x16x32_bf16 a[16:19], a[192:195], v[168:171], a[16:19]
    ds_read_b128 a[164:167], v14 offset:34368
    v_cvt_pk_bf16_f32 v96, v96, v97
    v_mfma_f32_16x16x32_bf16 a[20:23], a[196:199], v[136:139], a[20:23]
    v_exp_f32 v99, v99
    v_mfma_f32_16x16x32_bf16 a[24:27], a[196:199], v[144:147], a[24:27]
    ds_read_b128 a[168:171], v14 offset:34432
    v_add_f32 v196, v196, v97
    v_mfma_f32_16x16x32_bf16 a[28:31], a[196:199], v[152:155], a[28:31]
    v_exp_f32 v104, v104
    v_mfma_f32_16x16x32_bf16 a[32:35], a[196:199], v[160:163], a[32:35]
    v_cvt_pk_bf16_f32 v97, v98, v99
    v_add_f32 v196, v196, v98
    v_mfma_f32_16x16x32_bf16 a[36:39], a[196:199], v[168:171], a[36:39]
    v_exp_f32 v105, v105
    v_mfma_f32_16x16x32_bf16 a[40:43], a[200:203], v[136:139], a[40:43]
    ds_read_b128 a[172:175], v14 offset:34496
    v_add_f32 v196, v196, v99
    v_mfma_f32_16x16x32_bf16 a[44:47], a[200:203], v[144:147], a[44:47]
    v_exp_f32 v106, v106
    v_mfma_f32_16x16x32_bf16 a[48:51], a[200:203], v[152:155], a[48:51]
    ds_read_b128 a[176:179], v14 offset:34560
    v_add_f32 v197, v197, v104
    v_mfma_f32_16x16x32_bf16 a[52:55], a[200:203], v[160:163], a[52:55]
    v_exp_f32 v107, v107
    v_mfma_f32_16x16x32_bf16 a[56:59], a[200:203], v[168:171], a[56:59]
    v_cvt_pk_bf16_f32 v104, v104, v105
    v_add_f32 v197, v197, v105
    v_mfma_f32_16x16x32_bf16 a[60:63], a[204:207], v[136:139], a[60:63]
    v_exp_f32 v112, v112
    v_mfma_f32_16x16x32_bf16 a[64:67], a[204:207], v[144:147], a[64:67]
    ds_read_b128 a[180:183], v14 offset:34624
    v_cvt_pk_bf16_f32 v105, v106, v107
    v_mfma_f32_16x16x32_bf16 a[68:71], a[204:207], v[152:155], a[68:71]
    v_exp_f32 v113, v113
    v_mfma_f32_16x16x32_bf16 a[72:75], a[204:207], v[160:163], a[72:75]
    ds_read_b128 a[184:187], v14 offset:34688
    v_add_f32 v197, v197, v106
    v_mfma_f32_16x16x32_bf16 a[76:79], a[204:207], v[168:171], a[76:79]
    v_exp_f32 v114, v114
    v_mfma_f32_16x16x32_bf16 a[80:83], a[208:211], v[136:139], a[80:83]
    v_exp_f32 v115, v115
    v_mfma_f32_16x16x32_bf16 a[84:87], a[208:211], v[144:147], a[84:87]
    ds_read_b128 a[188:191], v14 offset:34752
    v_add_f32 v197, v197, v107
    v_mfma_f32_16x16x32_bf16 a[88:91], a[208:211], v[152:155], a[88:91]
    v_exp_f32 v120, v120
    v_mfma_f32_16x16x32_bf16 a[92:95], a[208:211], v[160:163], a[92:95]
    v_add_f32 v198, v198, v112
    v_cvt_pk_bf16_f32 v112, v112, v113
    v_mfma_f32_16x16x32_bf16 a[96:99], a[208:211], v[168:171], a[96:99]
    v_exp_f32 v121, v121
    v_mfma_f32_16x16x32_bf16 a[100:103], a[212:215], v[136:139], a[100:103]
    v_add_f32 v198, v198, v113
    v_cvt_pk_bf16_f32 v113, v114, v115
    v_mfma_f32_16x16x32_bf16 a[104:107], a[212:215], v[144:147], a[104:107]
    v_exp_f32 v122, v122
    v_mfma_f32_16x16x32_bf16 a[108:111], a[212:215], v[152:155], a[108:111]
    v_add_f32 v198, v198, v114
    v_add_f32 v198, v198, v115
    v_mfma_f32_16x16x32_bf16 a[112:115], a[212:215], v[160:163], a[112:115]
    v_exp_f32 v123, v123
    v_mfma_f32_16x16x32_bf16 a[116:119], a[212:215], v[168:171], a[116:119]
    v_add_f32 v199, v199, v120
    v_cvt_pk_bf16_f32 v120, v120, v121
    v_mfma_f32_16x16x32_bf16 a[120:123], a[216:219], v[136:139], a[120:123]
    v_exp_f32 v128, v128
    v_mfma_f32_16x16x32_bf16 a[124:127], a[216:219], v[144:147], a[124:127]
    v_add_f32 v199, v199, v121
    v_cvt_pk_bf16_f32 v121, v122, v123
    v_mfma_f32_16x16x32_bf16 a[128:131], a[216:219], v[152:155], a[128:131]
    v_exp_f32 v129, v129
    v_mfma_f32_16x16x32_bf16 a[132:135], a[216:219], v[160:163], a[132:135]
    v_cvt_pk_bf16_f32 v128, v128, v129
    v_add_f32 v199, v199, v122
    v_mfma_f32_16x16x32_bf16 a[136:139], a[216:219], v[168:171], a[136:139]
    v_exp_f32 v130, v130
    v_mfma_f32_16x16x32_bf16 a[140:143], a[220:223], v[136:139], a[140:143]
    v_exp_f32 v131, v131
    v_mfma_f32_16x16x32_bf16 a[144:147], a[220:223], v[144:147], a[144:147]
    v_cvt_pk_bf16_f32 v129, v130, v131
    v_add_f32 v199, v199, v123
    v_mfma_f32_16x16x32_bf16 a[148:151], a[220:223], v[152:155], a[148:151]
    v_exp_f32 v100, v100
    v_mfma_f32_16x16x32_bf16 a[152:155], a[220:223], v[160:163], a[152:155]
    v_exp_f32 v101, v101
    v_mfma_f32_16x16x32_bf16 a[156:159], a[220:223], v[168:171], a[156:159]
    s_waitcnt vmcnt(16) lgkmcnt(0)
    v_cvt_pk_bf16_f32 v98, v100, v101
    v_add_f32 v196, v196, v100
    v_mfma_f32_16x16x32_bf16 a[236:239], a[240:243], v[168:171], a[236:239]
    s_barrier
    v_exp_f32 v102, v102
    v_mfma_f32_16x16x32_bf16 v[136:139], a[160:163], v[16:19], v[176:179]
    s_add_u32 m0, s47, 33792
    ds_read_b64_tr_b16 a[192:193], v217 offset:33792
    v_add_f32 v196, v196, v101
    v_mfma_f32_16x16x32_bf16 v[144:147], a[160:163], v[32:35], v[180:183]
    buffer_load_dwordx4 v6, s[24:27], s52 offen offset:0 nt lds
    v_mfma_f32_16x16x32_bf16 v[152:155], a[160:163], v[48:51], v[184:187]
    v_exp_f32 v103, v103
    v_mfma_f32_16x16x32_bf16 v[160:163], a[160:163], v[64:67], v[188:191]
    ds_read_b64_tr_b16 a[194:195], v217 offset:34304
    v_cvt_pk_bf16_f32 v99, v102, v103
    v_mfma_f32_16x16x32_bf16 v[168:171], a[160:163], v[80:83], v[192:195]
    v_exp_f32 v108, v108
    v_mfma_f32_16x16x32_bf16 v[136:139], a[164:167], v[20:23], v[136:139]
    ds_read_b64_tr_b16 a[196:197], v217 offset:33824
    v_add_f32 v196, v196, v102
    v_mfma_f32_16x16x32_bf16 v[144:147], a[164:167], v[36:39], v[144:147]
    v_exp_f32 v109, v109
    v_mfma_f32_16x16x32_bf16 v[152:155], a[164:167], v[52:55], v[152:155]
    ds_read_b64_tr_b16 a[198:199], v217 offset:34336
    v_cvt_pk_bf16_f32 v106, v108, v109
    v_mfma_f32_16x16x32_bf16 v[160:163], a[164:167], v[68:71], v[160:163]
    v_exp_f32 v110, v110
    v_mfma_f32_16x16x32_bf16 v[168:171], a[164:167], v[84:87], v[168:171]
    ds_read_b64_tr_b16 a[200:201], v217 offset:33856
    v_add_f32 v196, v196, v103
    v_mfma_f32_16x16x32_bf16 v[136:139], a[168:171], v[24:27], v[136:139]
    v_exp_f32 v111, v111
    v_mfma_f32_16x16x32_bf16 v[144:147], a[168:171], v[40:43], v[144:147]
    buffer_load_dwordx4 v7, s[24:27], s52 offen offset:1056 nt lds
    v_mfma_f32_16x16x32_bf16 v[152:155], a[168:171], v[56:59], v[152:155]
    ds_read_b64_tr_b16 a[202:203], v217 offset:34368
    v_exp_f32 v116, v116
    v_mfma_f32_16x16x32_bf16 v[160:163], a[168:171], v[72:75], v[160:163]
    ds_read_b64_tr_b16 a[204:205], v217 offset:33888
    v_cvt_pk_bf16_f32 v107, v110, v111
    v_mfma_f32_16x16x32_bf16 v[168:171], a[168:171], v[88:91], v[168:171]
    v_exp_f32 v117, v117
    v_mfma_f32_16x16x32_bf16 v[136:139], a[172:175], v[28:31], v[136:139]
    ds_read_b64_tr_b16 a[206:207], v217 offset:34400
    v_cvt_pk_bf16_f32 v114, v116, v117
    v_mfma_f32_16x16x32_bf16 v[144:147], a[172:175], v[44:47], v[144:147]
    v_exp_f32 v118, v118
    v_mfma_f32_16x16x32_bf16 v[152:155], a[172:175], v[60:63], v[152:155]
    v_exp_f32 v119, v119
    v_mfma_f32_16x16x32_bf16 v[160:163], a[172:175], v[76:79], v[160:163]
    ds_read_b64_tr_b16 a[208:209], v217 offset:33920
    v_cvt_pk_bf16_f32 v115, v118, v119
    v_mfma_f32_16x16x32_bf16 v[168:171], a[172:175], v[92:95], v[168:171]
    v_exp_f32 v124, v124
    v_mfma_f32_16x16x32_bf16 v[140:143], a[176:179], v[16:19], v[176:179]
    ds_read_b64_tr_b16 a[210:211], v217 offset:34432
    v_add_f32 v197, v197, v108
    v_mfma_f32_16x16x32_bf16 v[148:151], a[176:179], v[32:35], v[180:183]
    buffer_load_dwordx4 v8, s[24:27], s52 offen offset:2112 nt lds
    v_mfma_f32_16x16x32_bf16 v[156:159], a[176:179], v[48:51], v[184:187]
    ds_read_b64_tr_b16 a[212:213], v217 offset:33952
    v_exp_f32 v125, v125
    v_mfma_f32_16x16x32_bf16 v[164:167], a[176:179], v[64:67], v[188:191]
    v_exp_f32 v126, v126
    v_mfma_f32_16x16x32_bf16 v[172:175], a[176:179], v[80:83], v[192:195]
    ds_read_b64_tr_b16 a[214:215], v217 offset:34464
    v_cvt_pk_bf16_f32 v122, v124, v125
    v_mfma_f32_16x16x32_bf16 v[140:143], a[180:183], v[20:23], v[140:143]
    v_exp_f32 v127, v127
    v_mfma_f32_16x16x32_bf16 v[148:151], a[180:183], v[36:39], v[148:151]
    ds_read_b64_tr_b16 a[216:217], v217 offset:33984
    v_cvt_pk_bf16_f32 v123, v126, v127
    v_mfma_f32_16x16x32_bf16 v[156:159], a[180:183], v[52:55], v[156:159]
    v_exp_f32 v132, v132
    v_mfma_f32_16x16x32_bf16 v[164:167], a[180:183], v[68:71], v[164:167]
    ds_read_b64_tr_b16 a[218:219], v217 offset:34496
    v_add_f32 v197, v197, v109
    v_mfma_f32_16x16x32_bf16 v[172:175], a[180:183], v[84:87], v[172:175]
    v_exp_f32 v133, v133
    v_mfma_f32_16x16x32_bf16 v[140:143], a[184:187], v[24:27], v[140:143]
    ds_read_b64_tr_b16 a[220:221], v217 offset:34016
    v_cvt_pk_bf16_f32 v130, v132, v133
    v_mfma_f32_16x16x32_bf16 v[148:151], a[184:187], v[40:43], v[148:151]
    buffer_load_dwordx4 v9, s[24:27], s52 offen offset:3168 nt lds
    v_mfma_f32_16x16x32_bf16 v[156:159], a[184:187], v[56:59], v[156:159]
    v_exp_f32 v134, v134
    v_mfma_f32_16x16x32_bf16 v[164:167], a[184:187], v[72:75], v[164:167]
    v_exp_f32 v135, v135
    v_mfma_f32_16x16x32_bf16 v[172:175], a[184:187], v[88:91], v[172:175]
    ds_read_b64_tr_b16 a[222:223], v217 offset:34528
    v_cvt_pk_bf16_f32 v131, v134, v135
    v_mfma_f32_16x16x32_bf16 v[140:143], a[188:191], v[28:31], v[140:143]
    v_add_f32 v197, v197, v110
    v_add_f32 v197, v197, v111
    v_mfma_f32_16x16x32_bf16 v[148:151], a[188:191], v[44:47], v[148:151]
    v_add_f32 v198, v198, v116
    v_add_f32 v198, v198, v117
    v_mfma_f32_16x16x32_bf16 v[156:159], a[188:191], v[60:63], v[156:159]
    v_add_f32 v198, v198, v118
    v_add_f32 v198, v198, v119
    v_mfma_f32_16x16x32_bf16 v[164:167], a[188:191], v[76:79], v[164:167]
    s_waitcnt lgkmcnt(0)
    v_add_f32 v199, v199, v124
    v_add_f32 v199, v199, v125
    v_mfma_f32_16x16x32_bf16 v[172:175], a[188:191], v[92:95], v[172:175]
    s_add_u32 s52, s52, 16384
    v_add_f32 v199, v199, v126
    v_add_f32 v199, v199, v127
    v_mfma_f32_16x16x32_bf16 a[0:3], a[192:195], v[96:99], a[0:3]
    v_exp_f32 v136, v136
    v_mfma_f32_16x16x32_bf16 a[4:7], a[192:195], v[104:107], a[4:7]
    v_exp_f32 v137, v137
    v_mfma_f32_16x16x32_bf16 a[8:11], a[192:195], v[112:115], a[8:11]
    ds_read_b128 a[160:163], v14 offset:50688
    v_add_f32 v196, v196, v136
    v_mfma_f32_16x16x32_bf16 a[12:15], a[192:195], v[120:123], a[12:15]
    v_exp_f32 v138, v138
    v_mfma_f32_16x16x32_bf16 a[16:19], a[192:195], v[128:131], a[16:19]
    ds_read_b128 a[164:167], v14 offset:50752
    v_cvt_pk_bf16_f32 v136, v136, v137
    v_mfma_f32_16x16x32_bf16 a[20:23], a[196:199], v[96:99], a[20:23]
    v_exp_f32 v139, v139
    v_mfma_f32_16x16x32_bf16 a[24:27], a[196:199], v[104:107], a[24:27]
    ds_read_b128 a[168:171], v14 offset:50816
    v_add_f32 v196, v196, v137
    v_mfma_f32_16x16x32_bf16 a[28:31], a[196:199], v[112:115], a[28:31]
    v_exp_f32 v144, v144
    v_mfma_f32_16x16x32_bf16 a[32:35], a[196:199], v[120:123], a[32:35]
    v_cvt_pk_bf16_f32 v137, v138, v139
    v_add_f32 v196, v196, v138
    v_mfma_f32_16x16x32_bf16 a[36:39], a[196:199], v[128:131], a[36:39]
    v_exp_f32 v145, v145
    v_mfma_f32_16x16x32_bf16 a[40:43], a[200:203], v[96:99], a[40:43]
    ds_read_b128 a[172:175], v14 offset:50880
    v_add_f32 v196, v196, v139
    v_mfma_f32_16x16x32_bf16 a[44:47], a[200:203], v[104:107], a[44:47]
    v_exp_f32 v146, v146
    v_mfma_f32_16x16x32_bf16 a[48:51], a[200:203], v[112:115], a[48:51]
    ds_read_b128 a[176:179], v14 offset:50944
    v_add_f32 v197, v197, v144
    v_mfma_f32_16x16x32_bf16 a[52:55], a[200:203], v[120:123], a[52:55]
    v_exp_f32 v147, v147
    v_mfma_f32_16x16x32_bf16 a[56:59], a[200:203], v[128:131], a[56:59]
    v_cvt_pk_bf16_f32 v144, v144, v145
    v_add_f32 v197, v197, v145
    v_mfma_f32_16x16x32_bf16 a[60:63], a[204:207], v[96:99], a[60:63]
    v_exp_f32 v152, v152
    v_mfma_f32_16x16x32_bf16 a[64:67], a[204:207], v[104:107], a[64:67]
    ds_read_b128 a[180:183], v14 offset:51008
    v_cvt_pk_bf16_f32 v145, v146, v147
    v_mfma_f32_16x16x32_bf16 a[68:71], a[204:207], v[112:115], a[68:71]
    v_exp_f32 v153, v153
    v_mfma_f32_16x16x32_bf16 a[72:75], a[204:207], v[120:123], a[72:75]
    ds_read_b128 a[184:187], v14 offset:51072
    v_add_f32 v197, v197, v146
    v_mfma_f32_16x16x32_bf16 a[76:79], a[204:207], v[128:131], a[76:79]
    v_exp_f32 v154, v154
    v_mfma_f32_16x16x32_bf16 a[80:83], a[208:211], v[96:99], a[80:83]
    v_exp_f32 v155, v155
    v_mfma_f32_16x16x32_bf16 a[84:87], a[208:211], v[104:107], a[84:87]
    ds_read_b128 a[188:191], v14 offset:51136
    v_add_f32 v197, v197, v147
    v_mfma_f32_16x16x32_bf16 a[88:91], a[208:211], v[112:115], a[88:91]
    v_exp_f32 v160, v160
    v_mfma_f32_16x16x32_bf16 a[92:95], a[208:211], v[120:123], a[92:95]
    v_add_f32 v198, v198, v152
    v_cvt_pk_bf16_f32 v152, v152, v153
    v_mfma_f32_16x16x32_bf16 a[96:99], a[208:211], v[128:131], a[96:99]
    v_exp_f32 v161, v161
    v_mfma_f32_16x16x32_bf16 a[100:103], a[212:215], v[96:99], a[100:103]
    v_add_f32 v198, v198, v153
    v_cvt_pk_bf16_f32 v153, v154, v155
    v_mfma_f32_16x16x32_bf16 a[104:107], a[212:215], v[104:107], a[104:107]
    v_exp_f32 v162, v162
    v_mfma_f32_16x16x32_bf16 a[108:111], a[212:215], v[112:115], a[108:111]
    v_add_f32 v198, v198, v154
    v_add_f32 v198, v198, v155
    v_mfma_f32_16x16x32_bf16 a[112:115], a[212:215], v[120:123], a[112:115]
    v_exp_f32 v163, v163
    v_mfma_f32_16x16x32_bf16 a[116:119], a[212:215], v[128:131], a[116:119]
    v_add_f32 v199, v199, v160
    v_cvt_pk_bf16_f32 v160, v160, v161
    v_mfma_f32_16x16x32_bf16 a[120:123], a[216:219], v[96:99], a[120:123]
    v_exp_f32 v168, v168
    v_mfma_f32_16x16x32_bf16 a[124:127], a[216:219], v[104:107], a[124:127]
    v_add_f32 v199, v199, v161
    v_cvt_pk_bf16_f32 v161, v162, v163
    v_mfma_f32_16x16x32_bf16 a[128:131], a[216:219], v[112:115], a[128:131]
    v_exp_f32 v169, v169
    v_mfma_f32_16x16x32_bf16 a[132:135], a[216:219], v[120:123], a[132:135]
    v_cvt_pk_bf16_f32 v168, v168, v169
    v_add_f32 v199, v199, v162
    v_mfma_f32_16x16x32_bf16 a[136:139], a[216:219], v[128:131], a[136:139]
    v_exp_f32 v170, v170
    v_mfma_f32_16x16x32_bf16 a[140:143], a[220:223], v[96:99], a[140:143]
    v_exp_f32 v171, v171
    v_mfma_f32_16x16x32_bf16 a[144:147], a[220:223], v[104:107], a[144:147]
    v_cvt_pk_bf16_f32 v169, v170, v171
    v_add_f32 v199, v199, v163
    v_mfma_f32_16x16x32_bf16 a[148:151], a[220:223], v[112:115], a[148:151]
    v_exp_f32 v140, v140
    v_mfma_f32_16x16x32_bf16 a[152:155], a[220:223], v[120:123], a[152:155]
    v_exp_f32 v141, v141
    v_mfma_f32_16x16x32_bf16 a[156:159], a[220:223], v[128:131], a[156:159]
    s_waitcnt lgkmcnt(0)
    v_cvt_pk_bf16_f32 v138, v140, v141
    v_add_f32 v196, v196, v140
    v_mfma_f32_16x16x32_bf16 a[236:239], a[240:243], v[128:131], a[236:239]
    v_exp_f32 v142, v142
    v_mfma_f32_16x16x32_bf16 v[96:99], a[160:163], v[16:19], v[176:179]
    s_add_u32 m0, s47, 84480
    ds_read_b64_tr_b16 a[192:193], v217 offset:42240
    v_add_f32 v196, v196, v141
    v_mfma_f32_16x16x32_bf16 v[104:107], a[160:163], v[32:35], v[180:183]
    buffer_load_dwordx4 v10, s[28:31], s53 offen offset:0 nt lds
    v_mfma_f32_16x16x32_bf16 v[112:115], a[160:163], v[48:51], v[184:187]
    v_exp_f32 v143, v143
    v_mfma_f32_16x16x32_bf16 v[120:123], a[160:163], v[64:67], v[188:191]
    ds_read_b64_tr_b16 a[194:195], v217 offset:42752
    v_cvt_pk_bf16_f32 v139, v142, v143
    v_mfma_f32_16x16x32_bf16 v[128:131], a[160:163], v[80:83], v[192:195]
    v_exp_f32 v148, v148
    v_mfma_f32_16x16x32_bf16 v[96:99], a[164:167], v[20:23], v[96:99]
    ds_read_b64_tr_b16 a[196:197], v217 offset:42272
    v_add_f32 v196, v196, v142
    v_mfma_f32_16x16x32_bf16 v[104:107], a[164:167], v[36:39], v[104:107]
    v_exp_f32 v149, v149
    v_mfma_f32_16x16x32_bf16 v[112:115], a[164:167], v[52:55], v[112:115]
    ds_read_b64_tr_b16 a[198:199], v217 offset:42784
    v_cvt_pk_bf16_f32 v146, v148, v149
    v_mfma_f32_16x16x32_bf16 v[120:123], a[164:167], v[68:71], v[120:123]
    v_exp_f32 v150, v150
    v_mfma_f32_16x16x32_bf16 v[128:131], a[164:167], v[84:87], v[128:131]
    ds_read_b64_tr_b16 a[200:201], v217 offset:42304
    v_add_f32 v196, v196, v143
    v_mfma_f32_16x16x32_bf16 v[96:99], a[168:171], v[24:27], v[96:99]
    v_exp_f32 v151, v151
    v_mfma_f32_16x16x32_bf16 v[104:107], a[168:171], v[40:43], v[104:107]
    buffer_load_dwordx4 v11, s[28:31], s53 offen offset:1056 nt lds
    v_mfma_f32_16x16x32_bf16 v[112:115], a[168:171], v[56:59], v[112:115]
    ds_read_b64_tr_b16 a[202:203], v217 offset:42816
    v_exp_f32 v156, v156
    v_mfma_f32_16x16x32_bf16 v[120:123], a[168:171], v[72:75], v[120:123]
    ds_read_b64_tr_b16 a[204:205], v217 offset:42336
    v_cvt_pk_bf16_f32 v147, v150, v151
    v_mfma_f32_16x16x32_bf16 v[128:131], a[168:171], v[88:91], v[128:131]
    v_exp_f32 v157, v157
    v_mfma_f32_16x16x32_bf16 v[96:99], a[172:175], v[28:31], v[96:99]
    ds_read_b64_tr_b16 a[206:207], v217 offset:42848
    v_cvt_pk_bf16_f32 v154, v156, v157
    v_mfma_f32_16x16x32_bf16 v[104:107], a[172:175], v[44:47], v[104:107]
    v_exp_f32 v158, v158
    v_mfma_f32_16x16x32_bf16 v[112:115], a[172:175], v[60:63], v[112:115]
    v_exp_f32 v159, v159
    v_mfma_f32_16x16x32_bf16 v[120:123], a[172:175], v[76:79], v[120:123]
    ds_read_b64_tr_b16 a[208:209], v217 offset:42368
    v_cvt_pk_bf16_f32 v155, v158, v159
    v_mfma_f32_16x16x32_bf16 v[128:131], a[172:175], v[92:95], v[128:131]
    v_exp_f32 v164, v164
    v_mfma_f32_16x16x32_bf16 v[100:103], a[176:179], v[16:19], v[176:179]
    ds_read_b64_tr_b16 a[210:211], v217 offset:42880
    v_add_f32 v197, v197, v148
    v_mfma_f32_16x16x32_bf16 v[108:111], a[176:179], v[32:35], v[180:183]
    buffer_load_dwordx4 v12, s[28:31], s53 offen offset:2112 nt lds
    v_mfma_f32_16x16x32_bf16 v[116:119], a[176:179], v[48:51], v[184:187]
    ds_read_b64_tr_b16 a[212:213], v217 offset:42400
    v_exp_f32 v165, v165
    v_mfma_f32_16x16x32_bf16 v[124:127], a[176:179], v[64:67], v[188:191]
    v_exp_f32 v166, v166
    v_mfma_f32_16x16x32_bf16 v[132:135], a[176:179], v[80:83], v[192:195]
    ds_read_b64_tr_b16 a[214:215], v217 offset:42912
    v_cvt_pk_bf16_f32 v162, v164, v165
    v_mfma_f32_16x16x32_bf16 v[100:103], a[180:183], v[20:23], v[100:103]
    v_exp_f32 v167, v167
    v_mfma_f32_16x16x32_bf16 v[108:111], a[180:183], v[36:39], v[108:111]
    ds_read_b64_tr_b16 a[216:217], v217 offset:42432
    v_cvt_pk_bf16_f32 v163, v166, v167
    v_mfma_f32_16x16x32_bf16 v[116:119], a[180:183], v[52:55], v[116:119]
    v_exp_f32 v172, v172
    v_mfma_f32_16x16x32_bf16 v[124:127], a[180:183], v[68:71], v[124:127]
    ds_read_b64_tr_b16 a[218:219], v217 offset:42944
    v_add_f32 v197, v197, v149
    v_mfma_f32_16x16x32_bf16 v[132:135], a[180:183], v[84:87], v[132:135]
    v_exp_f32 v173, v173
    v_mfma_f32_16x16x32_bf16 v[100:103], a[184:187], v[24:27], v[100:103]
    ds_read_b64_tr_b16 a[220:221], v217 offset:42464
    v_cvt_pk_bf16_f32 v170, v172, v173
    v_mfma_f32_16x16x32_bf16 v[108:111], a[184:187], v[40:43], v[108:111]
    buffer_load_dwordx4 v13, s[28:31], s53 offen offset:3168 nt lds
    v_mfma_f32_16x16x32_bf16 v[116:119], a[184:187], v[56:59], v[116:119]
    v_exp_f32 v174, v174
    v_mfma_f32_16x16x32_bf16 v[124:127], a[184:187], v[72:75], v[124:127]
    v_exp_f32 v175, v175
    v_mfma_f32_16x16x32_bf16 v[132:135], a[184:187], v[88:91], v[132:135]
    ds_read_b64_tr_b16 a[222:223], v217 offset:42976
    v_cvt_pk_bf16_f32 v171, v174, v175
    v_mfma_f32_16x16x32_bf16 v[100:103], a[188:191], v[28:31], v[100:103]
    v_add_f32 v197, v197, v150
    v_add_f32 v197, v197, v151
    v_mfma_f32_16x16x32_bf16 v[108:111], a[188:191], v[44:47], v[108:111]
    v_add_f32 v198, v198, v156
    v_add_f32 v198, v198, v157
    v_mfma_f32_16x16x32_bf16 v[116:119], a[188:191], v[60:63], v[116:119]
    v_add_f32 v198, v198, v158
    v_add_f32 v198, v198, v159
    v_mfma_f32_16x16x32_bf16 v[124:127], a[188:191], v[76:79], v[124:127]
    s_waitcnt lgkmcnt(0)
    v_add_f32 v199, v199, v164
    v_add_f32 v199, v199, v165
    v_mfma_f32_16x16x32_bf16 v[132:135], a[188:191], v[92:95], v[132:135]
    s_add_u32 s53, s53, 16384
    v_add_f32 v199, v199, v166
    v_add_f32 v199, v199, v167
    v_mfma_f32_16x16x32_bf16 a[0:3], a[192:195], v[136:139], a[0:3]
    v_exp_f32 v96, v96
    v_mfma_f32_16x16x32_bf16 a[4:7], a[192:195], v[144:147], a[4:7]
    v_exp_f32 v97, v97
    v_mfma_f32_16x16x32_bf16 a[8:11], a[192:195], v[152:155], a[8:11]
    ds_read_b128 a[160:163], v14 offset:51200
    v_add_f32 v196, v196, v96
    v_mfma_f32_16x16x32_bf16 a[12:15], a[192:195], v[160:163], a[12:15]
    v_exp_f32 v98, v98
    v_mfma_f32_16x16x32_bf16 a[16:19], a[192:195], v[168:171], a[16:19]
    ds_read_b128 a[164:167], v14 offset:51264
    v_cvt_pk_bf16_f32 v96, v96, v97
    v_mfma_f32_16x16x32_bf16 a[20:23], a[196:199], v[136:139], a[20:23]
    v_exp_f32 v99, v99
    v_mfma_f32_16x16x32_bf16 a[24:27], a[196:199], v[144:147], a[24:27]
    ds_read_b128 a[168:171], v14 offset:51328
    v_add_f32 v196, v196, v97
    v_mfma_f32_16x16x32_bf16 a[28:31], a[196:199], v[152:155], a[28:31]
    v_exp_f32 v104, v104
    v_mfma_f32_16x16x32_bf16 a[32:35], a[196:199], v[160:163], a[32:35]
    v_cvt_pk_bf16_f32 v97, v98, v99
    v_add_f32 v196, v196, v98
    v_mfma_f32_16x16x32_bf16 a[36:39], a[196:199], v[168:171], a[36:39]
    v_exp_f32 v105, v105
    v_mfma_f32_16x16x32_bf16 a[40:43], a[200:203], v[136:139], a[40:43]
    ds_read_b128 a[172:175], v14 offset:51392
    v_add_f32 v196, v196, v99
    v_mfma_f32_16x16x32_bf16 a[44:47], a[200:203], v[144:147], a[44:47]
    v_exp_f32 v106, v106
    v_mfma_f32_16x16x32_bf16 a[48:51], a[200:203], v[152:155], a[48:51]
    ds_read_b128 a[176:179], v14 offset:51456
    v_add_f32 v197, v197, v104
    v_mfma_f32_16x16x32_bf16 a[52:55], a[200:203], v[160:163], a[52:55]
    v_exp_f32 v107, v107
    v_mfma_f32_16x16x32_bf16 a[56:59], a[200:203], v[168:171], a[56:59]
    v_cvt_pk_bf16_f32 v104, v104, v105
    v_add_f32 v197, v197, v105
    v_mfma_f32_16x16x32_bf16 a[60:63], a[204:207], v[136:139], a[60:63]
    v_exp_f32 v112, v112
    v_mfma_f32_16x16x32_bf16 a[64:67], a[204:207], v[144:147], a[64:67]
    ds_read_b128 a[180:183], v14 offset:51520
    v_cvt_pk_bf16_f32 v105, v106, v107
    v_mfma_f32_16x16x32_bf16 a[68:71], a[204:207], v[152:155], a[68:71]
    v_exp_f32 v113, v113
    v_mfma_f32_16x16x32_bf16 a[72:75], a[204:207], v[160:163], a[72:75]
    ds_read_b128 a[184:187], v14 offset:51584
    v_add_f32 v197, v197, v106
    v_mfma_f32_16x16x32_bf16 a[76:79], a[204:207], v[168:171], a[76:79]
    v_exp_f32 v114, v114
    v_mfma_f32_16x16x32_bf16 a[80:83], a[208:211], v[136:139], a[80:83]
    v_exp_f32 v115, v115
    v_mfma_f32_16x16x32_bf16 a[84:87], a[208:211], v[144:147], a[84:87]
    ds_read_b128 a[188:191], v14 offset:51648
    v_add_f32 v197, v197, v107
    v_mfma_f32_16x16x32_bf16 a[88:91], a[208:211], v[152:155], a[88:91]
    v_exp_f32 v120, v120
    v_mfma_f32_16x16x32_bf16 a[92:95], a[208:211], v[160:163], a[92:95]
    v_add_f32 v198, v198, v112
    v_cvt_pk_bf16_f32 v112, v112, v113
    v_mfma_f32_16x16x32_bf16 a[96:99], a[208:211], v[168:171], a[96:99]
    v_exp_f32 v121, v121
    v_mfma_f32_16x16x32_bf16 a[100:103], a[212:215], v[136:139], a[100:103]
    v_add_f32 v198, v198, v113
    v_cvt_pk_bf16_f32 v113, v114, v115
    v_mfma_f32_16x16x32_bf16 a[104:107], a[212:215], v[144:147], a[104:107]
    v_exp_f32 v122, v122
    v_mfma_f32_16x16x32_bf16 a[108:111], a[212:215], v[152:155], a[108:111]
    v_add_f32 v198, v198, v114
    v_add_f32 v198, v198, v115
    v_mfma_f32_16x16x32_bf16 a[112:115], a[212:215], v[160:163], a[112:115]
    v_exp_f32 v123, v123
    v_mfma_f32_16x16x32_bf16 a[116:119], a[212:215], v[168:171], a[116:119]
    v_add_f32 v199, v199, v120
    v_cvt_pk_bf16_f32 v120, v120, v121
    v_mfma_f32_16x16x32_bf16 a[120:123], a[216:219], v[136:139], a[120:123]
    v_exp_f32 v128, v128
    v_mfma_f32_16x16x32_bf16 a[124:127], a[216:219], v[144:147], a[124:127]
    v_add_f32 v199, v199, v121
    v_cvt_pk_bf16_f32 v121, v122, v123
    v_mfma_f32_16x16x32_bf16 a[128:131], a[216:219], v[152:155], a[128:131]
    v_exp_f32 v129, v129
    v_mfma_f32_16x16x32_bf16 a[132:135], a[216:219], v[160:163], a[132:135]
    v_cvt_pk_bf16_f32 v128, v128, v129
    v_add_f32 v199, v199, v122
    v_mfma_f32_16x16x32_bf16 a[136:139], a[216:219], v[168:171], a[136:139]
    v_exp_f32 v130, v130
    v_mfma_f32_16x16x32_bf16 a[140:143], a[220:223], v[136:139], a[140:143]
    v_exp_f32 v131, v131
    v_mfma_f32_16x16x32_bf16 a[144:147], a[220:223], v[144:147], a[144:147]
    v_cvt_pk_bf16_f32 v129, v130, v131
    v_add_f32 v199, v199, v123
    v_mfma_f32_16x16x32_bf16 a[148:151], a[220:223], v[152:155], a[148:151]
    v_exp_f32 v100, v100
    v_mfma_f32_16x16x32_bf16 a[152:155], a[220:223], v[160:163], a[152:155]
    v_exp_f32 v101, v101
    v_mfma_f32_16x16x32_bf16 a[156:159], a[220:223], v[168:171], a[156:159]
    s_waitcnt vmcnt(16) lgkmcnt(0)
    v_cvt_pk_bf16_f32 v98, v100, v101
    v_add_f32 v196, v196, v100
    v_mfma_f32_16x16x32_bf16 a[236:239], a[240:243], v[168:171], a[236:239]
    s_barrier
    v_exp_f32 v102, v102
    v_mfma_f32_16x16x32_bf16 v[136:139], a[160:163], v[16:19], v[176:179]
    s_add_u32 m0, s47, 50688
    ds_read_b64_tr_b16 a[192:193], v217 offset:50688
    v_add_f32 v196, v196, v101
    v_mfma_f32_16x16x32_bf16 v[144:147], a[160:163], v[32:35], v[180:183]
    buffer_load_dwordx4 v6, s[24:27], s52 offen offset:0 nt lds
    v_mfma_f32_16x16x32_bf16 v[152:155], a[160:163], v[48:51], v[184:187]
    v_exp_f32 v103, v103
    v_mfma_f32_16x16x32_bf16 v[160:163], a[160:163], v[64:67], v[188:191]
    ds_read_b64_tr_b16 a[194:195], v217 offset:51200
    v_cvt_pk_bf16_f32 v99, v102, v103
    v_mfma_f32_16x16x32_bf16 v[168:171], a[160:163], v[80:83], v[192:195]
    v_exp_f32 v108, v108
    v_mfma_f32_16x16x32_bf16 v[136:139], a[164:167], v[20:23], v[136:139]
    ds_read_b64_tr_b16 a[196:197], v217 offset:50720
    v_add_f32 v196, v196, v102
    v_mfma_f32_16x16x32_bf16 v[144:147], a[164:167], v[36:39], v[144:147]
    v_exp_f32 v109, v109
    v_mfma_f32_16x16x32_bf16 v[152:155], a[164:167], v[52:55], v[152:155]
    ds_read_b64_tr_b16 a[198:199], v217 offset:51232
    v_cvt_pk_bf16_f32 v106, v108, v109
    v_mfma_f32_16x16x32_bf16 v[160:163], a[164:167], v[68:71], v[160:163]
    v_exp_f32 v110, v110
    v_mfma_f32_16x16x32_bf16 v[168:171], a[164:167], v[84:87], v[168:171]
    ds_read_b64_tr_b16 a[200:201], v217 offset:50752
    v_add_f32 v196, v196, v103
    v_mfma_f32_16x16x32_bf16 v[136:139], a[168:171], v[24:27], v[136:139]
    v_exp_f32 v111, v111
    v_mfma_f32_16x16x32_bf16 v[144:147], a[168:171], v[40:43], v[144:147]
    buffer_load_dwordx4 v7, s[24:27], s52 offen offset:1056 nt lds
    v_mfma_f32_16x16x32_bf16 v[152:155], a[168:171], v[56:59], v[152:155]
    ds_read_b64_tr_b16 a[202:203], v217 offset:51264
    v_exp_f32 v116, v116
    v_mfma_f32_16x16x32_bf16 v[160:163], a[168:171], v[72:75], v[160:163]
    ds_read_b64_tr_b16 a[204:205], v217 offset:50784
    v_cvt_pk_bf16_f32 v107, v110, v111
    v_mfma_f32_16x16x32_bf16 v[168:171], a[168:171], v[88:91], v[168:171]
    v_exp_f32 v117, v117
    v_mfma_f32_16x16x32_bf16 v[136:139], a[172:175], v[28:31], v[136:139]
    ds_read_b64_tr_b16 a[206:207], v217 offset:51296
    v_cvt_pk_bf16_f32 v114, v116, v117
    v_mfma_f32_16x16x32_bf16 v[144:147], a[172:175], v[44:47], v[144:147]
    v_exp_f32 v118, v118
    v_mfma_f32_16x16x32_bf16 v[152:155], a[172:175], v[60:63], v[152:155]
    v_exp_f32 v119, v119
    v_mfma_f32_16x16x32_bf16 v[160:163], a[172:175], v[76:79], v[160:163]
    ds_read_b64_tr_b16 a[208:209], v217 offset:50816
    v_cvt_pk_bf16_f32 v115, v118, v119
    v_mfma_f32_16x16x32_bf16 v[168:171], a[172:175], v[92:95], v[168:171]
    v_exp_f32 v124, v124
    v_mfma_f32_16x16x32_bf16 v[140:143], a[176:179], v[16:19], v[176:179]
    ds_read_b64_tr_b16 a[210:211], v217 offset:51328
    v_add_f32 v197, v197, v108
    v_mfma_f32_16x16x32_bf16 v[148:151], a[176:179], v[32:35], v[180:183]
    buffer_load_dwordx4 v8, s[24:27], s52 offen offset:2112 nt lds
    v_mfma_f32_16x16x32_bf16 v[156:159], a[176:179], v[48:51], v[184:187]
    ds_read_b64_tr_b16 a[212:213], v217 offset:50848
    v_exp_f32 v125, v125
    v_mfma_f32_16x16x32_bf16 v[164:167], a[176:179], v[64:67], v[188:191]
    v_exp_f32 v126, v126
    v_mfma_f32_16x16x32_bf16 v[172:175], a[176:179], v[80:83], v[192:195]
    ds_read_b64_tr_b16 a[214:215], v217 offset:51360
    v_cvt_pk_bf16_f32 v122, v124, v125
    v_mfma_f32_16x16x32_bf16 v[140:143], a[180:183], v[20:23], v[140:143]
    v_exp_f32 v127, v127
    v_mfma_f32_16x16x32_bf16 v[148:151], a[180:183], v[36:39], v[148:151]
    ds_read_b64_tr_b16 a[216:217], v217 offset:50880
    v_cvt_pk_bf16_f32 v123, v126, v127
    v_mfma_f32_16x16x32_bf16 v[156:159], a[180:183], v[52:55], v[156:159]
    v_exp_f32 v132, v132
    v_mfma_f32_16x16x32_bf16 v[164:167], a[180:183], v[68:71], v[164:167]
    ds_read_b64_tr_b16 a[218:219], v217 offset:51392
    v_add_f32 v197, v197, v109
    v_mfma_f32_16x16x32_bf16 v[172:175], a[180:183], v[84:87], v[172:175]
    v_exp_f32 v133, v133
    v_mfma_f32_16x16x32_bf16 v[140:143], a[184:187], v[24:27], v[140:143]
    ds_read_b64_tr_b16 a[220:221], v217 offset:50912
    v_cvt_pk_bf16_f32 v130, v132, v133
    v_mfma_f32_16x16x32_bf16 v[148:151], a[184:187], v[40:43], v[148:151]
    buffer_load_dwordx4 v9, s[24:27], s52 offen offset:3168 nt lds
    v_mfma_f32_16x16x32_bf16 v[156:159], a[184:187], v[56:59], v[156:159]
    v_exp_f32 v134, v134
    v_mfma_f32_16x16x32_bf16 v[164:167], a[184:187], v[72:75], v[164:167]
    v_exp_f32 v135, v135
    v_mfma_f32_16x16x32_bf16 v[172:175], a[184:187], v[88:91], v[172:175]
    ds_read_b64_tr_b16 a[222:223], v217 offset:51424
    v_cvt_pk_bf16_f32 v131, v134, v135
    v_mfma_f32_16x16x32_bf16 v[140:143], a[188:191], v[28:31], v[140:143]
    v_add_f32 v197, v197, v110
    v_add_f32 v197, v197, v111
    v_mfma_f32_16x16x32_bf16 v[148:151], a[188:191], v[44:47], v[148:151]
    v_add_f32 v198, v198, v116
    v_add_f32 v198, v198, v117
    v_mfma_f32_16x16x32_bf16 v[156:159], a[188:191], v[60:63], v[156:159]
    v_add_f32 v198, v198, v118
    v_add_f32 v198, v198, v119
    v_mfma_f32_16x16x32_bf16 v[164:167], a[188:191], v[76:79], v[164:167]
    s_waitcnt lgkmcnt(0)
    v_add_f32 v199, v199, v124
    v_add_f32 v199, v199, v125
    v_mfma_f32_16x16x32_bf16 v[172:175], a[188:191], v[92:95], v[172:175]
    s_add_u32 s52, s52, 16384
    v_add_f32 v199, v199, v126
    v_add_f32 v199, v199, v127
    v_mfma_f32_16x16x32_bf16 a[0:3], a[192:195], v[96:99], a[0:3]
    v_exp_f32 v136, v136
    v_mfma_f32_16x16x32_bf16 a[4:7], a[192:195], v[104:107], a[4:7]
    v_exp_f32 v137, v137
    v_mfma_f32_16x16x32_bf16 a[8:11], a[192:195], v[112:115], a[8:11]
    ds_read_b128 a[160:163], v14 offset:0
    v_add_f32 v196, v196, v136
    v_mfma_f32_16x16x32_bf16 a[12:15], a[192:195], v[120:123], a[12:15]
    v_exp_f32 v138, v138
    v_mfma_f32_16x16x32_bf16 a[16:19], a[192:195], v[128:131], a[16:19]
    ds_read_b128 a[164:167], v14 offset:64
    v_cvt_pk_bf16_f32 v136, v136, v137
    v_mfma_f32_16x16x32_bf16 a[20:23], a[196:199], v[96:99], a[20:23]
    v_exp_f32 v139, v139
    v_mfma_f32_16x16x32_bf16 a[24:27], a[196:199], v[104:107], a[24:27]
    ds_read_b128 a[168:171], v14 offset:128
    v_add_f32 v196, v196, v137
    v_mfma_f32_16x16x32_bf16 a[28:31], a[196:199], v[112:115], a[28:31]
    v_exp_f32 v144, v144
    v_mfma_f32_16x16x32_bf16 a[32:35], a[196:199], v[120:123], a[32:35]
    v_cvt_pk_bf16_f32 v137, v138, v139
    v_add_f32 v196, v196, v138
    v_mfma_f32_16x16x32_bf16 a[36:39], a[196:199], v[128:131], a[36:39]
    v_exp_f32 v145, v145
    v_mfma_f32_16x16x32_bf16 a[40:43], a[200:203], v[96:99], a[40:43]
    ds_read_b128 a[172:175], v14 offset:192
    v_add_f32 v196, v196, v139
    v_mfma_f32_16x16x32_bf16 a[44:47], a[200:203], v[104:107], a[44:47]
    v_exp_f32 v146, v146
    v_mfma_f32_16x16x32_bf16 a[48:51], a[200:203], v[112:115], a[48:51]
    ds_read_b128 a[176:179], v14 offset:256
    v_add_f32 v197, v197, v144
    v_mfma_f32_16x16x32_bf16 a[52:55], a[200:203], v[120:123], a[52:55]
    v_exp_f32 v147, v147
    v_mfma_f32_16x16x32_bf16 a[56:59], a[200:203], v[128:131], a[56:59]
    v_cvt_pk_bf16_f32 v144, v144, v145
    v_add_f32 v197, v197, v145
    v_mfma_f32_16x16x32_bf16 a[60:63], a[204:207], v[96:99], a[60:63]
    v_exp_f32 v152, v152
    v_mfma_f32_16x16x32_bf16 a[64:67], a[204:207], v[104:107], a[64:67]
    ds_read_b128 a[180:183], v14 offset:320
    v_cvt_pk_bf16_f32 v145, v146, v147
    v_mfma_f32_16x16x32_bf16 a[68:71], a[204:207], v[112:115], a[68:71]
    v_exp_f32 v153, v153
    v_mfma_f32_16x16x32_bf16 a[72:75], a[204:207], v[120:123], a[72:75]
    ds_read_b128 a[184:187], v14 offset:384
    v_add_f32 v197, v197, v146
    v_mfma_f32_16x16x32_bf16 a[76:79], a[204:207], v[128:131], a[76:79]
    v_exp_f32 v154, v154
    v_mfma_f32_16x16x32_bf16 a[80:83], a[208:211], v[96:99], a[80:83]
    v_exp_f32 v155, v155
    v_mfma_f32_16x16x32_bf16 a[84:87], a[208:211], v[104:107], a[84:87]
    ds_read_b128 a[188:191], v14 offset:448
    v_add_f32 v197, v197, v147
    v_mfma_f32_16x16x32_bf16 a[88:91], a[208:211], v[112:115], a[88:91]
    v_exp_f32 v160, v160
    v_mfma_f32_16x16x32_bf16 a[92:95], a[208:211], v[120:123], a[92:95]
    v_add_f32 v198, v198, v152
    v_cvt_pk_bf16_f32 v152, v152, v153
    v_mfma_f32_16x16x32_bf16 a[96:99], a[208:211], v[128:131], a[96:99]
    v_exp_f32 v161, v161
    v_mfma_f32_16x16x32_bf16 a[100:103], a[212:215], v[96:99], a[100:103]
    v_add_f32 v198, v198, v153
    v_cvt_pk_bf16_f32 v153, v154, v155
    v_mfma_f32_16x16x32_bf16 a[104:107], a[212:215], v[104:107], a[104:107]
    v_exp_f32 v162, v162
    v_mfma_f32_16x16x32_bf16 a[108:111], a[212:215], v[112:115], a[108:111]
    v_add_f32 v198, v198, v154
    v_add_f32 v198, v198, v155
    v_mfma_f32_16x16x32_bf16 a[112:115], a[212:215], v[120:123], a[112:115]
    v_exp_f32 v163, v163
    v_mfma_f32_16x16x32_bf16 a[116:119], a[212:215], v[128:131], a[116:119]
    v_add_f32 v199, v199, v160
    v_cvt_pk_bf16_f32 v160, v160, v161
    v_mfma_f32_16x16x32_bf16 a[120:123], a[216:219], v[96:99], a[120:123]
    s_cmp_eq_u32 s54, 1
    v_exp_f32 v168, v168
    v_mfma_f32_16x16x32_bf16 a[124:127], a[216:219], v[104:107], a[124:127]
    v_add_f32 v199, v199, v161
    v_cvt_pk_bf16_f32 v161, v162, v163
    v_mfma_f32_16x16x32_bf16 a[128:131], a[216:219], v[112:115], a[128:131]
    v_exp_f32 v169, v169
    v_mfma_f32_16x16x32_bf16 a[132:135], a[216:219], v[120:123], a[132:135]
    v_cvt_pk_bf16_f32 v168, v168, v169
    v_add_f32 v199, v199, v162
    v_mfma_f32_16x16x32_bf16 a[136:139], a[216:219], v[128:131], a[136:139]
    v_exp_f32 v170, v170
    v_mfma_f32_16x16x32_bf16 a[140:143], a[220:223], v[96:99], a[140:143]
    v_exp_f32 v171, v171
    v_mfma_f32_16x16x32_bf16 a[144:147], a[220:223], v[104:107], a[144:147]
    v_cvt_pk_bf16_f32 v169, v170, v171
    v_add_f32 v199, v199, v163
    v_mfma_f32_16x16x32_bf16 a[148:151], a[220:223], v[112:115], a[148:151]
    v_exp_f32 v140, v140
    v_mfma_f32_16x16x32_bf16 a[152:155], a[220:223], v[120:123], a[152:155]
    v_exp_f32 v141, v141
    v_mfma_f32_16x16x32_bf16 a[156:159], a[220:223], v[128:131], a[156:159]
    s_waitcnt lgkmcnt(0)
    v_cvt_pk_bf16_f32 v138, v140, v141
    v_add_f32 v196, v196, v140
    v_mfma_f32_16x16x32_bf16 a[236:239], a[240:243], v[128:131], a[236:239]
    v_exp_f32 v142, v142
    s_cbranch_scc1 K1_TAIL
    v_mfma_f32_16x16x32_bf16 v[96:99], a[160:163], v[16:19], v[176:179]
    s_add_u32 m0, s47, 101376
    ds_read_b64_tr_b16 a[192:193], v217 offset:59136
    v_add_f32 v196, v196, v141
    v_mfma_f32_16x16x32_bf16 v[104:107], a[160:163], v[32:35], v[180:183]
    buffer_load_dwordx4 v10, s[28:31], s53 offen offset:0 nt lds
    v_mfma_f32_16x16x32_bf16 v[112:115], a[160:163], v[48:51], v[184:187]
    v_exp_f32 v143, v143
    v_mfma_f32_16x16x32_bf16 v[120:123], a[160:163], v[64:67], v[188:191]
    ds_read_b64_tr_b16 a[194:195], v217 offset:59648
    v_cvt_pk_bf16_f32 v139, v142, v143
    v_mfma_f32_16x16x32_bf16 v[128:131], a[160:163], v[80:83], v[192:195]
    v_exp_f32 v148, v148
    v_mfma_f32_16x16x32_bf16 v[96:99], a[164:167], v[20:23], v[96:99]
    ds_read_b64_tr_b16 a[196:197], v217 offset:59168
    v_add_f32 v196, v196, v142
    v_mfma_f32_16x16x32_bf16 v[104:107], a[164:167], v[36:39], v[104:107]
    v_exp_f32 v149, v149
    v_mfma_f32_16x16x32_bf16 v[112:115], a[164:167], v[52:55], v[112:115]
    ds_read_b64_tr_b16 a[198:199], v217 offset:59680
    v_cvt_pk_bf16_f32 v146, v148, v149
    v_mfma_f32_16x16x32_bf16 v[120:123], a[164:167], v[68:71], v[120:123]
    v_exp_f32 v150, v150
    v_mfma_f32_16x16x32_bf16 v[128:131], a[164:167], v[84:87], v[128:131]
    ds_read_b64_tr_b16 a[200:201], v217 offset:59200
    v_add_f32 v196, v196, v143
    v_mfma_f32_16x16x32_bf16 v[96:99], a[168:171], v[24:27], v[96:99]
    v_exp_f32 v151, v151
    v_mfma_f32_16x16x32_bf16 v[104:107], a[168:171], v[40:43], v[104:107]
    buffer_load_dwordx4 v11, s[28:31], s53 offen offset:1056 nt lds
    v_mfma_f32_16x16x32_bf16 v[112:115], a[168:171], v[56:59], v[112:115]
    ds_read_b64_tr_b16 a[202:203], v217 offset:59712
    v_exp_f32 v156, v156
    v_mfma_f32_16x16x32_bf16 v[120:123], a[168:171], v[72:75], v[120:123]
    ds_read_b64_tr_b16 a[204:205], v217 offset:59232
    v_cvt_pk_bf16_f32 v147, v150, v151
    v_mfma_f32_16x16x32_bf16 v[128:131], a[168:171], v[88:91], v[128:131]
    v_exp_f32 v157, v157
    v_mfma_f32_16x16x32_bf16 v[96:99], a[172:175], v[28:31], v[96:99]
    ds_read_b64_tr_b16 a[206:207], v217 offset:59744
    v_cvt_pk_bf16_f32 v154, v156, v157
    v_mfma_f32_16x16x32_bf16 v[104:107], a[172:175], v[44:47], v[104:107]
    v_exp_f32 v158, v158
    v_mfma_f32_16x16x32_bf16 v[112:115], a[172:175], v[60:63], v[112:115]
    v_exp_f32 v159, v159
    v_mfma_f32_16x16x32_bf16 v[120:123], a[172:175], v[76:79], v[120:123]
    ds_read_b64_tr_b16 a[208:209], v217 offset:59264
    v_cvt_pk_bf16_f32 v155, v158, v159
    v_mfma_f32_16x16x32_bf16 v[128:131], a[172:175], v[92:95], v[128:131]
    v_exp_f32 v164, v164
    v_mfma_f32_16x16x32_bf16 v[100:103], a[176:179], v[16:19], v[176:179]
    ds_read_b64_tr_b16 a[210:211], v217 offset:59776
    v_add_f32 v197, v197, v148
    v_mfma_f32_16x16x32_bf16 v[108:111], a[176:179], v[32:35], v[180:183]
    buffer_load_dwordx4 v12, s[28:31], s53 offen offset:2112 nt lds
    v_mfma_f32_16x16x32_bf16 v[116:119], a[176:179], v[48:51], v[184:187]
    ds_read_b64_tr_b16 a[212:213], v217 offset:59296
    v_exp_f32 v165, v165
    v_mfma_f32_16x16x32_bf16 v[124:127], a[176:179], v[64:67], v[188:191]
    v_exp_f32 v166, v166
    v_mfma_f32_16x16x32_bf16 v[132:135], a[176:179], v[80:83], v[192:195]
    ds_read_b64_tr_b16 a[214:215], v217 offset:59808
    v_cvt_pk_bf16_f32 v162, v164, v165
    v_mfma_f32_16x16x32_bf16 v[100:103], a[180:183], v[20:23], v[100:103]
    v_exp_f32 v167, v167
    v_mfma_f32_16x16x32_bf16 v[108:111], a[180:183], v[36:39], v[108:111]
    ds_read_b64_tr_b16 a[216:217], v217 offset:59328
    v_cvt_pk_bf16_f32 v163, v166, v167
    v_mfma_f32_16x16x32_bf16 v[116:119], a[180:183], v[52:55], v[116:119]
    v_exp_f32 v172, v172
    v_mfma_f32_16x16x32_bf16 v[124:127], a[180:183], v[68:71], v[124:127]
    ds_read_b64_tr_b16 a[218:219], v217 offset:59840
    v_add_f32 v197, v197, v149
    v_mfma_f32_16x16x32_bf16 v[132:135], a[180:183], v[84:87], v[132:135]
    v_exp_f32 v173, v173
    v_mfma_f32_16x16x32_bf16 v[100:103], a[184:187], v[24:27], v[100:103]
    ds_read_b64_tr_b16 a[220:221], v217 offset:59360
    v_cvt_pk_bf16_f32 v170, v172, v173
    v_mfma_f32_16x16x32_bf16 v[108:111], a[184:187], v[40:43], v[108:111]
    buffer_load_dwordx4 v13, s[28:31], s53 offen offset:3168 nt lds
    v_mfma_f32_16x16x32_bf16 v[116:119], a[184:187], v[56:59], v[116:119]
    v_exp_f32 v174, v174
    v_mfma_f32_16x16x32_bf16 v[124:127], a[184:187], v[72:75], v[124:127]
    v_exp_f32 v175, v175
    v_mfma_f32_16x16x32_bf16 v[132:135], a[184:187], v[88:91], v[132:135]
    ds_read_b64_tr_b16 a[222:223], v217 offset:59872
    v_cvt_pk_bf16_f32 v171, v174, v175
    v_mfma_f32_16x16x32_bf16 v[100:103], a[188:191], v[28:31], v[100:103]
    v_add_f32 v197, v197, v150
    v_add_f32 v197, v197, v151
    v_mfma_f32_16x16x32_bf16 v[108:111], a[188:191], v[44:47], v[108:111]
    v_add_f32 v198, v198, v156
    v_add_f32 v198, v198, v157
    v_mfma_f32_16x16x32_bf16 v[116:119], a[188:191], v[60:63], v[116:119]
    v_add_f32 v198, v198, v158
    v_add_f32 v198, v198, v159
    v_mfma_f32_16x16x32_bf16 v[124:127], a[188:191], v[76:79], v[124:127]
    s_waitcnt lgkmcnt(0)
    v_add_f32 v199, v199, v164
    v_add_f32 v199, v199, v165
    v_mfma_f32_16x16x32_bf16 v[132:135], a[188:191], v[92:95], v[132:135]
    s_add_u32 s53, s53, 16384
    v_add_f32 v199, v199, v166
    v_add_f32 v199, v199, v167
    v_mfma_f32_16x16x32_bf16 a[0:3], a[192:195], v[136:139], a[0:3]
    v_exp_f32 v96, v96
    v_mfma_f32_16x16x32_bf16 a[4:7], a[192:195], v[144:147], a[4:7]
    v_exp_f32 v97, v97
    v_mfma_f32_16x16x32_bf16 a[8:11], a[192:195], v[152:155], a[8:11]
    ds_read_b128 a[160:163], v14 offset:512
    v_add_f32 v196, v196, v96
    v_mfma_f32_16x16x32_bf16 a[12:15], a[192:195], v[160:163], a[12:15]
    v_exp_f32 v98, v98
    v_mfma_f32_16x16x32_bf16 a[16:19], a[192:195], v[168:171], a[16:19]
    ds_read_b128 a[164:167], v14 offset:576
    v_cvt_pk_bf16_f32 v96, v96, v97
    v_mfma_f32_16x16x32_bf16 a[20:23], a[196:199], v[136:139], a[20:23]
    v_exp_f32 v99, v99
    v_mfma_f32_16x16x32_bf16 a[24:27], a[196:199], v[144:147], a[24:27]
    ds_read_b128 a[168:171], v14 offset:640
    v_add_f32 v196, v196, v97
    v_mfma_f32_16x16x32_bf16 a[28:31], a[196:199], v[152:155], a[28:31]
    v_exp_f32 v104, v104
    v_mfma_f32_16x16x32_bf16 a[32:35], a[196:199], v[160:163], a[32:35]
    v_cvt_pk_bf16_f32 v97, v98, v99
    v_add_f32 v196, v196, v98
    v_mfma_f32_16x16x32_bf16 a[36:39], a[196:199], v[168:171], a[36:39]
    v_exp_f32 v105, v105
    v_mfma_f32_16x16x32_bf16 a[40:43], a[200:203], v[136:139], a[40:43]
    ds_read_b128 a[172:175], v14 offset:704
    v_add_f32 v196, v196, v99
    v_mfma_f32_16x16x32_bf16 a[44:47], a[200:203], v[144:147], a[44:47]
    v_exp_f32 v106, v106
    v_mfma_f32_16x16x32_bf16 a[48:51], a[200:203], v[152:155], a[48:51]
    ds_read_b128 a[176:179], v14 offset:768
    v_add_f32 v197, v197, v104
    v_mfma_f32_16x16x32_bf16 a[52:55], a[200:203], v[160:163], a[52:55]
    v_exp_f32 v107, v107
    v_mfma_f32_16x16x32_bf16 a[56:59], a[200:203], v[168:171], a[56:59]
    v_cvt_pk_bf16_f32 v104, v104, v105
    v_add_f32 v197, v197, v105
    v_mfma_f32_16x16x32_bf16 a[60:63], a[204:207], v[136:139], a[60:63]
    v_exp_f32 v112, v112
    v_mfma_f32_16x16x32_bf16 a[64:67], a[204:207], v[144:147], a[64:67]
    ds_read_b128 a[180:183], v14 offset:832
    v_cvt_pk_bf16_f32 v105, v106, v107
    v_mfma_f32_16x16x32_bf16 a[68:71], a[204:207], v[152:155], a[68:71]
    v_exp_f32 v113, v113
    v_mfma_f32_16x16x32_bf16 a[72:75], a[204:207], v[160:163], a[72:75]
    ds_read_b128 a[184:187], v14 offset:896
    v_add_f32 v197, v197, v106
    v_mfma_f32_16x16x32_bf16 a[76:79], a[204:207], v[168:171], a[76:79]
    v_exp_f32 v114, v114
    v_mfma_f32_16x16x32_bf16 a[80:83], a[208:211], v[136:139], a[80:83]
    v_exp_f32 v115, v115
    v_mfma_f32_16x16x32_bf16 a[84:87], a[208:211], v[144:147], a[84:87]
    ds_read_b128 a[188:191], v14 offset:960
    v_add_f32 v197, v197, v107
    v_mfma_f32_16x16x32_bf16 a[88:91], a[208:211], v[152:155], a[88:91]
    v_exp_f32 v120, v120
    v_mfma_f32_16x16x32_bf16 a[92:95], a[208:211], v[160:163], a[92:95]
    v_add_f32 v198, v198, v112
    v_cvt_pk_bf16_f32 v112, v112, v113
    v_mfma_f32_16x16x32_bf16 a[96:99], a[208:211], v[168:171], a[96:99]
    v_exp_f32 v121, v121
    v_mfma_f32_16x16x32_bf16 a[100:103], a[212:215], v[136:139], a[100:103]
    v_add_f32 v198, v198, v113
    v_cvt_pk_bf16_f32 v113, v114, v115
    v_mfma_f32_16x16x32_bf16 a[104:107], a[212:215], v[144:147], a[104:107]
    v_exp_f32 v122, v122
    v_mfma_f32_16x16x32_bf16 a[108:111], a[212:215], v[152:155], a[108:111]
    v_add_f32 v198, v198, v114
    v_add_f32 v198, v198, v115
    v_mfma_f32_16x16x32_bf16 a[112:115], a[212:215], v[160:163], a[112:115]
    v_exp_f32 v123, v123
    v_mfma_f32_16x16x32_bf16 a[116:119], a[212:215], v[168:171], a[116:119]
    v_add_f32 v199, v199, v120
    v_cvt_pk_bf16_f32 v120, v120, v121
    v_mfma_f32_16x16x32_bf16 a[120:123], a[216:219], v[136:139], a[120:123]
    s_sub_u32 s54, s54, 1
    v_exp_f32 v128, v128
    v_mfma_f32_16x16x32_bf16 a[124:127], a[216:219], v[144:147], a[124:127]
    v_add_f32 v199, v199, v121
    v_cvt_pk_bf16_f32 v121, v122, v123
    v_mfma_f32_16x16x32_bf16 a[128:131], a[216:219], v[152:155], a[128:131]
    v_exp_f32 v129, v129
    v_mfma_f32_16x16x32_bf16 a[132:135], a[216:219], v[160:163], a[132:135]
    v_cvt_pk_bf16_f32 v128, v128, v129
    v_add_f32 v199, v199, v122
    v_mfma_f32_16x16x32_bf16 a[136:139], a[216:219], v[168:171], a[136:139]
    v_exp_f32 v130, v130
    v_mfma_f32_16x16x32_bf16 a[140:143], a[220:223], v[136:139], a[140:143]
    v_exp_f32 v131, v131
    v_mfma_f32_16x16x32_bf16 a[144:147], a[220:223], v[144:147], a[144:147]
    v_cvt_pk_bf16_f32 v129, v130, v131
    v_add_f32 v199, v199, v123
    v_mfma_f32_16x16x32_bf16 a[148:151], a[220:223], v[152:155], a[148:151]
    v_exp_f32 v100, v100
    v_mfma_f32_16x16x32_bf16 a[152:155], a[220:223], v[160:163], a[152:155]
    v_exp_f32 v101, v101
    v_mfma_f32_16x16x32_bf16 a[156:159], a[220:223], v[168:171], a[156:159]
    s_waitcnt vmcnt(16) lgkmcnt(0)
    v_cvt_pk_bf16_f32 v98, v100, v101
    v_add_f32 v196, v196, v100
    v_mfma_f32_16x16x32_bf16 a[236:239], a[240:243], v[168:171], a[236:239]
    s_barrier
    v_exp_f32 v102, v102
    s_branch K1_LOOP
K1_WARM:
    s_lshr_b32 s3, s39, 2
    s_lshl_b32 s3, s3, 5
    s_lshl_b32 s14, s38, 2
    s_add_u32 s3, s3, s14
    s_and_b32 s14, s39, 3
    s_add_u32 s3, s3, s14
    s_mul_i32 s3, s3, 36864
    v_lshlrev_b32 v213, 7, v0
    v_add_u32 v213, s3, v213
    s_add_u32 s14, s3, 36864
    s_mov_b32 s90, s14
    s_mov_b32 s91, 0x20000
    buffer_load_dword v215, v213, s[88:91], 0 offen
    v_add_u32 v213, 32768, v213
    buffer_load_dword v215, v213, s[88:91], 0 offen
    s_branch K1_WARMRET
K1_TAIL:
    ds_read_b64_tr_b16 a[192:193], v217 offset:59136
    v_add_f32 v196, v196, v141
    v_exp_f32 v143, v143
    s_nop 0
    ds_read_b64_tr_b16 a[194:195], v217 offset:59648
    v_cvt_pk_bf16_f32 v139, v142, v143
    v_exp_f32 v148, v148
    s_nop 0
    ds_read_b64_tr_b16 a[196:197], v217 offset:59168
    v_add_f32 v196, v196, v142
    v_exp_f32 v149, v149
    s_nop 0
    ds_read_b64_tr_b16 a[198:199], v217 offset:59680
    v_cvt_pk_bf16_f32 v146, v148, v149
    v_exp_f32 v150, v150
    s_nop 0
    ds_read_b64_tr_b16 a[200:201], v217 offset:59200
    v_add_f32 v196, v196, v143
    v_exp_f32 v151, v151
    s_nop 0
    ds_read_b64_tr_b16 a[202:203], v217 offset:59712
    v_exp_f32 v156, v156
    s_nop 0
    ds_read_b64_tr_b16 a[204:205], v217 offset:59232
    v_cvt_pk_bf16_f32 v147, v150, v151
    v_exp_f32 v157, v157
    s_nop 0
    ds_read_b64_tr_b16 a[206:207], v217 offset:59744
    v_cvt_pk_bf16_f32 v154, v156, v157
    v_exp_f32 v158, v158
    v_exp_f32 v159, v159
    s_nop 0
    ds_read_b64_tr_b16 a[208:209], v217 offset:59264
    v_cvt_pk_bf16_f32 v155, v158, v159
    v_exp_f32 v164, v164
    s_nop 0
    ds_read_b64_tr_b16 a[210:211], v217 offset:59776
    v_add_f32 v197, v197, v148
    ds_read_b64_tr_b16 a[212:213], v217 offset:59296
    v_exp_f32 v165, v165
    v_exp_f32 v166, v166
    s_nop 0
    ds_read_b64_tr_b16 a[214:215], v217 offset:59808
    v_cvt_pk_bf16_f32 v162, v164, v165
    v_exp_f32 v167, v167
    s_nop 0
    ds_read_b64_tr_b16 a[216:217], v217 offset:59328
    v_cvt_pk_bf16_f32 v163, v166, v167
    v_exp_f32 v172, v172
    s_nop 0
    ds_read_b64_tr_b16 a[218:219], v217 offset:59840
    v_add_f32 v197, v197, v149
    v_exp_f32 v173, v173
    s_nop 0
    ds_read_b64_tr_b16 a[220:221], v217 offset:59360
    v_cvt_pk_bf16_f32 v170, v172, v173
    v_exp_f32 v174, v174
    v_exp_f32 v175, v175
    s_nop 0
    ds_read_b64_tr_b16 a[222:223], v217 offset:59872
    v_cvt_pk_bf16_f32 v171, v174, v175
    v_add_f32 v197, v197, v150
    v_add_f32 v197, v197, v151
    v_add_f32 v198, v198, v156
    v_add_f32 v198, v198, v157
    v_add_f32 v198, v198, v158
    v_add_f32 v198, v198, v159
    v_add_f32 v199, v199, v164
    v_add_f32 v199, v199, v165
    v_add_f32 v199, v199, v166
    v_add_f32 v199, v199, v167
    s_nop 1
    v_mfma_f32_16x16x32_bf16 a[236:239], a[240:243], v[168:171], a[236:239]
    v_mov_b32 v201, v196
    v_mov_b32 v202, v197
    v_mov_b32 v203, v198
    v_mov_b32 v204, v199
    s_nop 1
    v_permlane32_swap_b32 v196, v201
    v_permlane32_swap_b32 v197, v202
    v_permlane32_swap_b32 v198, v203
    v_permlane32_swap_b32 v199, v204
    s_nop 1
    v_add_f32 v196, v196, v201
    v_add_f32 v197, v197, v202
    v_add_f32 v198, v198, v203
    v_add_f32 v199, v199, v204
    v_mov_b32 v201, v196
    v_mov_b32 v202, v197
    v_mov_b32 v203, v198
    v_mov_b32 v204, v199
    s_nop 1
    v_permlane16_swap_b32 v196, v201
    v_permlane16_swap_b32 v197, v202
    v_permlane16_swap_b32 v198, v203
    v_permlane16_swap_b32 v199, v204
    s_nop 1
    v_add_f32 v196, v196, v201
    v_add_f32 v197, v197, v202
    v_add_f32 v198, v198, v203
    v_add_f32 v199, v199, v204
    v_accvgpr_read_b32 v200, a236
    s_mov_b32 s14, 0x4e800000
    v_cmp_nle_f32 s[44:45], v196, s14
    v_cmp_nle_f32 s[48:49], v197, s14
    s_nop 1
    s_or_b64 s[44:45], s[44:45], s[48:49]
    v_cmp_nle_f32 s[48:49], v198, s14
    s_nop 1
    s_or_b64 s[44:45], s[44:45], s[48:49]
    v_cmp_nle_f32 s[48:49], v199, s14
    s_nop 1
    s_or_b64 s[44:45], s[44:45], s[48:49]
    v_cmp_nle_f32 s[48:49], v200, s14
    s_nop 1
    s_or_b64 s[44:45], s[44:45], s[48:49]
    s_cmp_lg_u64 s[44:45], 0
    s_cselect_b32 s14, 1, 0
    s_lshl_b32 s15, s36, 2
    s_add_u32 s15, s15, 135168
    v_mov_b32 v201, s15
    v_mov_b32 v202, s14
    ds_write_b32 v201, v202
    s_waitcnt vmcnt(0) lgkmcnt(0)
    s_barrier
    v_mov_b32 v201, 135168
    ds_read_b128 v[204:207], v201
    s_waitcnt lgkmcnt(0)
    v_or3_b32 v204, v204, v205, v206
    v_or_b32 v204, v204, v207
    s_nop 0
    v_readfirstlane_b32 s14, v204
    s_nop 3
    s_cmp_lg_u32 s14, 0
    s_cbranch_scc1 K1_SLOW
K1_SLOWRET:
    v_rcp_f32 v24, v196
    v_rcp_f32 v25, v197
    v_rcp_f32 v26, v198
    v_rcp_f32 v27, v199
    v_rcp_f32 v28, v200
    v_lshlrev_b32 v29, 4, v1
    v_readfirstlane_b32 s99, v218
    s_nop 3
    s_cmp_lg_u32 s99, 0
    s_cbranch_scc1 K1_HAVENONCE
    s_load_dwordx2 s[14:15], s[0:1], 88
    s_waitcnt lgkmcnt(0)
    v_mov_b32 v19, 0
    s_mov_b32 s51, 0x40000
P2_NON_f:
    global_load_dword v20, v19, s[14:15] sc1
    s_waitcnt vmcnt(0)
    v_readfirstlane_b32 s99, v20
    s_nop 3
    s_cmp_lg_u32 s99, 0
    s_cbranch_scc1 P2_NOND_f
    s_sub_u32 s51, s51, 1
    s_cmp_eq_u32 s51, 0
    s_cbranch_scc1 P2_NOND_f
    s_sleep 1
    s_branch P2_NON_f
P2_NOND_f:
K1_HAVENONCE:
    s_and_b32 s40, s39, 3
    s_lshr_b32 s41, s39, 2
    s_and_b32 s42, s36, 1
    s_lshr_b32 s43, s36, 1
    v_accvgpr_read_b32 v2, a224
    v_accvgpr_read_b32 v3, a225
    v_accvgpr_read_b32 v4, a226
    v_accvgpr_read_b32 v5, a227
    v_accvgpr_read_b32 v6, a228
    v_accvgpr_read_b32 v7, a229
    v_accvgpr_read_b32 v8, a230
    v_accvgpr_read_b32 v9, a231
    v_accvgpr_read_b32 v10, a232
    v_accvgpr_read_b32 v11, a233
    v_accvgpr_read_b32 v17, a234
    v_accvgpr_read_b32 v18, a235
    v_lshlrev_b32 v12, 4, v1
    s_lshl_b32 s3, s37, 3
    s_add_u32 s3, s3, s38
    s_mul_i32 s14, s3, 10
    s_mul_i32 s15, s42, 5
    s_add_u32 s14, s14, s15
    s_mul_i32 s14, s14, 131072
    s_add_u32 s16, s12, s14
    s_addc_u32 s17, s13, 0
    s_mov_b32 s18, 655360
    s_mov_b32 s19, 0x20000
    s_mul_i32 s14, s40, 288
    s_and_b32 s15, s40, 1
    s_lshl_b32 s15, s15, 5
    s_sub_u32 s14, s14, s15
    s_add_u32 s20, s88, s14
    s_addc_u32 s21, s89, 0
    s_sub_u32 s20, s20, 8192
    s_subb_u32 s21, s21, 0
    s_sub_u32 s22, 4726784, s14
    s_mov_b32 s23, 0x20000
    s_lshl_b32 s14, s3, 2
    s_add_u32 s14, s14, s40
    s_mul_i32 s14, s14, 196608
    s_add_u32 s14, s14, 33554432
    s_add_u32 s24, s12, s14
    s_addc_u32 s25, s13, 0
    s_mov_b32 s26, 196608
    s_mov_b32 s27, 0x20000
    s_mul_i32 s14, s38, 368640
    s_mul_i32 s15, s37, 1152
    s_add_u32 s14, s14, s15
    s_mul_i32 s15, s40, 288
    s_add_u32 s14, s14, s15
    s_add_u32 s28, s58, s14
    s_addc_u32 s29, s59, 0
    s_sub_u32 s30, 2949120, s14
    s_mov_b32 s31, 0x20000
    s_add_u32 s92, s12, 62914560
    s_addc_u32 s93, s13, 0
    s_mov_b32 s94, 98304
    s_mov_b32 s95, 0x20000
    s_lshl_b32 s3, s3, 4
    s_add_u32 s14, s3, s39
    s_lshl_b32 s52, s14, 7
    s_lshl_b32 s53, s3, 7
    s_mov_b32 s44, 0
    s_mul_i32 s47, s36, 0
    s_lshl_b32 s57, s41, 5
    s_lshl_b32 s14, s43, 2
    s_add_u32 s57, s57, s14
    s_lshl_b32 s14, s43, 1
    s_add_u32 s14, s14, s42
    s_mul_i32 s47, s14, 10240
    s_add_u32 s48, s40, 0
    s_and_b32 s48, s48, 3
    s_lshl_b32 s48, s48, 3
    s_add_u32 s48, s48, s57
    s_add_u32 s48, s48, 0
    s_lshl_b32 s45, s48, 10
    s_add_u32 s48, s48, s42
    s_mul_i32 s46, s48, 36864
    s_mov_b32 s54, s45
    s_add_u32 m0, s47, 0
    s_nop 0
    buffer_load_dwordx4 v2, s[20:23], s46 offen offset:0 lds
    buffer_load_dwordx4 v3, s[20:23], s46 offen offset:1024 lds
    buffer_load_dwordx4 v4, s[20:23], s46 offen offset:2048 lds
    buffer_load_dwordx4 v5, s[20:23], s46 offen offset:3072 lds
    s_add_u32 m0, s47, 4096
    s_nop 0
    buffer_load_dwordx4 v6, s[20:23], s46 offen offset:0 lds
    buffer_load_dwordx4 v7, s[20:23], s46 offen offset:1024 lds
    buffer_load_dwordx4 v8, s[20:23], s46 offen offset:2048 lds
    buffer_load_dwordx4 v9, s[20:23], s46 offen offset:3072 lds
    s_add_u32 m0, s47, 8192
    s_nop 0
    buffer_load_dwordx4 v10, s[20:23], s46 offen offset:0 lds
    buffer_load_dwordx4 v11, s[20:23], s46 offen offset:1024 lds
    s_add_u32 s48, s40, 0
    s_and_b32 s48, s48, 3
    s_lshl_b32 s48, s48, 3
    s_add_u32 s48, s48, s57
    s_add_u32 s48, s48, 2
    s_lshl_b32 s45, s48, 10
    s_add_u32 s48, s48, s42
    s_mul_i32 s46, s48, 36864
    s_mov_b32 s55, s45
    s_add_u32 m0, s47, 40960
    s_nop 0
    buffer_load_dwordx4 v2, s[20:23], s46 offen offset:0 lds
    buffer_load_dwordx4 v3, s[20:23], s46 offen offset:1024 lds
    buffer_load_dwordx4 v4, s[20:23], s46 offen offset:2048 lds
    buffer_load_dwordx4 v5, s[20:23], s46 offen offset:3072 lds
    s_add_u32 m0, s47, 45056
    s_nop 0
    buffer_load_dwordx4 v6, s[20:23], s46 offen offset:0 lds
    buffer_load_dwordx4 v7, s[20:23], s46 offen offset:1024 lds
    buffer_load_dwordx4 v8, s[20:23], s46 offen offset:2048 lds
    buffer_load_dwordx4 v9, s[20:23], s46 offen offset:3072 lds
    s_add_u32 m0, s47, 49152
    s_nop 0
    buffer_load_dwordx4 v10, s[20:23], s46 offen offset:0 lds
    buffer_load_dwordx4 v11, s[20:23], s46 offen offset:1024 lds
    v_mfma_f32_16x16x32_bf16 a[0:3], a[192:195], v[136:139], a[0:3]
    v_mfma_f32_16x16x32_bf16 a[4:7], a[192:195], v[144:147], a[4:7]
    v_mfma_f32_16x16x32_bf16 a[8:11], a[192:195], v[152:155], a[8:11]
    v_mfma_f32_16x16x32_bf16 a[12:15], a[192:195], v[160:163], a[12:15]
    v_mfma_f32_16x16x32_bf16 a[16:19], a[192:195], v[168:171], a[16:19]
    v_mfma_f32_16x16x32_bf16 a[20:23], a[196:199], v[136:139], a[20:23]
    v_mfma_f32_16x16x32_bf16 a[24:27], a[196:199], v[144:147], a[24:27]
    v_mfma_f32_16x16x32_bf16 a[28:31], a[196:199], v[152:155], a[28:31]
    v_mfma_f32_16x16x32_bf16 a[32:35], a[196:199], v[160:163], a[32:35]
    v_mfma_f32_16x16x32_bf16 a[36:39], a[196:199], v[168:171], a[36:39]
    v_mfma_f32_16x16x32_bf16 a[40:43], a[200:203], v[136:139], a[40:43]
    v_mfma_f32_16x16x32_bf16 a[44:47], a[200:203], v[144:147], a[44:47]
    v_mfma_f32_16x16x32_bf16 a[48:51], a[200:203], v[152:155], a[48:51]
    v_mfma_f32_16x16x32_bf16 a[52:55], a[200:203], v[160:163], a[52:55]
    v_accvgpr_read_b32 v32, a0
    v_accvgpr_read_b32 v33, a1
    v_accvgpr_read_b32 v34, a2
    v_accvgpr_read_b32 v35, a3
    v_accvgpr_read_b32 v36, a20
    v_accvgpr_read_b32 v37, a21
    v_mfma_f32_16x16x32_bf16 a[56:59], a[200:203], v[168:171], a[56:59]
    v_accvgpr_read_b32 v38, a22
    v_accvgpr_read_b32 v39, a23
    v_mul_f32 v32, v24, v32
    v_mul_f32 v33, v24, v33
    v_mul_f32 v34, v24, v34
    v_mul_f32 v35, v24, v35
    v_mfma_f32_16x16x32_bf16 a[60:63], a[204:207], v[136:139], a[60:63]
    v_mul_f32 v36, v24, v36
    v_mul_f32 v37, v24, v37
    v_mul_f32 v38, v24, v38
    v_mul_f32 v39, v24, v39
    v_cvt_pk_bf16_f32 v176, v32, v33
    v_cvt_pk_bf16_f32 v177, v34, v35
    v_mfma_f32_16x16x32_bf16 a[64:67], a[204:207], v[144:147], a[64:67]
    v_cvt_pk_bf16_f32 v178, v36, v37
    v_cvt_pk_bf16_f32 v179, v38, v39
    s_mov_b32 s14, 0
    buffer_store_dwordx4 v[176:179], v29, s[32:35], s14 offen sc1
    v_accvgpr_read_b32 v40, a4
    v_accvgpr_read_b32 v41, a5
    v_mfma_f32_16x16x32_bf16 a[68:71], a[204:207], v[152:155], a[68:71]
    v_accvgpr_read_b32 v42, a6
    v_accvgpr_read_b32 v43, a7
    v_accvgpr_read_b32 v44, a24
    v_accvgpr_read_b32 v45, a25
    v_accvgpr_read_b32 v46, a26
    v_accvgpr_read_b32 v47, a27
    v_mfma_f32_16x16x32_bf16 a[72:75], a[204:207], v[160:163], a[72:75]
    v_mul_f32 v40, v25, v40
    v_mul_f32 v41, v25, v41
    v_mul_f32 v42, v25, v42
    v_mul_f32 v43, v25, v43
    v_mul_f32 v44, v25, v44
    v_mul_f32 v45, v25, v45
    v_mfma_f32_16x16x32_bf16 a[76:79], a[204:207], v[168:171], a[76:79]
    v_mul_f32 v46, v25, v46
    v_mul_f32 v47, v25, v47
    v_cvt_pk_bf16_f32 v192, v40, v41
    v_cvt_pk_bf16_f32 v193, v42, v43
    v_cvt_pk_bf16_f32 v194, v44, v45
    v_cvt_pk_bf16_f32 v195, v46, v47
    v_mfma_f32_16x16x32_bf16 a[80:83], a[208:211], v[136:139], a[80:83]
    s_mov_b32 s14, 131072
    buffer_store_dwordx4 v[192:195], v29, s[32:35], s14 offen sc1
    v_accvgpr_read_b32 v48, a8
    v_accvgpr_read_b32 v49, a9
    v_accvgpr_read_b32 v50, a10
    v_accvgpr_read_b32 v51, a11
    v_mfma_f32_16x16x32_bf16 a[84:87], a[208:211], v[144:147], a[84:87]
    v_accvgpr_read_b32 v52, a28
    v_accvgpr_read_b32 v53, a29
    v_accvgpr_read_b32 v54, a30
    v_accvgpr_read_b32 v55, a31
    v_mul_f32 v48, v26, v48
    v_mul_f32 v49, v26, v49
    v_mfma_f32_16x16x32_bf16 a[88:91], a[208:211], v[152:155], a[88:91]
    v_mul_f32 v50, v26, v50
    v_mul_f32 v51, v26, v51
    v_mul_f32 v52, v26, v52
    v_mul_f32 v53, v26, v53
    v_mul_f32 v54, v26, v54
    v_mul_f32 v55, v26, v55
    v_mfma_f32_16x16x32_bf16 a[92:95], a[208:211], v[160:163], a[92:95]
    v_cvt_pk_bf16_f32 v208, v48, v49
    v_cvt_pk_bf16_f32 v209, v50, v51
    v_cvt_pk_bf16_f32 v210, v52, v53
    v_cvt_pk_bf16_f32 v211, v54, v55
    s_mov_b32 s14, 262144
    buffer_store_dwordx4 v[208:211], v29, s[32:35], s14 offen sc1
    v_mfma_f32_16x16x32_bf16 a[96:99], a[208:211], v[168:171], a[96:99]
    v_accvgpr_read_b32 v32, a12
    v_accvgpr_read_b32 v33, a13
    v_accvgpr_read_b32 v34, a14
    v_accvgpr_read_b32 v35, a15
    v_accvgpr_read_b32 v36, a32
    v_accvgpr_read_b32 v37, a33
    v_mfma_f32_16x16x32_bf16 a[100:103], a[212:215], v[136:139], a[100:103]
    v_accvgpr_read_b32 v38, a34
    v_accvgpr_read_b32 v39, a35
    v_mul_f32 v32, v27, v32
    v_mul_f32 v33, v27, v33
    v_mul_f32 v34, v27, v34
    v_mul_f32 v35, v27, v35
    v_mfma_f32_16x16x32_bf16 a[104:107], a[212:215], v[144:147], a[104:107]
    v_mul_f32 v36, v27, v36
    v_mul_f32 v37, v27, v37
    v_mul_f32 v38, v27, v38
    v_mul_f32 v39, v27, v39
    v_cvt_pk_bf16_f32 v224, v32, v33
    v_cvt_pk_bf16_f32 v225, v34, v35
    v_mfma_f32_16x16x32_bf16 a[108:111], a[212:215], v[152:155], a[108:111]
    v_cvt_pk_bf16_f32 v226, v36, v37
    v_cvt_pk_bf16_f32 v227, v38, v39
    s_mov_b32 s14, 393216
    buffer_store_dwordx4 v[224:227], v29, s[32:35], s14 offen sc1
    v_accvgpr_read_b32 v40, a16
    v_accvgpr_read_b32 v41, a17
    v_mfma_f32_16x16x32_bf16 a[112:115], a[212:215], v[160:163], a[112:115]
    v_accvgpr_read_b32 v42, a18
    v_accvgpr_read_b32 v43, a19
    v_accvgpr_read_b32 v44, a36
    v_accvgpr_read_b32 v45, a37
    v_accvgpr_read_b32 v46, a38
    v_accvgpr_read_b32 v47, a39
    v_mfma_f32_16x16x32_bf16 a[116:119], a[212:215], v[168:171], a[116:119]
    v_mul_f32 v40, v28, v40
    v_mul_f32 v41, v28, v41
    v_mul_f32 v42, v28, v42
    v_mul_f32 v43, v28, v43
    v_mul_f32 v44, v28, v44
    v_mul_f32 v45, v28, v45
    v_mfma_f32_16x16x32_bf16 a[120:123], a[216:219], v[136:139], a[120:123]
    v_mul_f32 v46, v28, v46
    v_mul_f32 v47, v28, v47
    v_cvt_pk_bf16_f32 v240, v40, v41
    v_cvt_pk_bf16_f32 v241, v42, v43
    v_cvt_pk_bf16_f32 v242, v44, v45
    v_cvt_pk_bf16_f32 v243, v46, v47
    v_mfma_f32_16x16x32_bf16 a[124:127], a[216:219], v[144:147], a[124:127]
    s_mov_b32 s14, 524288
    buffer_store_dwordx4 v[240:243], v29, s[32:35], s14 offen sc1
    v_accvgpr_read_b32 v48, a40
    v_accvgpr_read_b32 v49, a41
    v_accvgpr_read_b32 v50, a42
    v_accvgpr_read_b32 v51, a43
    v_mfma_f32_16x16x32_bf16 a[128:131], a[216:219], v[152:155], a[128:131]
    v_accvgpr_read_b32 v52, a60
    v_accvgpr_read_b32 v53, a61
    v_accvgpr_read_b32 v54, a62
    v_accvgpr_read_b32 v55, a63
    v_mul_f32 v48, v24, v48
    v_mul_f32 v49, v24, v49
    v_mfma_f32_16x16x32_bf16 a[132:135], a[216:219], v[160:163], a[132:135]
    v_mul_f32 v50, v24, v50
    v_mul_f32 v51, v24, v51
    v_mul_f32 v52, v24, v52
    v_mul_f32 v53, v24, v53
    v_mul_f32 v54, v24, v54
    v_mul_f32 v55, v24, v55
    v_mfma_f32_16x16x32_bf16 a[136:139], a[216:219], v[168:171], a[136:139]
    v_cvt_pk_bf16_f32 v180, v48, v49
    v_cvt_pk_bf16_f32 v181, v50, v51
    v_cvt_pk_bf16_f32 v182, v52, v53
    v_cvt_pk_bf16_f32 v183, v54, v55
    s_mov_b32 s14, 1024
    buffer_store_dwordx4 v[180:183], v29, s[32:35], s14 offen sc1
    v_mfma_f32_16x16x32_bf16 a[140:143], a[220:223], v[136:139], a[140:143]
    v_accvgpr_read_b32 v32, a44
    v_accvgpr_read_b32 v33, a45
    v_accvgpr_read_b32 v34, a46
    v_accvgpr_read_b32 v35, a47
    v_accvgpr_read_b32 v36, a64
    v_accvgpr_read_b32 v37, a65
    v_mfma_f32_16x16x32_bf16 a[144:147], a[220:223], v[144:147], a[144:147]
    v_accvgpr_read_b32 v38, a66
    v_accvgpr_read_b32 v39, a67
    v_mul_f32 v32, v25, v32
    v_mul_f32 v33, v25, v33
    v_mul_f32 v34, v25, v34
    v_mul_f32 v35, v25, v35
    v_mfma_f32_16x16x32_bf16 a[148:151], a[220:223], v[152:155], a[148:151]
    v_mul_f32 v36, v25, v36
    v_mul_f32 v37, v25, v37
    v_mul_f32 v38, v25, v38
    v_mul_f32 v39, v25, v39
    v_cvt_pk_bf16_f32 v196, v32, v33
    v_cvt_pk_bf16_f32 v197, v34, v35
    v_mfma_f32_16x16x32_bf16 a[152:155], a[220:223], v[160:163], a[152:155]
    v_cvt_pk_bf16_f32 v198, v36, v37
    v_cvt_pk_bf16_f32 v199, v38, v39
    s_mov_b32 s14, 132096
    buffer_store_dwordx4 v[196:199], v29, s[32:35], s14 offen sc1
    v_accvgpr_read_b32 v40, a48
    v_accvgpr_read_b32 v41, a49
    v_mfma_f32_16x16x32_bf16 a[156:159], a[220:223], v[168:171], a[156:159]
    v_accvgpr_read_b32 v42, a50
    v_accvgpr_read_b32 v43, a51
    v_accvgpr_read_b32 v44, a68
    v_accvgpr_read_b32 v45, a69
    v_accvgpr_read_b32 v46, a70
    v_accvgpr_read_b32 v47, a71
    s_nop 7
    v_mul_f32 v40, v26, v40
    v_mul_f32 v41, v26, v41
    v_mul_f32 v42, v26, v42
    v_mul_f32 v43, v26, v43
    v_mul_f32 v44, v26, v44
    v_mul_f32 v45, v26, v45
    v_mul_f32 v46, v26, v46
    v_mul_f32 v47, v26, v47
    v_cvt_pk_bf16_f32 v212, v40, v41
    v_cvt_pk_bf16_f32 v213, v42, v43
    v_cvt_pk_bf16_f32 v214, v44, v45
    v_cvt_pk_bf16_f32 v215, v46, v47
    s_mov_b32 s14, 263168
    buffer_store_dwordx4 v[212:215], v29, s[32:35], s14 offen sc1
    v_accvgpr_read_b32 v48, a52
    v_accvgpr_read_b32 v49, a53
    v_accvgpr_read_b32 v50, a54
    v_accvgpr_read_b32 v51, a55
    v_accvgpr_read_b32 v52, a72
    v_accvgpr_read_b32 v53, a73
    v_accvgpr_read_b32 v54, a74
    v_accvgpr_read_b32 v55, a75
    v_mul_f32 v48, v27, v48
    v_mul_f32 v49, v27, v49
    v_mul_f32 v50, v27, v50
    v_mul_f32 v51, v27, v51
    v_mul_f32 v52, v27, v52
    v_mul_f32 v53, v27, v53
    v_mul_f32 v54, v27, v54
    v_mul_f32 v55, v27, v55
    v_cvt_pk_bf16_f32 v228, v48, v49
    v_cvt_pk_bf16_f32 v229, v50, v51
    v_cvt_pk_bf16_f32 v230, v52, v53
    v_cvt_pk_bf16_f32 v231, v54, v55
    s_mov_b32 s14, 394240
    buffer_store_dwordx4 v[228:231], v29, s[32:35], s14 offen sc1
    v_accvgpr_read_b32 v32, a56
    v_accvgpr_read_b32 v33, a57
    v_accvgpr_read_b32 v34, a58
    v_accvgpr_read_b32 v35, a59
    v_accvgpr_read_b32 v36, a76
    v_accvgpr_read_b32 v37, a77
    v_accvgpr_read_b32 v38, a78
    v_accvgpr_read_b32 v39, a79
    v_mul_f32 v32, v28, v32
    v_mul_f32 v33, v28, v33
    v_mul_f32 v34, v28, v34
    v_mul_f32 v35, v28, v35
    v_mul_f32 v36, v28, v36
    v_mul_f32 v37, v28, v37
    v_mul_f32 v38, v28, v38
    v_mul_f32 v39, v28, v39
    v_cvt_pk_bf16_f32 v244, v32, v33
    v_cvt_pk_bf16_f32 v245, v34, v35
    v_cvt_pk_bf16_f32 v246, v36, v37
    v_cvt_pk_bf16_f32 v247, v38, v39
    s_mov_b32 s14, 525312
    buffer_store_dwordx4 v[244:247], v29, s[32:35], s14 offen sc1
    v_accvgpr_read_b32 v40, a80
    v_accvgpr_read_b32 v41, a81
    v_accvgpr_read_b32 v42, a82
    v_accvgpr_read_b32 v43, a83
    v_accvgpr_read_b32 v44, a100
    v_accvgpr_read_b32 v45, a101
    v_accvgpr_read_b32 v46, a102
    v_accvgpr_read_b32 v47, a103
    v_mul_f32 v40, v24, v40
    v_mul_f32 v41, v24, v41
    v_mul_f32 v42, v24, v42
    v_mul_f32 v43, v24, v43
    v_mul_f32 v44, v24, v44
    v_mul_f32 v45, v24, v45
    v_mul_f32 v46, v24, v46
    v_mul_f32 v47, v24, v47
    v_cvt_pk_bf16_f32 v184, v40, v41
    v_cvt_pk_bf16_f32 v185, v42, v43
    v_cvt_pk_bf16_f32 v186, v44, v45
    v_cvt_pk_bf16_f32 v187, v46, v47
    s_mov_b32 s14, 2048
    buffer_store_dwordx4 v[184:187], v29, s[32:35], s14 offen sc1
    v_accvgpr_read_b32 v48, a84
    v_accvgpr_read_b32 v49, a85
    v_accvgpr_read_b32 v50, a86
    v_accvgpr_read_b32 v51, a87
    v_accvgpr_read_b32 v52, a104
    v_accvgpr_read_b32 v53, a105
    v_accvgpr_read_b32 v54, a106
    v_accvgpr_read_b32 v55, a107
    v_mul_f32 v48, v25, v48
    v_mul_f32 v49, v25, v49
    v_mul_f32 v50, v25, v50
    v_mul_f32 v51, v25, v51
    v_mul_f32 v52, v25, v52
    v_mul_f32 v53, v25, v53
    v_mul_f32 v54, v25, v54
    v_mul_f32 v55, v25, v55
    v_cvt_pk_bf16_f32 v200, v48, v49
    v_cvt_pk_bf16_f32 v201, v50, v51
    v_cvt_pk_bf16_f32 v202, v52, v53
    v_cvt_pk_bf16_f32 v203, v54, v55
    s_mov_b32 s14, 133120
    buffer_store_dwordx4 v[200:203], v29, s[32:35], s14 offen sc1
    v_accvgpr_read_b32 v32, a88
    v_accvgpr_read_b32 v33, a89
    v_accvgpr_read_b32 v34, a90
    v_accvgpr_read_b32 v35, a91
    v_accvgpr_read_b32 v36, a108
    v_accvgpr_read_b32 v37, a109
    v_accvgpr_read_b32 v38, a110
    v_accvgpr_read_b32 v39, a111
    v_mul_f32 v32, v26, v32
    v_mul_f32 v33, v26, v33
    v_mul_f32 v34, v26, v34
    v_mul_f32 v35, v26, v35
    v_mul_f32 v36, v26, v36
    v_mul_f32 v37, v26, v37
    v_mul_f32 v38, v26, v38
    v_mul_f32 v39, v26, v39
    v_cvt_pk_bf16_f32 v216, v32, v33
    v_cvt_pk_bf16_f32 v217, v34, v35
    v_cvt_pk_bf16_f32 v218, v36, v37
    v_cvt_pk_bf16_f32 v219, v38, v39
    s_mov_b32 s14, 264192
    buffer_store_dwordx4 v[216:219], v29, s[32:35], s14 offen sc1
    v_accvgpr_read_b32 v40, a92
    v_accvgpr_read_b32 v41, a93
    v_accvgpr_read_b32 v42, a94
    v_accvgpr_read_b32 v43, a95
    v_accvgpr_read_b32 v44, a112
    v_accvgpr_read_b32 v45, a113
    v_accvgpr_read_b32 v46, a114
    v_accvgpr_read_b32 v47, a115
    v_mul_f32 v40, v27, v40
    v_mul_f32 v41, v27, v41
    v_mul_f32 v42, v27, v42
    v_mul_f32 v43, v27, v43
    v_mul_f32 v44, v27, v44
    v_mul_f32 v45, v27, v45
    v_mul_f32 v46, v27, v46
    v_mul_f32 v47, v27, v47
    v_cvt_pk_bf16_f32 v232, v40, v41
    v_cvt_pk_bf16_f32 v233, v42, v43
    v_cvt_pk_bf16_f32 v234, v44, v45
    v_cvt_pk_bf16_f32 v235, v46, v47
    s_mov_b32 s14, 395264
    buffer_store_dwordx4 v[232:235], v29, s[32:35], s14 offen sc1
    v_accvgpr_read_b32 v48, a96
    v_accvgpr_read_b32 v49, a97
    v_accvgpr_read_b32 v50, a98
    v_accvgpr_read_b32 v51, a99
    v_accvgpr_read_b32 v52, a116
    v_accvgpr_read_b32 v53, a117
    v_accvgpr_read_b32 v54, a118
    v_accvgpr_read_b32 v55, a119
    v_mul_f32 v48, v28, v48
    v_mul_f32 v49, v28, v49
    v_mul_f32 v50, v28, v50
    v_mul_f32 v51, v28, v51
    v_mul_f32 v52, v28, v52
    v_mul_f32 v53, v28, v53
    v_mul_f32 v54, v28, v54
    v_mul_f32 v55, v28, v55
    v_cvt_pk_bf16_f32 v248, v48, v49
    v_cvt_pk_bf16_f32 v249, v50, v51
    v_cvt_pk_bf16_f32 v250, v52, v53
    v_cvt_pk_bf16_f32 v251, v54, v55
    s_mov_b32 s14, 526336
    buffer_store_dwordx4 v[248:251], v29, s[32:35], s14 offen sc1
    v_accvgpr_read_b32 v32, a120
    v_accvgpr_read_b32 v33, a121
    v_accvgpr_read_b32 v34, a122
    v_accvgpr_read_b32 v35, a123
    v_accvgpr_read_b32 v36, a140
    v_accvgpr_read_b32 v37, a141
    v_accvgpr_read_b32 v38, a142
    v_accvgpr_read_b32 v39, a143
    v_mul_f32 v32, v24, v32
    v_mul_f32 v33, v24, v33
    v_mul_f32 v34, v24, v34
    v_mul_f32 v35, v24, v35
    v_mul_f32 v36, v24, v36
    v_mul_f32 v37, v24, v37
    v_mul_f32 v38, v24, v38
    v_mul_f32 v39, v24, v39
    v_cvt_pk_bf16_f32 v188, v32, v33
    v_cvt_pk_bf16_f32 v189, v34, v35
    v_cvt_pk_bf16_f32 v190, v36, v37
    v_cvt_pk_bf16_f32 v191, v38, v39
    s_mov_b32 s14, 3072
    buffer_store_dwordx4 v[188:191], v29, s[32:35], s14 offen sc1
    v_accvgpr_read_b32 v40, a124
    v_accvgpr_read_b32 v41, a125
    v_accvgpr_read_b32 v42, a126
    v_accvgpr_read_b32 v43, a127
    v_accvgpr_read_b32 v44, a144
    v_accvgpr_read_b32 v45, a145
    v_accvgpr_read_b32 v46, a146
    v_accvgpr_read_b32 v47, a147
    v_mul_f32 v40, v25, v40
    v_mul_f32 v41, v25, v41
    v_mul_f32 v42, v25, v42
    v_mul_f32 v43, v25, v43
    v_mul_f32 v44, v25, v44
    v_mul_f32 v45, v25, v45
    v_mul_f32 v46, v25, v46
    v_mul_f32 v47, v25, v47
    v_cvt_pk_bf16_f32 v204, v40, v41
    v_cvt_pk_bf16_f32 v205, v42, v43
    v_cvt_pk_bf16_f32 v206, v44, v45
    v_cvt_pk_bf16_f32 v207, v46, v47
    s_mov_b32 s14, 134144
    buffer_store_dwordx4 v[204:207], v29, s[32:35], s14 offen sc1
    v_accvgpr_read_b32 v48, a128
    v_accvgpr_read_b32 v49, a129
    v_accvgpr_read_b32 v50, a130
    v_accvgpr_read_b32 v51, a131
    v_accvgpr_read_b32 v52, a148
    v_accvgpr_read_b32 v53, a149
    v_accvgpr_read_b32 v54, a150
    v_accvgpr_read_b32 v55, a151
    v_mul_f32 v48, v26, v48
    v_mul_f32 v49, v26, v49
    v_mul_f32 v50, v26, v50
    v_mul_f32 v51, v26, v51
    v_mul_f32 v52, v26, v52
    v_mul_f32 v53, v26, v53
    v_mul_f32 v54, v26, v54
    v_mul_f32 v55, v26, v55
    v_cvt_pk_bf16_f32 v220, v48, v49
    v_cvt_pk_bf16_f32 v221, v50, v51
    v_cvt_pk_bf16_f32 v222, v52, v53
    v_cvt_pk_bf16_f32 v223, v54, v55
    s_mov_b32 s14, 265216
    buffer_store_dwordx4 v[220:223], v29, s[32:35], s14 offen sc1
    v_accvgpr_read_b32 v32, a132
    v_accvgpr_read_b32 v33, a133
    v_accvgpr_read_b32 v34, a134
    v_accvgpr_read_b32 v35, a135
    v_accvgpr_read_b32 v36, a152
    v_accvgpr_read_b32 v37, a153
    v_accvgpr_read_b32 v38, a154
    v_accvgpr_read_b32 v39, a155
    v_mul_f32 v32, v27, v32
    v_mul_f32 v33, v27, v33
    v_mul_f32 v34, v27, v34
    v_mul_f32 v35, v27, v35
    v_mul_f32 v36, v27, v36
    v_mul_f32 v37, v27, v37
    v_mul_f32 v38, v27, v38
    v_mul_f32 v39, v27, v39
    v_cvt_pk_bf16_f32 v236, v32, v33
    v_cvt_pk_bf16_f32 v237, v34, v35
    v_cvt_pk_bf16_f32 v238, v36, v37
    v_cvt_pk_bf16_f32 v239, v38, v39
    s_mov_b32 s14, 396288
    buffer_store_dwordx4 v[236:239], v29, s[32:35], s14 offen sc1
    v_accvgpr_read_b32 v40, a136
    v_accvgpr_read_b32 v41, a137
    v_accvgpr_read_b32 v42, a138
    v_accvgpr_read_b32 v43, a139
    v_accvgpr_read_b32 v44, a156
    v_accvgpr_read_b32 v45, a157
    v_accvgpr_read_b32 v46, a158
    v_accvgpr_read_b32 v47, a159
    v_mul_f32 v40, v28, v40
    v_mul_f32 v41, v28, v41
    v_mul_f32 v42, v28, v42
    v_mul_f32 v43, v28, v43
    v_mul_f32 v44, v28, v44
    v_mul_f32 v45, v28, v45
    v_mul_f32 v46, v28, v46
    v_mul_f32 v47, v28, v47
    v_cvt_pk_bf16_f32 v252, v40, v41
    v_cvt_pk_bf16_f32 v253, v42, v43
    v_cvt_pk_bf16_f32 v254, v44, v45
    v_cvt_pk_bf16_f32 v255, v46, v47
    s_mov_b32 s14, 527360
    buffer_store_dwordx4 v[252:255], v29, s[32:35], s14 offen sc1
    v_mov_b32 v20, 0
    v_mov_b32 v21, 0
    v_mov_b32 v22, 0
    v_mov_b32 v23, 0
    s_nop 1
    v_mfma_f32_32x32x16_bf16 a[0:15], v[20:23], v[20:23], 0
    v_mfma_f32_32x32x16_bf16 a[16:31], v[20:23], v[20:23], 0
    v_mfma_f32_32x32x16_bf16 a[32:47], v[20:23], v[20:23], 0
    v_mfma_f32_32x32x16_bf16 a[48:63], v[20:23], v[20:23], 0
    v_mfma_f32_32x32x16_bf16 a[64:79], v[20:23], v[20:23], 0
    v_mfma_f32_32x32x16_bf16 a[80:95], v[20:23], v[20:23], 0
    v_mfma_f32_32x32x16_bf16 a[96:111], v[20:23], v[20:23], 0
    v_mfma_f32_32x32x16_bf16 a[112:127], v[20:23], v[20:23], 0
    v_mfma_f32_32x32x16_bf16 a[128:143], v[20:23], v[20:23], 0
    v_mfma_f32_32x32x16_bf16 a[144:159], v[20:23], v[20:23], 0
    v_mfma_f32_32x32x16_bf16 a[160:175], v[20:23], v[20:23], 0
    v_accvgpr_write_b32 a176, 0
    v_accvgpr_write_b32 a177, 0
    v_accvgpr_write_b32 a178, 0
    v_accvgpr_write_b32 a179, 0
    s_waitcnt vmcnt(10)
    s_barrier
    s_cmp_lg_u32 s36, 0
    s_cbranch_scc1 P2_SIG_a1
    s_add_u32 s48, s52, 0
    v_mov_b32 v19, 0
    v_mov_b32 v20, s99
    s_mov_b64 s[14:15], exec
    s_mov_b64 exec, 1
    buffer_store_dword v20, v19, s[92:95], s48 offen sc1
    s_mov_b64 exec, s[14:15]
P2_SIG_a1:
    v_mov_b32 v13, v17
    v_mov_b32 v14, v18
    v_and_b32 v30, 3, v1
    s_add_u32 s49, s40, 1
    s_and_b32 s49, s49, 3
    v_mov_b32 v31, s49
    v_cmp_eq_u32 vcc, s40, v30
    s_nop 1
    v_cndmask_b32 v30, v30, v31, vcc
    v_lshlrev_b32 v30, 7, v30
    ds_read_b64_tr_b16 a[180:181], v13 offset:0
    ds_read_b64_tr_b16 a[182:183], v13 offset:5120
    ds_read_b64_tr_b16 a[184:185], v14 offset:32
    ds_read_b64_tr_b16 a[186:187], v14 offset:5152
    ds_read_b64_tr_b16 a[188:189], v13 offset:64
    ds_read_b64_tr_b16 a[190:191], v13 offset:5184
    ds_read_b64_tr_b16 a[192:193], v14 offset:96
    ds_read_b64_tr_b16 a[194:195], v14 offset:5216
    ds_read_b64_tr_b16 a[196:197], v13 offset:128
    ds_read_b64_tr_b16 a[198:199], v13 offset:5248
    ds_read_b64_tr_b16 a[200:201], v14 offset:160
    ds_read_b64_tr_b16 a[202:203], v14 offset:5280
    ds_read_b64_tr_b16 a[204:205], v13 offset:192
    ds_read_b64_tr_b16 a[206:207], v13 offset:5312
    ds_read_b64_tr_b16 a[208:209], v14 offset:224
    ds_read_b64_tr_b16 a[210:211], v14 offset:5344
    ds_read_b64_tr_b16 a[212:213], v13 offset:256
    ds_read_b64_tr_b16 a[214:215], v13 offset:5376
    s_waitcnt lgkmcnt(0)
    v_mfma_f32_16x16x32_bf16 a[0:3], a[180:183], v[176:179], a[0:3]
    s_add_u32 s48, s40, 1
    s_and_b32 s48, s48, 3
    v_mfma_f32_16x16x32_bf16 a[4:7], a[180:183], v[192:195], a[4:7]
    ds_read_b64_tr_b16 a[216:217], v13 offset:10240
    v_mfma_f32_16x16x32_bf16 a[8:11], a[180:183], v[208:211], a[8:11]
    s_lshl_b32 s48, s48, 3
    s_add_u32 s48, s48, s57
    v_mfma_f32_16x16x32_bf16 a[12:15], a[180:183], v[224:227], a[12:15]
    ds_read_b64_tr_b16 a[218:219], v13 offset:15360
    v_mfma_f32_16x16x32_bf16 a[16:19], a[180:183], v[240:243], a[16:19]
    s_add_u32 s48, s48, 0
    s_lshl_b32 s45, s48, 10
    v_mfma_f32_16x16x32_bf16 a[20:23], a[184:187], v[176:179], a[20:23]
    ds_read_b64_tr_b16 a[220:221], v14 offset:10272
    v_mfma_f32_16x16x32_bf16 a[24:27], a[184:187], v[192:195], a[24:27]
    s_add_u32 s48, s48, s42
    s_mul_i32 s46, s48, 36864
    v_mfma_f32_16x16x32_bf16 a[28:31], a[184:187], v[208:211], a[28:31]
    ds_read_b64_tr_b16 a[222:223], v14 offset:15392
    v_mfma_f32_16x16x32_bf16 a[32:35], a[184:187], v[224:227], a[32:35]
    v_mfma_f32_16x16x32_bf16 a[36:39], a[184:187], v[240:243], a[36:39]
    ds_read_b64_tr_b16 a[224:225], v13 offset:10304
    v_mfma_f32_16x16x32_bf16 a[40:43], a[188:191], v[176:179], a[40:43]
    v_mfma_f32_16x16x32_bf16 a[44:47], a[188:191], v[192:195], a[44:47]
    ds_read_b64_tr_b16 a[226:227], v13 offset:15424
    v_mfma_f32_16x16x32_bf16 a[48:51], a[188:191], v[208:211], a[48:51]
    s_add_u32 m0, s47, 81920
    v_mfma_f32_16x16x32_bf16 a[52:55], a[188:191], v[224:227], a[52:55]
    ds_read_b64_tr_b16 a[228:229], v14 offset:10336
    buffer_load_dwordx4 v2, s[20:23], s46 offen offset:0 lds
    v_mfma_f32_16x16x32_bf16 a[56:59], a[188:191], v[240:243], a[56:59]
    v_mfma_f32_16x16x32_bf16 a[60:63], a[192:195], v[176:179], a[60:63]
    ds_read_b64_tr_b16 a[230:231], v14 offset:15456
    v_mfma_f32_16x16x32_bf16 a[64:67], a[192:195], v[192:195], a[64:67]
    buffer_load_dwordx4 v3, s[20:23], s46 offen offset:1024 lds
    v_mfma_f32_16x16x32_bf16 a[68:71], a[192:195], v[208:211], a[68:71]
    ds_read_b64_tr_b16 a[232:233], v13 offset:10368
    v_mfma_f32_16x16x32_bf16 a[72:75], a[192:195], v[224:227], a[72:75]
    v_mfma_f32_16x16x32_bf16 a[76:79], a[192:195], v[240:243], a[76:79]
    ds_read_b64_tr_b16 a[234:235], v13 offset:15488
    buffer_load_dwordx4 v4, s[20:23], s46 offen offset:2048 lds
    v_mfma_f32_16x16x32_bf16 a[80:83], a[196:199], v[176:179], a[80:83]
    v_mfma_f32_16x16x32_bf16 a[84:87], a[196:199], v[192:195], a[84:87]
    ds_read_b64_tr_b16 a[236:237], v14 offset:10400
    v_mfma_f32_16x16x32_bf16 a[88:91], a[196:199], v[208:211], a[88:91]
    buffer_load_dwordx4 v5, s[20:23], s46 offen offset:3072 lds
    v_mfma_f32_16x16x32_bf16 a[92:95], a[196:199], v[224:227], a[92:95]
    ds_read_b64_tr_b16 a[238:239], v14 offset:15520
    v_mfma_f32_16x16x32_bf16 a[96:99], a[196:199], v[240:243], a[96:99]
    s_add_u32 m0, s47, 86016
    v_mfma_f32_16x16x32_bf16 a[100:103], a[200:203], v[176:179], a[100:103]
    ds_read_b64_tr_b16 a[240:241], v13 offset:10432
    buffer_load_dwordx4 v6, s[20:23], s46 offen offset:0 lds
    v_mfma_f32_16x16x32_bf16 a[104:107], a[200:203], v[192:195], a[104:107]
    v_mfma_f32_16x16x32_bf16 a[108:111], a[200:203], v[208:211], a[108:111]
    ds_read_b64_tr_b16 a[242:243], v13 offset:15552
    v_mfma_f32_16x16x32_bf16 a[112:115], a[200:203], v[224:227], a[112:115]
    buffer_load_dwordx4 v7, s[20:23], s46 offen offset:1024 lds
    v_mfma_f32_16x16x32_bf16 a[116:119], a[200:203], v[240:243], a[116:119]
    ds_read_b64_tr_b16 a[244:245], v14 offset:10464
    v_mfma_f32_16x16x32_bf16 a[120:123], a[204:207], v[176:179], a[120:123]
    v_mfma_f32_16x16x32_bf16 a[124:127], a[204:207], v[192:195], a[124:127]
    ds_read_b64_tr_b16 a[246:247], v14 offset:15584
    buffer_load_dwordx4 v8, s[20:23], s46 offen offset:2048 lds
    v_mfma_f32_16x16x32_bf16 a[128:131], a[204:207], v[208:211], a[128:131]
    v_mfma_f32_16x16x32_bf16 a[132:135], a[204:207], v[224:227], a[132:135]
    ds_read_b64_tr_b16 a[248:249], v13 offset:10496
    v_mfma_f32_16x16x32_bf16 a[136:139], a[204:207], v[240:243], a[136:139]
    buffer_load_dwordx4 v9, s[20:23], s46 offen offset:3072 lds
    v_mfma_f32_16x16x32_bf16 a[140:143], a[208:211], v[176:179], a[140:143]
    ds_read_b64_tr_b16 a[250:251], v13 offset:15616
    v_mfma_f32_16x16x32_bf16 a[144:147], a[208:211], v[192:195], a[144:147]
    s_add_u32 m0, s47, 90112
    v_mfma_f32_16x16x32_bf16 a[148:151], a[208:211], v[208:211], a[148:151]
    buffer_load_dwordx4 v10, s[20:23], s46 offen offset:0 lds
    v_mfma_f32_16x16x32_bf16 a[152:155], a[208:211], v[224:227], a[152:155]
    v_mfma_f32_16x16x32_bf16 a[156:159], a[208:211], v[240:243], a[156:159]
    v_mfma_f32_16x16x32_bf16 a[160:163], a[212:215], v[176:179], a[160:163]
    buffer_load_dwordx4 v11, s[20:23], s46 offen offset:1024 lds
    v_mfma_f32_16x16x32_bf16 a[164:167], a[212:215], v[192:195], a[164:167]
    v_mfma_f32_16x16x32_bf16 a[168:171], a[212:215], v[208:211], a[168:171]
    s_mov_b32 s54, s45
    v_mfma_f32_16x16x32_bf16 a[172:175], a[212:215], v[224:227], a[172:175]
    v_mfma_f32_16x16x32_bf16 a[176:179], a[212:215], v[240:243], a[176:179]
    s_waitcnt vmcnt(10) lgkmcnt(0)
    s_barrier
    s_cmp_lg_u32 s36, 0
    s_cbranch_scc1 P2_SIG_a
    s_add_u32 s48, s52, 65536
    v_mov_b32 v19, 0
    v_mov_b32 v20, s99
    s_mov_b64 s[14:15], exec
    s_mov_b64 exec, 1
    buffer_store_dword v20, v19, s[92:95], s48 offen sc1
    s_mov_b64 exec, s[14:15]
P2_SIG_a:
    v_add_u32 v15, 40960, v17
    v_add_u32 v16, 40960, v18
    v_mfma_f32_16x16x32_bf16 a[0:3], a[216:219], v[180:183], a[0:3]
    v_mfma_f32_16x16x32_bf16 a[4:7], a[216:219], v[196:199], a[4:7]
    ds_read_b64_tr_b16 a[180:181], v15 offset:0
    v_mfma_f32_16x16x32_bf16 a[8:11], a[216:219], v[212:215], a[8:11]
    v_mfma_f32_16x16x32_bf16 a[12:15], a[216:219], v[228:231], a[12:15]
    ds_read_b64_tr_b16 a[182:183], v15 offset:5120
    v_mfma_f32_16x16x32_bf16 a[16:19], a[216:219], v[244:247], a[16:19]
    v_mfma_f32_16x16x32_bf16 a[20:23], a[220:223], v[180:183], a[20:23]
    ds_read_b64_tr_b16 a[184:185], v16 offset:32
    v_mfma_f32_16x16x32_bf16 a[24:27], a[220:223], v[196:199], a[24:27]
    v_mfma_f32_16x16x32_bf16 a[28:31], a[220:223], v[212:215], a[28:31]
    ds_read_b64_tr_b16 a[186:187], v16 offset:5152
    v_mfma_f32_16x16x32_bf16 a[32:35], a[220:223], v[228:231], a[32:35]
    v_mfma_f32_16x16x32_bf16 a[36:39], a[220:223], v[244:247], a[36:39]
    ds_read_b64_tr_b16 a[188:189], v15 offset:64
    v_mfma_f32_16x16x32_bf16 a[40:43], a[224:227], v[180:183], a[40:43]
    v_mfma_f32_16x16x32_bf16 a[44:47], a[224:227], v[196:199], a[44:47]
    ds_read_b64_tr_b16 a[190:191], v15 offset:5184
    v_mfma_f32_16x16x32_bf16 a[48:51], a[224:227], v[212:215], a[48:51]
    v_mfma_f32_16x16x32_bf16 a[52:55], a[224:227], v[228:231], a[52:55]
    ds_read_b64_tr_b16 a[192:193], v16 offset:96
    v_mfma_f32_16x16x32_bf16 a[56:59], a[224:227], v[244:247], a[56:59]
    v_mfma_f32_16x16x32_bf16 a[60:63], a[228:231], v[180:183], a[60:63]
    ds_read_b64_tr_b16 a[194:195], v16 offset:5216
    v_mfma_f32_16x16x32_bf16 a[64:67], a[228:231], v[196:199], a[64:67]
    v_mfma_f32_16x16x32_bf16 a[68:71], a[228:231], v[212:215], a[68:71]
    ds_read_b64_tr_b16 a[196:197], v15 offset:128
    v_mfma_f32_16x16x32_bf16 a[72:75], a[228:231], v[228:231], a[72:75]
    v_mfma_f32_16x16x32_bf16 a[76:79], a[228:231], v[244:247], a[76:79]
    ds_read_b64_tr_b16 a[198:199], v15 offset:5248
    v_mfma_f32_16x16x32_bf16 a[80:83], a[232:235], v[180:183], a[80:83]
    v_mfma_f32_16x16x32_bf16 a[84:87], a[232:235], v[196:199], a[84:87]
    ds_read_b64_tr_b16 a[200:201], v16 offset:160
    v_mfma_f32_16x16x32_bf16 a[88:91], a[232:235], v[212:215], a[88:91]
    v_mfma_f32_16x16x32_bf16 a[92:95], a[232:235], v[228:231], a[92:95]
    ds_read_b64_tr_b16 a[202:203], v16 offset:5280
    v_mfma_f32_16x16x32_bf16 a[96:99], a[232:235], v[244:247], a[96:99]
    v_mfma_f32_16x16x32_bf16 a[100:103], a[236:239], v[180:183], a[100:103]
    ds_read_b64_tr_b16 a[204:205], v15 offset:192
    v_mfma_f32_16x16x32_bf16 a[104:107], a[236:239], v[196:199], a[104:107]
    v_mfma_f32_16x16x32_bf16 a[108:111], a[236:239], v[212:215], a[108:111]
    ds_read_b64_tr_b16 a[206:207], v15 offset:5312
    v_mfma_f32_16x16x32_bf16 a[112:115], a[236:239], v[228:231], a[112:115]
    v_mfma_f32_16x16x32_bf16 a[116:119], a[236:239], v[244:247], a[116:119]
    ds_read_b64_tr_b16 a[208:209], v16 offset:224
    v_mfma_f32_16x16x32_bf16 a[120:123], a[240:243], v[180:183], a[120:123]
    v_mfma_f32_16x16x32_bf16 a[124:127], a[240:243], v[196:199], a[124:127]
    ds_read_b64_tr_b16 a[210:211], v16 offset:5344
    v_mfma_f32_16x16x32_bf16 a[128:131], a[240:243], v[212:215], a[128:131]
    v_mfma_f32_16x16x32_bf16 a[132:135], a[240:243], v[228:231], a[132:135]
    ds_read_b64_tr_b16 a[212:213], v15 offset:256
    v_mfma_f32_16x16x32_bf16 a[136:139], a[240:243], v[244:247], a[136:139]
    v_mfma_f32_16x16x32_bf16 a[140:143], a[244:247], v[180:183], a[140:143]
    ds_read_b64_tr_b16 a[214:215], v15 offset:5376
    v_mfma_f32_16x16x32_bf16 a[144:147], a[244:247], v[196:199], a[144:147]
    v_mfma_f32_16x16x32_bf16 a[148:151], a[244:247], v[212:215], a[148:151]
    v_mfma_f32_16x16x32_bf16 a[152:155], a[244:247], v[228:231], a[152:155]
    v_mfma_f32_16x16x32_bf16 a[156:159], a[244:247], v[244:247], a[156:159]
    v_mfma_f32_16x16x32_bf16 a[160:163], a[248:251], v[180:183], a[160:163]
    v_mfma_f32_16x16x32_bf16 a[164:167], a[248:251], v[196:199], a[164:167]
    v_mfma_f32_16x16x32_bf16 a[168:171], a[248:251], v[212:215], a[168:171]
    v_mfma_f32_16x16x32_bf16 a[172:175], a[248:251], v[228:231], a[172:175]
    v_mfma_f32_16x16x32_bf16 a[176:179], a[248:251], v[244:247], a[176:179]
    v_mov_b32 v13, v15
    v_mov_b32 v14, v16
    s_cmp_lg_u32 s36, 0
    s_cbranch_scc1 P2_POLLED_a
    v_and_b32 v19, 3, v1
    s_add_u32 s49, s40, 1
    s_and_b32 s49, s49, 3
    v_mov_b32 v20, s49
    v_cmp_eq_u32 vcc, s40, v19
    s_nop 1
    v_cndmask_b32 v19, v19, v20, vcc
    s_lshl_b32 s48, s41, 9
    s_add_u32 s48, s48, s53
    s_add_u32 s48, s48, 0
    v_lshlrev_b32 v19, 7, v19
    s_mov_b32 s51, 0x40000
P2_POLL_a:
    buffer_load_dword v20, v19, s[92:95], s48 offen sc1
    s_waitcnt vmcnt(0)
    v_cmp_ne_u32 vcc, s99, v20
    s_nop 4
    s_cbranch_vccz P2_POLLED_a
    s_sub_u32 s51, s51, 1
    s_cmp_eq_u32 s51, 0
    s_cbranch_scc1 P2_POLLED_a
    s_sleep 1
    s_branch P2_POLL_a
P2_POLLED_a:
    s_barrier
    s_mov_b32 s45, s54
    s_add_u32 s50, s45, 0
    buffer_load_dwordx4 v[136:139], v12, s[16:19], s50 offen sc1
    s_add_u32 s50, s45, 131072
    buffer_load_dwordx4 v[140:143], v12, s[16:19], s50 offen sc1
    s_add_u32 s50, s45, 262144
    buffer_load_dwordx4 v[144:147], v12, s[16:19], s50 offen sc1
    s_add_u32 s50, s45, 393216
    buffer_load_dwordx4 v[148:151], v12, s[16:19], s50 offen sc1
    s_add_u32 s50, s45, 524288
    buffer_load_dwordx4 v[152:155], v12, s[16:19], s50 offen sc1
    s_add_u32 s50, s45, 1024
    buffer_load_dwordx4 v[156:159], v12, s[16:19], s50 offen sc1
    s_add_u32 s50, s45, 132096
    buffer_load_dwordx4 v[160:163], v12, s[16:19], s50 offen sc1
    s_add_u32 s50, s45, 263168
    buffer_load_dwordx4 v[164:167], v12, s[16:19], s50 offen sc1
    s_add_u32 s50, s45, 394240
    buffer_load_dwordx4 v[168:171], v12, s[16:19], s50 offen sc1
    s_add_u32 s50, s45, 525312
    buffer_load_dwordx4 v[172:175], v12, s[16:19], s50 offen sc1
    s_waitcnt lgkmcnt(0)
    v_mfma_f32_16x16x32_bf16 a[0:3], a[180:183], v[184:187], a[0:3]
    s_add_u32 s48, s40, 2
    s_and_b32 s48, s48, 3
    v_mfma_f32_16x16x32_bf16 a[4:7], a[180:183], v[200:203], a[4:7]
    ds_read_b64_tr_b16 a[216:217], v13 offset:10240
    v_mfma_f32_16x16x32_bf16 a[8:11], a[180:183], v[216:219], a[8:11]
    s_lshl_b32 s48, s48, 3
    s_add_u32 s48, s48, s57
    v_mfma_f32_16x16x32_bf16 a[12:15], a[180:183], v[232:235], a[12:15]
    ds_read_b64_tr_b16 a[218:219], v13 offset:15360
    v_mfma_f32_16x16x32_bf16 a[16:19], a[180:183], v[248:251], a[16:19]
    s_add_u32 s48, s48, 0
    s_lshl_b32 s45, s48, 10
    v_mfma_f32_16x16x32_bf16 a[20:23], a[184:187], v[184:187], a[20:23]
    ds_read_b64_tr_b16 a[220:221], v14 offset:10272
    v_mfma_f32_16x16x32_bf16 a[24:27], a[184:187], v[200:203], a[24:27]
    s_add_u32 s48, s48, s42
    s_mul_i32 s46, s48, 36864
    v_mfma_f32_16x16x32_bf16 a[28:31], a[184:187], v[216:219], a[28:31]
    ds_read_b64_tr_b16 a[222:223], v14 offset:15392
    v_mfma_f32_16x16x32_bf16 a[32:35], a[184:187], v[232:235], a[32:35]
    v_mfma_f32_16x16x32_bf16 a[36:39], a[184:187], v[248:251], a[36:39]
    ds_read_b64_tr_b16 a[224:225], v13 offset:10304
    v_mfma_f32_16x16x32_bf16 a[40:43], a[188:191], v[184:187], a[40:43]
    v_mfma_f32_16x16x32_bf16 a[44:47], a[188:191], v[200:203], a[44:47]
    ds_read_b64_tr_b16 a[226:227], v13 offset:15424
    v_mfma_f32_16x16x32_bf16 a[48:51], a[188:191], v[216:219], a[48:51]
    s_add_u32 m0, s47, 0
    v_mfma_f32_16x16x32_bf16 a[52:55], a[188:191], v[232:235], a[52:55]
    ds_read_b64_tr_b16 a[228:229], v14 offset:10336
    buffer_load_dwordx4 v2, s[20:23], s46 offen offset:0 lds
    v_mfma_f32_16x16x32_bf16 a[56:59], a[188:191], v[248:251], a[56:59]
    v_mfma_f32_16x16x32_bf16 a[60:63], a[192:195], v[184:187], a[60:63]
    ds_read_b64_tr_b16 a[230:231], v14 offset:15456
    v_mfma_f32_16x16x32_bf16 a[64:67], a[192:195], v[200:203], a[64:67]
    buffer_load_dwordx4 v3, s[20:23], s46 offen offset:1024 lds
    v_mfma_f32_16x16x32_bf16 a[68:71], a[192:195], v[216:219], a[68:71]
    ds_read_b64_tr_b16 a[232:233], v13 offset:10368
    v_mfma_f32_16x16x32_bf16 a[72:75], a[192:195], v[232:235], a[72:75]
    v_mfma_f32_16x16x32_bf16 a[76:79], a[192:195], v[248:251], a[76:79]
    ds_read_b64_tr_b16 a[234:235], v13 offset:15488
    buffer_load_dwordx4 v4, s[20:23], s46 offen offset:2048 lds
    v_mfma_f32_16x16x32_bf16 a[80:83], a[196:199], v[184:187], a[80:83]
    v_mfma_f32_16x16x32_bf16 a[84:87], a[196:199], v[200:203], a[84:87]
    ds_read_b64_tr_b16 a[236:237], v14 offset:10400
    v_mfma_f32_16x16x32_bf16 a[88:91], a[196:199], v[216:219], a[88:91]
    buffer_load_dwordx4 v5, s[20:23], s46 offen offset:3072 lds
    v_mfma_f32_16x16x32_bf16 a[92:95], a[196:199], v[232:235], a[92:95]
    ds_read_b64_tr_b16 a[238:239], v14 offset:15520
    v_mfma_f32_16x16x32_bf16 a[96:99], a[196:199], v[248:251], a[96:99]
    s_add_u32 m0, s47, 4096
    v_mfma_f32_16x16x32_bf16 a[100:103], a[200:203], v[184:187], a[100:103]
    ds_read_b64_tr_b16 a[240:241], v13 offset:10432
    buffer_load_dwordx4 v6, s[20:23], s46 offen offset:0 lds
    v_mfma_f32_16x16x32_bf16 a[104:107], a[200:203], v[200:203], a[104:107]
    v_mfma_f32_16x16x32_bf16 a[108:111], a[200:203], v[216:219], a[108:111]
    ds_read_b64_tr_b16 a[242:243], v13 offset:15552
    v_mfma_f32_16x16x32_bf16 a[112:115], a[200:203], v[232:235], a[112:115]
    buffer_load_dwordx4 v7, s[20:23], s46 offen offset:1024 lds
    v_mfma_f32_16x16x32_bf16 a[116:119], a[200:203], v[248:251], a[116:119]
    ds_read_b64_tr_b16 a[244:245], v14 offset:10464
    v_mfma_f32_16x16x32_bf16 a[120:123], a[204:207], v[184:187], a[120:123]
    v_mfma_f32_16x16x32_bf16 a[124:127], a[204:207], v[200:203], a[124:127]
    ds_read_b64_tr_b16 a[246:247], v14 offset:15584
    buffer_load_dwordx4 v8, s[20:23], s46 offen offset:2048 lds
    v_mfma_f32_16x16x32_bf16 a[128:131], a[204:207], v[216:219], a[128:131]
    v_mfma_f32_16x16x32_bf16 a[132:135], a[204:207], v[232:235], a[132:135]
    ds_read_b64_tr_b16 a[248:249], v13 offset:10496
    v_mfma_f32_16x16x32_bf16 a[136:139], a[204:207], v[248:251], a[136:139]
    buffer_load_dwordx4 v9, s[20:23], s46 offen offset:3072 lds
    v_mfma_f32_16x16x32_bf16 a[140:143], a[208:211], v[184:187], a[140:143]
    ds_read_b64_tr_b16 a[250:251], v13 offset:15616
    v_mfma_f32_16x16x32_bf16 a[144:147], a[208:211], v[200:203], a[144:147]
    s_add_u32 m0, s47, 8192
    v_mfma_f32_16x16x32_bf16 a[148:151], a[208:211], v[216:219], a[148:151]
    buffer_load_dwordx4 v10, s[20:23], s46 offen offset:0 lds
    v_mfma_f32_16x16x32_bf16 a[152:155], a[208:211], v[232:235], a[152:155]
    v_mfma_f32_16x16x32_bf16 a[156:159], a[208:211], v[248:251], a[156:159]
    v_mfma_f32_16x16x32_bf16 a[160:163], a[212:215], v[184:187], a[160:163]
    buffer_load_dwordx4 v11, s[20:23], s46 offen offset:1024 lds
    v_mfma_f32_16x16x32_bf16 a[164:167], a[212:215], v[200:203], a[164:167]
    v_mfma_f32_16x16x32_bf16 a[168:171], a[212:215], v[216:219], a[168:171]
    s_mov_b32 s55, s45
    v_mfma_f32_16x16x32_bf16 a[172:175], a[212:215], v[232:235], a[172:175]
    v_mfma_f32_16x16x32_bf16 a[176:179], a[212:215], v[248:251], a[176:179]
    s_waitcnt vmcnt(20) lgkmcnt(0)
    s_barrier
    v_add_u32 v15, 81920, v17
    v_add_u32 v16, 81920, v18
    v_mfma_f32_16x16x32_bf16 a[0:3], a[216:219], v[188:191], a[0:3]
    v_mfma_f32_16x16x32_bf16 a[4:7], a[216:219], v[204:207], a[4:7]
    ds_read_b64_tr_b16 a[180:181], v15 offset:0
    v_mfma_f32_16x16x32_bf16 a[8:11], a[216:219], v[220:223], a[8:11]
    v_mfma_f32_16x16x32_bf16 a[12:15], a[216:219], v[236:239], a[12:15]
    ds_read_b64_tr_b16 a[182:183], v15 offset:5120
    v_mfma_f32_16x16x32_bf16 a[16:19], a[216:219], v[252:255], a[16:19]
    v_mfma_f32_16x16x32_bf16 a[20:23], a[220:223], v[188:191], a[20:23]
    ds_read_b64_tr_b16 a[184:185], v16 offset:32
    v_mfma_f32_16x16x32_bf16 a[24:27], a[220:223], v[204:207], a[24:27]
    v_mfma_f32_16x16x32_bf16 a[28:31], a[220:223], v[220:223], a[28:31]
    ds_read_b64_tr_b16 a[186:187], v16 offset:5152
    v_mfma_f32_16x16x32_bf16 a[32:35], a[220:223], v[236:239], a[32:35]
    v_mfma_f32_16x16x32_bf16 a[36:39], a[220:223], v[252:255], a[36:39]
    ds_read_b64_tr_b16 a[188:189], v15 offset:64
    v_mfma_f32_16x16x32_bf16 a[40:43], a[224:227], v[188:191], a[40:43]
    v_mfma_f32_16x16x32_bf16 a[44:47], a[224:227], v[204:207], a[44:47]
    ds_read_b64_tr_b16 a[190:191], v15 offset:5184
    v_mfma_f32_16x16x32_bf16 a[48:51], a[224:227], v[220:223], a[48:51]
    v_mfma_f32_16x16x32_bf16 a[52:55], a[224:227], v[236:239], a[52:55]
    ds_read_b64_tr_b16 a[192:193], v16 offset:96
    v_mfma_f32_16x16x32_bf16 a[56:59], a[224:227], v[252:255], a[56:59]
    v_mfma_f32_16x16x32_bf16 a[60:63], a[228:231], v[188:191], a[60:63]
    ds_read_b64_tr_b16 a[194:195], v16 offset:5216
    v_mfma_f32_16x16x32_bf16 a[64:67], a[228:231], v[204:207], a[64:67]
    v_mfma_f32_16x16x32_bf16 a[68:71], a[228:231], v[220:223], a[68:71]
    ds_read_b64_tr_b16 a[196:197], v15 offset:128
    v_mfma_f32_16x16x32_bf16 a[72:75], a[228:231], v[236:239], a[72:75]
    v_mfma_f32_16x16x32_bf16 a[76:79], a[228:231], v[252:255], a[76:79]
    ds_read_b64_tr_b16 a[198:199], v15 offset:5248
    v_mfma_f32_16x16x32_bf16 a[80:83], a[232:235], v[188:191], a[80:83]
    v_mfma_f32_16x16x32_bf16 a[84:87], a[232:235], v[204:207], a[84:87]
    ds_read_b64_tr_b16 a[200:201], v16 offset:160
    v_mfma_f32_16x16x32_bf16 a[88:91], a[232:235], v[220:223], a[88:91]
    v_mfma_f32_16x16x32_bf16 a[92:95], a[232:235], v[236:239], a[92:95]
    ds_read_b64_tr_b16 a[202:203], v16 offset:5280
    v_mfma_f32_16x16x32_bf16 a[96:99], a[232:235], v[252:255], a[96:99]
    v_mfma_f32_16x16x32_bf16 a[100:103], a[236:239], v[188:191], a[100:103]
    ds_read_b64_tr_b16 a[204:205], v15 offset:192
    v_mfma_f32_16x16x32_bf16 a[104:107], a[236:239], v[204:207], a[104:107]
    v_mfma_f32_16x16x32_bf16 a[108:111], a[236:239], v[220:223], a[108:111]
    ds_read_b64_tr_b16 a[206:207], v15 offset:5312
    v_mfma_f32_16x16x32_bf16 a[112:115], a[236:239], v[236:239], a[112:115]
    v_mfma_f32_16x16x32_bf16 a[116:119], a[236:239], v[252:255], a[116:119]
    ds_read_b64_tr_b16 a[208:209], v16 offset:224
    v_mfma_f32_16x16x32_bf16 a[120:123], a[240:243], v[188:191], a[120:123]
    v_mfma_f32_16x16x32_bf16 a[124:127], a[240:243], v[204:207], a[124:127]
    ds_read_b64_tr_b16 a[210:211], v16 offset:5344
    v_mfma_f32_16x16x32_bf16 a[128:131], a[240:243], v[220:223], a[128:131]
    v_mfma_f32_16x16x32_bf16 a[132:135], a[240:243], v[236:239], a[132:135]
    ds_read_b64_tr_b16 a[212:213], v15 offset:256
    v_mfma_f32_16x16x32_bf16 a[136:139], a[240:243], v[252:255], a[136:139]
    v_mfma_f32_16x16x32_bf16 a[140:143], a[244:247], v[188:191], a[140:143]
    ds_read_b64_tr_b16 a[214:215], v15 offset:5376
    v_mfma_f32_16x16x32_bf16 a[144:147], a[244:247], v[204:207], a[144:147]
    v_mfma_f32_16x16x32_bf16 a[148:151], a[244:247], v[220:223], a[148:151]
    v_mfma_f32_16x16x32_bf16 a[152:155], a[244:247], v[236:239], a[152:155]
    v_mfma_f32_16x16x32_bf16 a[156:159], a[244:247], v[252:255], a[156:159]
    v_mfma_f32_16x16x32_bf16 a[160:163], a[248:251], v[188:191], a[160:163]
    v_mfma_f32_16x16x32_bf16 a[164:167], a[248:251], v[204:207], a[164:167]
    v_mfma_f32_16x16x32_bf16 a[168:171], a[248:251], v[220:223], a[168:171]
    v_mfma_f32_16x16x32_bf16 a[172:175], a[248:251], v[236:239], a[172:175]
    v_mfma_f32_16x16x32_bf16 a[176:179], a[248:251], v[252:255], a[176:179]
    v_mov_b32 v13, v15
    v_mov_b32 v14, v16
    s_mov_b32 s45, s55
    s_add_u32 s50, s45, 0
    buffer_load_dwordx4 v[56:59], v12, s[16:19], s50 offen sc1
    s_add_u32 s50, s45, 131072
    buffer_load_dwordx4 v[60:63], v12, s[16:19], s50 offen sc1
    s_add_u32 s50, s45, 262144
    buffer_load_dwordx4 v[64:67], v12, s[16:19], s50 offen sc1
    s_add_u32 s50, s45, 393216
    buffer_load_dwordx4 v[68:71], v12, s[16:19], s50 offen sc1
    s_add_u32 s50, s45, 524288
    buffer_load_dwordx4 v[72:75], v12, s[16:19], s50 offen sc1
    s_add_u32 s50, s45, 1024
    buffer_load_dwordx4 v[76:79], v12, s[16:19], s50 offen sc1
    s_add_u32 s50, s45, 132096
    buffer_load_dwordx4 v[80:83], v12, s[16:19], s50 offen sc1
    s_add_u32 s50, s45, 263168
    buffer_load_dwordx4 v[84:87], v12, s[16:19], s50 offen sc1
    s_add_u32 s50, s45, 394240
    buffer_load_dwordx4 v[88:91], v12, s[16:19], s50 offen sc1
    s_add_u32 s50, s45, 525312
    buffer_load_dwordx4 v[92:95], v12, s[16:19], s50 offen sc1
    s_waitcnt vmcnt(20) lgkmcnt(0)
    v_mfma_f32_16x16x32_bf16 a[0:3], a[180:183], v[136:139], a[0:3]
    s_add_u32 s48, s40, 3
    s_and_b32 s48, s48, 3
    v_mfma_f32_16x16x32_bf16 a[4:7], a[180:183], v[140:143], a[4:7]
    ds_read_b64_tr_b16 a[216:217], v13 offset:10240
    v_mfma_f32_16x16x32_bf16 a[8:11], a[180:183], v[144:147], a[8:11]
    s_lshl_b32 s48, s48, 3
    s_add_u32 s48, s48, s57
    v_mfma_f32_16x16x32_bf16 a[12:15], a[180:183], v[148:151], a[12:15]
    ds_read_b64_tr_b16 a[218:219], v13 offset:15360
    v_mfma_f32_16x16x32_bf16 a[16:19], a[180:183], v[152:155], a[16:19]
    s_add_u32 s48, s48, 0
    s_lshl_b32 s45, s48, 10
    v_mfma_f32_16x16x32_bf16 a[20:23], a[184:187], v[136:139], a[20:23]
    ds_read_b64_tr_b16 a[220:221], v14 offset:10272
    v_mfma_f32_16x16x32_bf16 a[24:27], a[184:187], v[140:143], a[24:27]
    s_add_u32 s48, s48, s42
    s_mul_i32 s46, s48, 36864
    v_mfma_f32_16x16x32_bf16 a[28:31], a[184:187], v[144:147], a[28:31]
    ds_read_b64_tr_b16 a[222:223], v14 offset:15392
    v_mfma_f32_16x16x32_bf16 a[32:35], a[184:187], v[148:151], a[32:35]
    v_mfma_f32_16x16x32_bf16 a[36:39], a[184:187], v[152:155], a[36:39]
    ds_read_b64_tr_b16 a[224:225], v13 offset:10304
    v_mfma_f32_16x16x32_bf16 a[40:43], a[188:191], v[136:139], a[40:43]
    v_mfma_f32_16x16x32_bf16 a[44:47], a[188:191], v[140:143], a[44:47]
    ds_read_b64_tr_b16 a[226:227], v13 offset:15424
    v_mfma_f32_16x16x32_bf16 a[48:51], a[188:191], v[144:147], a[48:51]
    s_add_u32 m0, s47, 40960
    v_mfma_f32_16x16x32_bf16 a[52:55], a[188:191], v[148:151], a[52:55]
    ds_read_b64_tr_b16 a[228:229], v14 offset:10336
    buffer_load_dwordx4 v2, s[20:23], s46 offen offset:0 lds
    v_mfma_f32_16x16x32_bf16 a[56:59], a[188:191], v[152:155], a[56:59]
    v_mfma_f32_16x16x32_bf16 a[60:63], a[192:195], v[136:139], a[60:63]
    ds_read_b64_tr_b16 a[230:231], v14 offset:15456
    v_mfma_f32_16x16x32_bf16 a[64:67], a[192:195], v[140:143], a[64:67]
    buffer_load_dwordx4 v3, s[20:23], s46 offen offset:1024 lds
    v_mfma_f32_16x16x32_bf16 a[68:71], a[192:195], v[144:147], a[68:71]
    ds_read_b64_tr_b16 a[232:233], v13 offset:10368
    v_mfma_f32_16x16x32_bf16 a[72:75], a[192:195], v[148:151], a[72:75]
    v_mfma_f32_16x16x32_bf16 a[76:79], a[192:195], v[152:155], a[76:79]
    ds_read_b64_tr_b16 a[234:235], v13 offset:15488
    buffer_load_dwordx4 v4, s[20:23], s46 offen offset:2048 lds
    v_mfma_f32_16x16x32_bf16 a[80:83], a[196:199], v[136:139], a[80:83]
    v_mfma_f32_16x16x32_bf16 a[84:87], a[196:199], v[140:143], a[84:87]
    ds_read_b64_tr_b16 a[236:237], v14 offset:10400
    v_mfma_f32_16x16x32_bf16 a[88:91], a[196:199], v[144:147], a[88:91]
    buffer_load_dwordx4 v5, s[20:23], s46 offen offset:3072 lds
    v_mfma_f32_16x16x32_bf16 a[92:95], a[196:199], v[148:151], a[92:95]
    ds_read_b64_tr_b16 a[238:239], v14 offset:15520
    v_mfma_f32_16x16x32_bf16 a[96:99], a[196:199], v[152:155], a[96:99]
    s_add_u32 m0, s47, 45056
    v_mfma_f32_16x16x32_bf16 a[100:103], a[200:203], v[136:139], a[100:103]
    ds_read_b64_tr_b16 a[240:241], v13 offset:10432
    buffer_load_dwordx4 v6, s[20:23], s46 offen offset:0 lds
    v_mfma_f32_16x16x32_bf16 a[104:107], a[200:203], v[140:143], a[104:107]
    v_mfma_f32_16x16x32_bf16 a[108:111], a[200:203], v[144:147], a[108:111]
    ds_read_b64_tr_b16 a[242:243], v13 offset:15552
    v_mfma_f32_16x16x32_bf16 a[112:115], a[200:203], v[148:151], a[112:115]
    buffer_load_dwordx4 v7, s[20:23], s46 offen offset:1024 lds
    v_mfma_f32_16x16x32_bf16 a[116:119], a[200:203], v[152:155], a[116:119]
    ds_read_b64_tr_b16 a[244:245], v14 offset:10464
    v_mfma_f32_16x16x32_bf16 a[120:123], a[204:207], v[136:139], a[120:123]
    v_mfma_f32_16x16x32_bf16 a[124:127], a[204:207], v[140:143], a[124:127]
    ds_read_b64_tr_b16 a[246:247], v14 offset:15584
    buffer_load_dwordx4 v8, s[20:23], s46 offen offset:2048 lds
    v_mfma_f32_16x16x32_bf16 a[128:131], a[204:207], v[144:147], a[128:131]
    v_mfma_f32_16x16x32_bf16 a[132:135], a[204:207], v[148:151], a[132:135]
    ds_read_b64_tr_b16 a[248:249], v13 offset:10496
    v_mfma_f32_16x16x32_bf16 a[136:139], a[204:207], v[152:155], a[136:139]
    buffer_load_dwordx4 v9, s[20:23], s46 offen offset:3072 lds
    v_mfma_f32_16x16x32_bf16 a[140:143], a[208:211], v[136:139], a[140:143]
    ds_read_b64_tr_b16 a[250:251], v13 offset:15616
    v_mfma_f32_16x16x32_bf16 a[144:147], a[208:211], v[140:143], a[144:147]
    s_add_u32 m0, s47, 49152
    v_mfma_f32_16x16x32_bf16 a[148:151], a[208:211], v[144:147], a[148:151]
    buffer_load_dwordx4 v10, s[20:23], s46 offen offset:0 lds
    v_mfma_f32_16x16x32_bf16 a[152:155], a[208:211], v[148:151], a[152:155]
    v_mfma_f32_16x16x32_bf16 a[156:159], a[208:211], v[152:155], a[156:159]
    v_mfma_f32_16x16x32_bf16 a[160:163], a[212:215], v[136:139], a[160:163]
    buffer_load_dwordx4 v11, s[20:23], s46 offen offset:1024 lds
    v_mfma_f32_16x16x32_bf16 a[164:167], a[212:215], v[140:143], a[164:167]
    v_mfma_f32_16x16x32_bf16 a[168:171], a[212:215], v[144:147], a[168:171]
    s_mov_b32 s54, s45
    v_mfma_f32_16x16x32_bf16 a[172:175], a[212:215], v[148:151], a[172:175]
    v_mfma_f32_16x16x32_bf16 a[176:179], a[212:215], v[152:155], a[176:179]
    s_waitcnt vmcnt(20) lgkmcnt(0)
    s_barrier
    v_add_u32 v15, 0, v17
    v_add_u32 v16, 0, v18
    v_mfma_f32_16x16x32_bf16 a[0:3], a[216:219], v[156:159], a[0:3]
    s_lshl_b32 s48, s41, 9
    s_add_u32 s48, s48, s53
    v_mfma_f32_16x16x32_bf16 a[4:7], a[216:219], v[160:163], a[4:7]
    ds_read_b64_tr_b16 a[180:181], v15 offset:0
    s_add_u32 s48, s48, 65536
    buffer_load_dword v31, v30, s[92:95], s48 offen sc1
    v_mfma_f32_16x16x32_bf16 a[8:11], a[216:219], v[164:167], a[8:11]
    s_add_u32 s50, s45, 0
    buffer_load_dwordx4 v[96:99], v12, s[16:19], s50 offen sc1
    v_mfma_f32_16x16x32_bf16 a[12:15], a[216:219], v[168:171], a[12:15]
    ds_read_b64_tr_b16 a[182:183], v15 offset:5120
    v_mfma_f32_16x16x32_bf16 a[16:19], a[216:219], v[172:175], a[16:19]
    v_mfma_f32_16x16x32_bf16 a[20:23], a[220:223], v[156:159], a[20:23]
    ds_read_b64_tr_b16 a[184:185], v16 offset:32
    v_mfma_f32_16x16x32_bf16 a[24:27], a[220:223], v[160:163], a[24:27]
    s_add_u32 s50, s45, 131072
    buffer_load_dwordx4 v[100:103], v12, s[16:19], s50 offen sc1
    v_mfma_f32_16x16x32_bf16 a[28:31], a[220:223], v[164:167], a[28:31]
    ds_read_b64_tr_b16 a[186:187], v16 offset:5152
    v_mfma_f32_16x16x32_bf16 a[32:35], a[220:223], v[168:171], a[32:35]
    v_mfma_f32_16x16x32_bf16 a[36:39], a[220:223], v[172:175], a[36:39]
    ds_read_b64_tr_b16 a[188:189], v15 offset:64
    v_mfma_f32_16x16x32_bf16 a[40:43], a[224:227], v[156:159], a[40:43]
    s_add_u32 s50, s45, 262144
    buffer_load_dwordx4 v[104:107], v12, s[16:19], s50 offen sc1
    v_mfma_f32_16x16x32_bf16 a[44:47], a[224:227], v[160:163], a[44:47]
    ds_read_b64_tr_b16 a[190:191], v15 offset:5184
    v_mfma_f32_16x16x32_bf16 a[48:51], a[224:227], v[164:167], a[48:51]
    v_mfma_f32_16x16x32_bf16 a[52:55], a[224:227], v[168:171], a[52:55]
    ds_read_b64_tr_b16 a[192:193], v16 offset:96
    v_mfma_f32_16x16x32_bf16 a[56:59], a[224:227], v[172:175], a[56:59]
    s_add_u32 s50, s45, 393216
    buffer_load_dwordx4 v[108:111], v12, s[16:19], s50 offen sc1
    v_mfma_f32_16x16x32_bf16 a[60:63], a[228:231], v[156:159], a[60:63]
    ds_read_b64_tr_b16 a[194:195], v16 offset:5216
    v_mfma_f32_16x16x32_bf16 a[64:67], a[228:231], v[160:163], a[64:67]
    v_mfma_f32_16x16x32_bf16 a[68:71], a[228:231], v[164:167], a[68:71]
    ds_read_b64_tr_b16 a[196:197], v15 offset:128
    v_mfma_f32_16x16x32_bf16 a[72:75], a[228:231], v[168:171], a[72:75]
    s_add_u32 s50, s45, 524288
    buffer_load_dwordx4 v[112:115], v12, s[16:19], s50 offen sc1
    v_mfma_f32_16x16x32_bf16 a[76:79], a[228:231], v[172:175], a[76:79]
    ds_read_b64_tr_b16 a[198:199], v15 offset:5248
    v_mfma_f32_16x16x32_bf16 a[80:83], a[232:235], v[156:159], a[80:83]
    v_mfma_f32_16x16x32_bf16 a[84:87], a[232:235], v[160:163], a[84:87]
    ds_read_b64_tr_b16 a[200:201], v16 offset:160
    v_mfma_f32_16x16x32_bf16 a[88:91], a[232:235], v[164:167], a[88:91]
    s_add_u32 s50, s45, 1024
    buffer_load_dwordx4 v[116:119], v12, s[16:19], s50 offen sc1
    v_mfma_f32_16x16x32_bf16 a[92:95], a[232:235], v[168:171], a[92:95]
    ds_read_b64_tr_b16 a[202:203], v16 offset:5280
    v_mfma_f32_16x16x32_bf16 a[96:99], a[232:235], v[172:175], a[96:99]
    v_mfma_f32_16x16x32_bf16 a[100:103], a[236:239], v[156:159], a[100:103]
    ds_read_b64_tr_b16 a[204:205], v15 offset:192
    v_mfma_f32_16x16x32_bf16 a[104:107], a[236:239], v[160:163], a[104:107]
    s_add_u32 s50, s45, 132096
    buffer_load_dwordx4 v[120:123], v12, s[16:19], s50 offen sc1
    v_mfma_f32_16x16x32_bf16 a[108:111], a[236:239], v[164:167], a[108:111]
    ds_read_b64_tr_b16 a[206:207], v15 offset:5312
    v_mfma_f32_16x16x32_bf16 a[112:115], a[236:239], v[168:171], a[112:115]
    v_mfma_f32_16x16x32_bf16 a[116:119], a[236:239], v[172:175], a[116:119]
    ds_read_b64_tr_b16 a[208:209], v16 offset:224
    v_mfma_f32_16x16x32_bf16 a[120:123], a[240:243], v[156:159], a[120:123]
    s_add_u32 s50, s45, 263168
    buffer_load_dwordx4 v[124:127], v12, s[16:19], s50 offen sc1
    v_mfma_f32_16x16x32_bf16 a[124:127], a[240:243], v[160:163], a[124:127]
    ds_read_b64_tr_b16 a[210:211], v16 offset:5344
    v_mfma_f32_16x16x32_bf16 a[128:131], a[240:243], v[164:167], a[128:131]
    v_mfma_f32_16x16x32_bf16 a[132:135], a[240:243], v[168:171], a[132:135]
    ds_read_b64_tr_b16 a[212:213], v15 offset:256
    v_mfma_f32_16x16x32_bf16 a[136:139], a[240:243], v[172:175], a[136:139]
    s_add_u32 s50, s45, 394240
    buffer_load_dwordx4 v[128:131], v12, s[16:19], s50 offen sc1
    v_mfma_f32_16x16x32_bf16 a[140:143], a[244:247], v[156:159], a[140:143]
    ds_read_b64_tr_b16 a[214:215], v15 offset:5376
    v_mfma_f32_16x16x32_bf16 a[144:147], a[244:247], v[160:163], a[144:147]
    v_mfma_f32_16x16x32_bf16 a[148:151], a[244:247], v[164:167], a[148:151]
    v_mfma_f32_16x16x32_bf16 a[152:155], a[244:247], v[168:171], a[152:155]
    s_add_u32 s50, s45, 525312
    buffer_load_dwordx4 v[132:135], v12, s[16:19], s50 offen sc1
    v_mfma_f32_16x16x32_bf16 a[156:159], a[244:247], v[172:175], a[156:159]
    v_mfma_f32_16x16x32_bf16 a[160:163], a[248:251], v[156:159], a[160:163]
    v_mfma_f32_16x16x32_bf16 a[164:167], a[248:251], v[160:163], a[164:167]
    v_mfma_f32_16x16x32_bf16 a[168:171], a[248:251], v[164:167], a[168:171]
    v_mfma_f32_16x16x32_bf16 a[172:175], a[248:251], v[168:171], a[172:175]
    v_mfma_f32_16x16x32_bf16 a[176:179], a[248:251], v[172:175], a[176:179]
    v_mov_b32 v13, v15
    v_mov_b32 v14, v16
    s_waitcnt vmcnt(21) lgkmcnt(0)
    v_mfma_f32_16x16x32_bf16 a[0:3], a[180:183], v[56:59], a[0:3]
    s_add_u32 s48, s40, 1
    s_and_b32 s48, s48, 3
    v_mfma_f32_16x16x32_bf16 a[4:7], a[180:183], v[60:63], a[4:7]
    ds_read_b64_tr_b16 a[216:217], v13 offset:10240
    v_mfma_f32_16x16x32_bf16 a[8:11], a[180:183], v[64:67], a[8:11]
    s_lshl_b32 s48, s48, 3
    s_add_u32 s48, s48, s57
    v_mfma_f32_16x16x32_bf16 a[12:15], a[180:183], v[68:71], a[12:15]
    ds_read_b64_tr_b16 a[218:219], v13 offset:15360
    v_mfma_f32_16x16x32_bf16 a[16:19], a[180:183], v[72:75], a[16:19]
    s_add_u32 s48, s48, 2
    s_lshl_b32 s45, s48, 10
    v_mfma_f32_16x16x32_bf16 a[20:23], a[184:187], v[56:59], a[20:23]
    ds_read_b64_tr_b16 a[220:221], v14 offset:10272
    v_mfma_f32_16x16x32_bf16 a[24:27], a[184:187], v[60:63], a[24:27]
    s_add_u32 s48, s48, s42
    s_mul_i32 s46, s48, 36864
    v_mfma_f32_16x16x32_bf16 a[28:31], a[184:187], v[64:67], a[28:31]
    ds_read_b64_tr_b16 a[222:223], v14 offset:15392
    v_mfma_f32_16x16x32_bf16 a[32:35], a[184:187], v[68:71], a[32:35]
    v_mfma_f32_16x16x32_bf16 a[36:39], a[184:187], v[72:75], a[36:39]
    ds_read_b64_tr_b16 a[224:225], v13 offset:10304
    v_mfma_f32_16x16x32_bf16 a[40:43], a[188:191], v[56:59], a[40:43]
    v_mfma_f32_16x16x32_bf16 a[44:47], a[188:191], v[60:63], a[44:47]
    ds_read_b64_tr_b16 a[226:227], v13 offset:15424
    v_mfma_f32_16x16x32_bf16 a[48:51], a[188:191], v[64:67], a[48:51]
    s_add_u32 m0, s47, 81920
    v_mfma_f32_16x16x32_bf16 a[52:55], a[188:191], v[68:71], a[52:55]
    ds_read_b64_tr_b16 a[228:229], v14 offset:10336
    buffer_load_dwordx4 v2, s[20:23], s46 offen offset:0 lds
    v_mfma_f32_16x16x32_bf16 a[56:59], a[188:191], v[72:75], a[56:59]
    v_mfma_f32_16x16x32_bf16 a[60:63], a[192:195], v[56:59], a[60:63]
    ds_read_b64_tr_b16 a[230:231], v14 offset:15456
    v_mfma_f32_16x16x32_bf16 a[64:67], a[192:195], v[60:63], a[64:67]
    buffer_load_dwordx4 v3, s[20:23], s46 offen offset:1024 lds
    v_mfma_f32_16x16x32_bf16 a[68:71], a[192:195], v[64:67], a[68:71]
    ds_read_b64_tr_b16 a[232:233], v13 offset:10368
    v_mfma_f32_16x16x32_bf16 a[72:75], a[192:195], v[68:71], a[72:75]
    v_mfma_f32_16x16x32_bf16 a[76:79], a[192:195], v[72:75], a[76:79]
    ds_read_b64_tr_b16 a[234:235], v13 offset:15488
    buffer_load_dwordx4 v4, s[20:23], s46 offen offset:2048 lds
    v_mfma_f32_16x16x32_bf16 a[80:83], a[196:199], v[56:59], a[80:83]
    v_mfma_f32_16x16x32_bf16 a[84:87], a[196:199], v[60:63], a[84:87]
    ds_read_b64_tr_b16 a[236:237], v14 offset:10400
    v_mfma_f32_16x16x32_bf16 a[88:91], a[196:199], v[64:67], a[88:91]
    buffer_load_dwordx4 v5, s[20:23], s46 offen offset:3072 lds
    v_mfma_f32_16x16x32_bf16 a[92:95], a[196:199], v[68:71], a[92:95]
    ds_read_b64_tr_b16 a[238:239], v14 offset:15520
    v_mfma_f32_16x16x32_bf16 a[96:99], a[196:199], v[72:75], a[96:99]
    s_add_u32 m0, s47, 86016
    v_mfma_f32_16x16x32_bf16 a[100:103], a[200:203], v[56:59], a[100:103]
    ds_read_b64_tr_b16 a[240:241], v13 offset:10432
    buffer_load_dwordx4 v6, s[20:23], s46 offen offset:0 lds
    v_mfma_f32_16x16x32_bf16 a[104:107], a[200:203], v[60:63], a[104:107]
    v_mfma_f32_16x16x32_bf16 a[108:111], a[200:203], v[64:67], a[108:111]
    ds_read_b64_tr_b16 a[242:243], v13 offset:15552
    v_mfma_f32_16x16x32_bf16 a[112:115], a[200:203], v[68:71], a[112:115]
    buffer_load_dwordx4 v7, s[20:23], s46 offen offset:1024 lds
    v_mfma_f32_16x16x32_bf16 a[116:119], a[200:203], v[72:75], a[116:119]
    ds_read_b64_tr_b16 a[244:245], v14 offset:10464
    v_mfma_f32_16x16x32_bf16 a[120:123], a[204:207], v[56:59], a[120:123]
    v_mfma_f32_16x16x32_bf16 a[124:127], a[204:207], v[60:63], a[124:127]
    ds_read_b64_tr_b16 a[246:247], v14 offset:15584
    buffer_load_dwordx4 v8, s[20:23], s46 offen offset:2048 lds
    v_mfma_f32_16x16x32_bf16 a[128:131], a[204:207], v[64:67], a[128:131]
    v_mfma_f32_16x16x32_bf16 a[132:135], a[204:207], v[68:71], a[132:135]
    ds_read_b64_tr_b16 a[248:249], v13 offset:10496
    v_mfma_f32_16x16x32_bf16 a[136:139], a[204:207], v[72:75], a[136:139]
    buffer_load_dwordx4 v9, s[20:23], s46 offen offset:3072 lds
    v_mfma_f32_16x16x32_bf16 a[140:143], a[208:211], v[56:59], a[140:143]
    ds_read_b64_tr_b16 a[250:251], v13 offset:15616
    v_mfma_f32_16x16x32_bf16 a[144:147], a[208:211], v[60:63], a[144:147]
    s_add_u32 m0, s47, 90112
    v_mfma_f32_16x16x32_bf16 a[148:151], a[208:211], v[64:67], a[148:151]
    buffer_load_dwordx4 v10, s[20:23], s46 offen offset:0 lds
    v_mfma_f32_16x16x32_bf16 a[152:155], a[208:211], v[68:71], a[152:155]
    v_mfma_f32_16x16x32_bf16 a[156:159], a[208:211], v[72:75], a[156:159]
    v_mfma_f32_16x16x32_bf16 a[160:163], a[212:215], v[56:59], a[160:163]
    buffer_load_dwordx4 v11, s[20:23], s46 offen offset:1024 lds
    v_mfma_f32_16x16x32_bf16 a[164:167], a[212:215], v[60:63], a[164:167]
    v_mfma_f32_16x16x32_bf16 a[168:171], a[212:215], v[64:67], a[168:171]
    s_mov_b32 s55, s45
    v_mfma_f32_16x16x32_bf16 a[172:175], a[212:215], v[68:71], a[172:175]
    v_mfma_f32_16x16x32_bf16 a[176:179], a[212:215], v[72:75], a[176:179]
    s_waitcnt vmcnt(20) lgkmcnt(0)
    s_barrier
    v_cmp_ne_u32 vcc, s99, v31
    s_nop 4
    s_cbranch_vccz P2_A2OK
    v_and_b32 v19, 3, v1
    s_add_u32 s49, s40, 1
    s_and_b32 s49, s49, 3
    v_mov_b32 v20, s49
    v_cmp_eq_u32 vcc, s40, v19
    s_nop 1
    v_cndmask_b32 v19, v19, v20, vcc
    s_lshl_b32 s48, s41, 9
    s_add_u32 s48, s48, s53
    s_add_u32 s48, s48, 65536
    v_lshlrev_b32 v19, 7, v19
    s_mov_b32 s51, 0x40000
P2_POLL_a2:
    buffer_load_dword v20, v19, s[92:95], s48 offen sc1
    s_waitcnt vmcnt(0)
    v_cmp_ne_u32 vcc, s99, v20
    s_nop 4
    s_cbranch_vccz P2_POLLED_a2
    s_sub_u32 s51, s51, 1
    s_cmp_eq_u32 s51, 0
    s_cbranch_scc1 P2_POLLED_a2
    s_sleep 1
    s_branch P2_POLL_a2
P2_POLLED_a2:
P2_A2OK:
    v_add_u32 v15, 40960, v17
    v_add_u32 v16, 40960, v18
    v_mfma_f32_16x16x32_bf16 a[0:3], a[216:219], v[76:79], a[0:3]
    v_mfma_f32_16x16x32_bf16 a[4:7], a[216:219], v[80:83], a[4:7]
    ds_read_b64_tr_b16 a[180:181], v15 offset:0
    v_mfma_f32_16x16x32_bf16 a[8:11], a[216:219], v[84:87], a[8:11]
    s_add_u32 s50, s45, 0
    buffer_load_dwordx4 v[136:139], v12, s[16:19], s50 offen sc1
    v_mfma_f32_16x16x32_bf16 a[12:15], a[216:219], v[88:91], a[12:15]
    ds_read_b64_tr_b16 a[182:183], v15 offset:5120
    v_mfma_f32_16x16x32_bf16 a[16:19], a[216:219], v[92:95], a[16:19]
    v_mfma_f32_16x16x32_bf16 a[20:23], a[220:223], v[76:79], a[20:23]
    ds_read_b64_tr_b16 a[184:185], v16 offset:32
    v_mfma_f32_16x16x32_bf16 a[24:27], a[220:223], v[80:83], a[24:27]
    s_add_u32 s50, s45, 131072
    buffer_load_dwordx4 v[140:143], v12, s[16:19], s50 offen sc1
    v_mfma_f32_16x16x32_bf16 a[28:31], a[220:223], v[84:87], a[28:31]
    ds_read_b64_tr_b16 a[186:187], v16 offset:5152
    v_mfma_f32_16x16x32_bf16 a[32:35], a[220:223], v[88:91], a[32:35]
    v_mfma_f32_16x16x32_bf16 a[36:39], a[220:223], v[92:95], a[36:39]
    ds_read_b64_tr_b16 a[188:189], v15 offset:64
    v_mfma_f32_16x16x32_bf16 a[40:43], a[224:227], v[76:79], a[40:43]
    s_add_u32 s50, s45, 262144
    buffer_load_dwordx4 v[144:147], v12, s[16:19], s50 offen sc1
    v_mfma_f32_16x16x32_bf16 a[44:47], a[224:227], v[80:83], a[44:47]
    ds_read_b64_tr_b16 a[190:191], v15 offset:5184
    v_mfma_f32_16x16x32_bf16 a[48:51], a[224:227], v[84:87], a[48:51]
    v_mfma_f32_16x16x32_bf16 a[52:55], a[224:227], v[88:91], a[52:55]
    ds_read_b64_tr_b16 a[192:193], v16 offset:96
    v_mfma_f32_16x16x32_bf16 a[56:59], a[224:227], v[92:95], a[56:59]
    s_add_u32 s50, s45, 393216
    buffer_load_dwordx4 v[148:151], v12, s[16:19], s50 offen sc1
    v_mfma_f32_16x16x32_bf16 a[60:63], a[228:231], v[76:79], a[60:63]
    ds_read_b64_tr_b16 a[194:195], v16 offset:5216
    v_mfma_f32_16x16x32_bf16 a[64:67], a[228:231], v[80:83], a[64:67]
    v_mfma_f32_16x16x32_bf16 a[68:71], a[228:231], v[84:87], a[68:71]
    ds_read_b64_tr_b16 a[196:197], v15 offset:128
    v_mfma_f32_16x16x32_bf16 a[72:75], a[228:231], v[88:91], a[72:75]
    s_add_u32 s50, s45, 524288
    buffer_load_dwordx4 v[152:155], v12, s[16:19], s50 offen sc1
    v_mfma_f32_16x16x32_bf16 a[76:79], a[228:231], v[92:95], a[76:79]
    ds_read_b64_tr_b16 a[198:199], v15 offset:5248
    v_mfma_f32_16x16x32_bf16 a[80:83], a[232:235], v[76:79], a[80:83]
    v_mfma_f32_16x16x32_bf16 a[84:87], a[232:235], v[80:83], a[84:87]
    ds_read_b64_tr_b16 a[200:201], v16 offset:160
    v_mfma_f32_16x16x32_bf16 a[88:91], a[232:235], v[84:87], a[88:91]
    s_add_u32 s50, s45, 1024
    buffer_load_dwordx4 v[156:159], v12, s[16:19], s50 offen sc1
    v_mfma_f32_16x16x32_bf16 a[92:95], a[232:235], v[88:91], a[92:95]
    ds_read_b64_tr_b16 a[202:203], v16 offset:5280
    v_mfma_f32_16x16x32_bf16 a[96:99], a[232:235], v[92:95], a[96:99]
    v_mfma_f32_16x16x32_bf16 a[100:103], a[236:239], v[76:79], a[100:103]
    ds_read_b64_tr_b16 a[204:205], v15 offset:192
    v_mfma_f32_16x16x32_bf16 a[104:107], a[236:239], v[80:83], a[104:107]
    s_add_u32 s50, s45, 132096
    buffer_load_dwordx4 v[160:163], v12, s[16:19], s50 offen sc1
    v_mfma_f32_16x16x32_bf16 a[108:111], a[236:239], v[84:87], a[108:111]
    ds_read_b64_tr_b16 a[206:207], v15 offset:5312
    v_mfma_f32_16x16x32_bf16 a[112:115], a[236:239], v[88:91], a[112:115]
    v_mfma_f32_16x16x32_bf16 a[116:119], a[236:239], v[92:95], a[116:119]
    ds_read_b64_tr_b16 a[208:209], v16 offset:224
    v_mfma_f32_16x16x32_bf16 a[120:123], a[240:243], v[76:79], a[120:123]
    s_add_u32 s50, s45, 263168
    buffer_load_dwordx4 v[164:167], v12, s[16:19], s50 offen sc1
    v_mfma_f32_16x16x32_bf16 a[124:127], a[240:243], v[80:83], a[124:127]
    ds_read_b64_tr_b16 a[210:211], v16 offset:5344
    v_mfma_f32_16x16x32_bf16 a[128:131], a[240:243], v[84:87], a[128:131]
    v_mfma_f32_16x16x32_bf16 a[132:135], a[240:243], v[88:91], a[132:135]
    ds_read_b64_tr_b16 a[212:213], v15 offset:256
    v_mfma_f32_16x16x32_bf16 a[136:139], a[240:243], v[92:95], a[136:139]
    s_add_u32 s50, s45, 394240
    buffer_load_dwordx4 v[168:171], v12, s[16:19], s50 offen sc1
    v_mfma_f32_16x16x32_bf16 a[140:143], a[244:247], v[76:79], a[140:143]
    ds_read_b64_tr_b16 a[214:215], v15 offset:5376
    v_mfma_f32_16x16x32_bf16 a[144:147], a[244:247], v[80:83], a[144:147]
    v_mfma_f32_16x16x32_bf16 a[148:151], a[244:247], v[84:87], a[148:151]
    v_mfma_f32_16x16x32_bf16 a[152:155], a[244:247], v[88:91], a[152:155]
    s_add_u32 s50, s45, 525312
    buffer_load_dwordx4 v[172:175], v12, s[16:19], s50 offen sc1
    v_mfma_f32_16x16x32_bf16 a[156:159], a[244:247], v[92:95], a[156:159]
    v_mfma_f32_16x16x32_bf16 a[160:163], a[248:251], v[76:79], a[160:163]
    v_mfma_f32_16x16x32_bf16 a[164:167], a[248:251], v[80:83], a[164:167]
    v_mfma_f32_16x16x32_bf16 a[168:171], a[248:251], v[84:87], a[168:171]
    v_mfma_f32_16x16x32_bf16 a[172:175], a[248:251], v[88:91], a[172:175]
    v_mfma_f32_16x16x32_bf16 a[176:179], a[248:251], v[92:95], a[176:179]
    v_mov_b32 v13, v15
    v_mov_b32 v14, v16
    s_waitcnt vmcnt(20) lgkmcnt(0)
    v_mfma_f32_16x16x32_bf16 a[0:3], a[180:183], v[96:99], a[0:3]
    s_add_u32 s48, s40, 2
    s_and_b32 s48, s48, 3
    v_mfma_f32_16x16x32_bf16 a[4:7], a[180:183], v[100:103], a[4:7]
    ds_read_b64_tr_b16 a[216:217], v13 offset:10240
    v_mfma_f32_16x16x32_bf16 a[8:11], a[180:183], v[104:107], a[8:11]
    s_lshl_b32 s48, s48, 3
    s_add_u32 s48, s48, s57
    v_mfma_f32_16x16x32_bf16 a[12:15], a[180:183], v[108:111], a[12:15]
    ds_read_b64_tr_b16 a[218:219], v13 offset:15360
    v_mfma_f32_16x16x32_bf16 a[16:19], a[180:183], v[112:115], a[16:19]
    s_add_u32 s48, s48, 2
    s_lshl_b32 s45, s48, 10
    v_mfma_f32_16x16x32_bf16 a[20:23], a[184:187], v[96:99], a[20:23]
    ds_read_b64_tr_b16 a[220:221], v14 offset:10272
    v_mfma_f32_16x16x32_bf16 a[24:27], a[184:187], v[100:103], a[24:27]
    s_add_u32 s48, s48, s42
    s_mul_i32 s46, s48, 36864
    v_mfma_f32_16x16x32_bf16 a[28:31], a[184:187], v[104:107], a[28:31]
    ds_read_b64_tr_b16 a[222:223], v14 offset:15392
    v_mfma_f32_16x16x32_bf16 a[32:35], a[184:187], v[108:111], a[32:35]
    v_mfma_f32_16x16x32_bf16 a[36:39], a[184:187], v[112:115], a[36:39]
    ds_read_b64_tr_b16 a[224:225], v13 offset:10304
    v_mfma_f32_16x16x32_bf16 a[40:43], a[188:191], v[96:99], a[40:43]
    v_mfma_f32_16x16x32_bf16 a[44:47], a[188:191], v[100:103], a[44:47]
    ds_read_b64_tr_b16 a[226:227], v13 offset:15424
    v_mfma_f32_16x16x32_bf16 a[48:51], a[188:191], v[104:107], a[48:51]
    s_add_u32 m0, s47, 0
    v_mfma_f32_16x16x32_bf16 a[52:55], a[188:191], v[108:111], a[52:55]
    ds_read_b64_tr_b16 a[228:229], v14 offset:10336
    buffer_load_dwordx4 v2, s[20:23], s46 offen offset:0 lds
    v_mfma_f32_16x16x32_bf16 a[56:59], a[188:191], v[112:115], a[56:59]
    v_mfma_f32_16x16x32_bf16 a[60:63], a[192:195], v[96:99], a[60:63]
    ds_read_b64_tr_b16 a[230:231], v14 offset:15456
    v_mfma_f32_16x16x32_bf16 a[64:67], a[192:195], v[100:103], a[64:67]
    buffer_load_dwordx4 v3, s[20:23], s46 offen offset:1024 lds
    v_mfma_f32_16x16x32_bf16 a[68:71], a[192:195], v[104:107], a[68:71]
    ds_read_b64_tr_b16 a[232:233], v13 offset:10368
    v_mfma_f32_16x16x32_bf16 a[72:75], a[192:195], v[108:111], a[72:75]
    v_mfma_f32_16x16x32_bf16 a[76:79], a[192:195], v[112:115], a[76:79]
    ds_read_b64_tr_b16 a[234:235], v13 offset:15488
    buffer_load_dwordx4 v4, s[20:23], s46 offen offset:2048 lds
    v_mfma_f32_16x16x32_bf16 a[80:83], a[196:199], v[96:99], a[80:83]
    v_mfma_f32_16x16x32_bf16 a[84:87], a[196:199], v[100:103], a[84:87]
    ds_read_b64_tr_b16 a[236:237], v14 offset:10400
    v_mfma_f32_16x16x32_bf16 a[88:91], a[196:199], v[104:107], a[88:91]
    buffer_load_dwordx4 v5, s[20:23], s46 offen offset:3072 lds
    v_mfma_f32_16x16x32_bf16 a[92:95], a[196:199], v[108:111], a[92:95]
    ds_read_b64_tr_b16 a[238:239], v14 offset:15520
    v_mfma_f32_16x16x32_bf16 a[96:99], a[196:199], v[112:115], a[96:99]
    s_add_u32 m0, s47, 4096
    v_mfma_f32_16x16x32_bf16 a[100:103], a[200:203], v[96:99], a[100:103]
    ds_read_b64_tr_b16 a[240:241], v13 offset:10432
    buffer_load_dwordx4 v6, s[20:23], s46 offen offset:0 lds
    v_mfma_f32_16x16x32_bf16 a[104:107], a[200:203], v[100:103], a[104:107]
    v_mfma_f32_16x16x32_bf16 a[108:111], a[200:203], v[104:107], a[108:111]
    ds_read_b64_tr_b16 a[242:243], v13 offset:15552
    v_mfma_f32_16x16x32_bf16 a[112:115], a[200:203], v[108:111], a[112:115]
    buffer_load_dwordx4 v7, s[20:23], s46 offen offset:1024 lds
    v_mfma_f32_16x16x32_bf16 a[116:119], a[200:203], v[112:115], a[116:119]
    ds_read_b64_tr_b16 a[244:245], v14 offset:10464
    v_mfma_f32_16x16x32_bf16 a[120:123], a[204:207], v[96:99], a[120:123]
    v_mfma_f32_16x16x32_bf16 a[124:127], a[204:207], v[100:103], a[124:127]
    ds_read_b64_tr_b16 a[246:247], v14 offset:15584
    buffer_load_dwordx4 v8, s[20:23], s46 offen offset:2048 lds
    v_mfma_f32_16x16x32_bf16 a[128:131], a[204:207], v[104:107], a[128:131]
    v_mfma_f32_16x16x32_bf16 a[132:135], a[204:207], v[108:111], a[132:135]
    ds_read_b64_tr_b16 a[248:249], v13 offset:10496
    v_mfma_f32_16x16x32_bf16 a[136:139], a[204:207], v[112:115], a[136:139]
    buffer_load_dwordx4 v9, s[20:23], s46 offen offset:3072 lds
    v_mfma_f32_16x16x32_bf16 a[140:143], a[208:211], v[96:99], a[140:143]
    ds_read_b64_tr_b16 a[250:251], v13 offset:15616
    v_mfma_f32_16x16x32_bf16 a[144:147], a[208:211], v[100:103], a[144:147]
    s_add_u32 m0, s47, 8192
    v_mfma_f32_16x16x32_bf16 a[148:151], a[208:211], v[104:107], a[148:151]
    buffer_load_dwordx4 v10, s[20:23], s46 offen offset:0 lds
    v_mfma_f32_16x16x32_bf16 a[152:155], a[208:211], v[108:111], a[152:155]
    v_mfma_f32_16x16x32_bf16 a[156:159], a[208:211], v[112:115], a[156:159]
    v_mfma_f32_16x16x32_bf16 a[160:163], a[212:215], v[96:99], a[160:163]
    buffer_load_dwordx4 v11, s[20:23], s46 offen offset:1024 lds
    v_mfma_f32_16x16x32_bf16 a[164:167], a[212:215], v[100:103], a[164:167]
    v_mfma_f32_16x16x32_bf16 a[168:171], a[212:215], v[104:107], a[168:171]
    s_mov_b32 s54, s45
    v_mfma_f32_16x16x32_bf16 a[172:175], a[212:215], v[108:111], a[172:175]
    v_mfma_f32_16x16x32_bf16 a[176:179], a[212:215], v[112:115], a[176:179]
    s_waitcnt vmcnt(20) lgkmcnt(0)
    s_barrier
    v_add_u32 v15, 81920, v17
    v_add_u32 v16, 81920, v18
    v_mfma_f32_16x16x32_bf16 a[0:3], a[216:219], v[116:119], a[0:3]
    v_mfma_f32_16x16x32_bf16 a[4:7], a[216:219], v[120:123], a[4:7]
    ds_read_b64_tr_b16 a[180:181], v15 offset:0
    v_mfma_f32_16x16x32_bf16 a[8:11], a[216:219], v[124:127], a[8:11]
    s_add_u32 s50, s45, 0
    buffer_load_dwordx4 v[56:59], v12, s[16:19], s50 offen sc1
    v_mfma_f32_16x16x32_bf16 a[12:15], a[216:219], v[128:131], a[12:15]
    ds_read_b64_tr_b16 a[182:183], v15 offset:5120
    v_mfma_f32_16x16x32_bf16 a[16:19], a[216:219], v[132:135], a[16:19]
    v_mfma_f32_16x16x32_bf16 a[20:23], a[220:223], v[116:119], a[20:23]
    ds_read_b64_tr_b16 a[184:185], v16 offset:32
    v_mfma_f32_16x16x32_bf16 a[24:27], a[220:223], v[120:123], a[24:27]
    s_add_u32 s50, s45, 131072
    buffer_load_dwordx4 v[60:63], v12, s[16:19], s50 offen sc1
    v_mfma_f32_16x16x32_bf16 a[28:31], a[220:223], v[124:127], a[28:31]
    ds_read_b64_tr_b16 a[186:187], v16 offset:5152
    v_mfma_f32_16x16x32_bf16 a[32:35], a[220:223], v[128:131], a[32:35]
    v_mfma_f32_16x16x32_bf16 a[36:39], a[220:223], v[132:135], a[36:39]
    ds_read_b64_tr_b16 a[188:189], v15 offset:64
    v_mfma_f32_16x16x32_bf16 a[40:43], a[224:227], v[116:119], a[40:43]
    s_add_u32 s50, s45, 262144
    buffer_load_dwordx4 v[64:67], v12, s[16:19], s50 offen sc1
    v_mfma_f32_16x16x32_bf16 a[44:47], a[224:227], v[120:123], a[44:47]
    ds_read_b64_tr_b16 a[190:191], v15 offset:5184
    v_mfma_f32_16x16x32_bf16 a[48:51], a[224:227], v[124:127], a[48:51]
    v_mfma_f32_16x16x32_bf16 a[52:55], a[224:227], v[128:131], a[52:55]
    ds_read_b64_tr_b16 a[192:193], v16 offset:96
    v_mfma_f32_16x16x32_bf16 a[56:59], a[224:227], v[132:135], a[56:59]
    s_add_u32 s50, s45, 393216
    buffer_load_dwordx4 v[68:71], v12, s[16:19], s50 offen sc1
    v_mfma_f32_16x16x32_bf16 a[60:63], a[228:231], v[116:119], a[60:63]
    ds_read_b64_tr_b16 a[194:195], v16 offset:5216
    v_mfma_f32_16x16x32_bf16 a[64:67], a[228:231], v[120:123], a[64:67]
    v_mfma_f32_16x16x32_bf16 a[68:71], a[228:231], v[124:127], a[68:71]
    ds_read_b64_tr_b16 a[196:197], v15 offset:128
    v_mfma_f32_16x16x32_bf16 a[72:75], a[228:231], v[128:131], a[72:75]
    s_add_u32 s50, s45, 524288
    buffer_load_dwordx4 v[72:75], v12, s[16:19], s50 offen sc1
    v_mfma_f32_16x16x32_bf16 a[76:79], a[228:231], v[132:135], a[76:79]
    ds_read_b64_tr_b16 a[198:199], v15 offset:5248
    v_mfma_f32_16x16x32_bf16 a[80:83], a[232:235], v[116:119], a[80:83]
    v_mfma_f32_16x16x32_bf16 a[84:87], a[232:235], v[120:123], a[84:87]
    ds_read_b64_tr_b16 a[200:201], v16 offset:160
    v_mfma_f32_16x16x32_bf16 a[88:91], a[232:235], v[124:127], a[88:91]
    s_add_u32 s50, s45, 1024
    buffer_load_dwordx4 v[76:79], v12, s[16:19], s50 offen sc1
    v_mfma_f32_16x16x32_bf16 a[92:95], a[232:235], v[128:131], a[92:95]
    ds_read_b64_tr_b16 a[202:203], v16 offset:5280
    v_mfma_f32_16x16x32_bf16 a[96:99], a[232:235], v[132:135], a[96:99]
    v_mfma_f32_16x16x32_bf16 a[100:103], a[236:239], v[116:119], a[100:103]
    ds_read_b64_tr_b16 a[204:205], v15 offset:192
    v_mfma_f32_16x16x32_bf16 a[104:107], a[236:239], v[120:123], a[104:107]
    s_add_u32 s50, s45, 132096
    buffer_load_dwordx4 v[80:83], v12, s[16:19], s50 offen sc1
    v_mfma_f32_16x16x32_bf16 a[108:111], a[236:239], v[124:127], a[108:111]
    ds_read_b64_tr_b16 a[206:207], v15 offset:5312
    v_mfma_f32_16x16x32_bf16 a[112:115], a[236:239], v[128:131], a[112:115]
    v_mfma_f32_16x16x32_bf16 a[116:119], a[236:239], v[132:135], a[116:119]
    ds_read_b64_tr_b16 a[208:209], v16 offset:224
    v_mfma_f32_16x16x32_bf16 a[120:123], a[240:243], v[116:119], a[120:123]
    s_add_u32 s50, s45, 263168
    buffer_load_dwordx4 v[84:87], v12, s[16:19], s50 offen sc1
    v_mfma_f32_16x16x32_bf16 a[124:127], a[240:243], v[120:123], a[124:127]
    ds_read_b64_tr_b16 a[210:211], v16 offset:5344
    v_mfma_f32_16x16x32_bf16 a[128:131], a[240:243], v[124:127], a[128:131]
    v_mfma_f32_16x16x32_bf16 a[132:135], a[240:243], v[128:131], a[132:135]
    ds_read_b64_tr_b16 a[212:213], v15 offset:256
    v_mfma_f32_16x16x32_bf16 a[136:139], a[240:243], v[132:135], a[136:139]
    s_add_u32 s50, s45, 394240
    buffer_load_dwordx4 v[88:91], v12, s[16:19], s50 offen sc1
    v_mfma_f32_16x16x32_bf16 a[140:143], a[244:247], v[116:119], a[140:143]
    ds_read_b64_tr_b16 a[214:215], v15 offset:5376
    v_mfma_f32_16x16x32_bf16 a[144:147], a[244:247], v[120:123], a[144:147]
    v_mfma_f32_16x16x32_bf16 a[148:151], a[244:247], v[124:127], a[148:151]
    v_mfma_f32_16x16x32_bf16 a[152:155], a[244:247], v[128:131], a[152:155]
    s_add_u32 s50, s45, 525312
    buffer_load_dwordx4 v[92:95], v12, s[16:19], s50 offen sc1
    v_mfma_f32_16x16x32_bf16 a[156:159], a[244:247], v[132:135], a[156:159]
    v_mfma_f32_16x16x32_bf16 a[160:163], a[248:251], v[116:119], a[160:163]
    v_mfma_f32_16x16x32_bf16 a[164:167], a[248:251], v[120:123], a[164:167]
    v_mfma_f32_16x16x32_bf16 a[168:171], a[248:251], v[124:127], a[168:171]
    v_mfma_f32_16x16x32_bf16 a[172:175], a[248:251], v[128:131], a[172:175]
    v_mfma_f32_16x16x32_bf16 a[176:179], a[248:251], v[132:135], a[176:179]
    v_mov_b32 v13, v15
    v_mov_b32 v14, v16
    s_waitcnt vmcnt(20) lgkmcnt(0)
    v_mfma_f32_16x16x32_bf16 a[0:3], a[180:183], v[136:139], a[0:3]
    s_add_u32 s48, s40, 3
    s_and_b32 s48, s48, 3
    v_mfma_f32_16x16x32_bf16 a[4:7], a[180:183], v[140:143], a[4:7]
    ds_read_b64_tr_b16 a[216:217], v13 offset:10240
    v_mfma_f32_16x16x32_bf16 a[8:11], a[180:183], v[144:147], a[8:11]
    s_lshl_b32 s48, s48, 3
    s_add_u32 s48, s48, s57
    v_mfma_f32_16x16x32_bf16 a[12:15], a[180:183], v[148:151], a[12:15]
    ds_read_b64_tr_b16 a[218:219], v13 offset:15360
    v_mfma_f32_16x16x32_bf16 a[16:19], a[180:183], v[152:155], a[16:19]
    s_add_u32 s48, s48, 2
    s_lshl_b32 s45, s48, 10
    v_mfma_f32_16x16x32_bf16 a[20:23], a[184:187], v[136:139], a[20:23]
    ds_read_b64_tr_b16 a[220:221], v14 offset:10272
    v_mfma_f32_16x16x32_bf16 a[24:27], a[184:187], v[140:143], a[24:27]
    s_add_u32 s48, s48, s42
    s_mul_i32 s46, s48, 36864
    v_mfma_f32_16x16x32_bf16 a[28:31], a[184:187], v[144:147], a[28:31]
    ds_read_b64_tr_b16 a[222:223], v14 offset:15392
    v_mfma_f32_16x16x32_bf16 a[32:35], a[184:187], v[148:151], a[32:35]
    v_mfma_f32_16x16x32_bf16 a[36:39], a[184:187], v[152:155], a[36:39]
    ds_read_b64_tr_b16 a[224:225], v13 offset:10304
    v_mfma_f32_16x16x32_bf16 a[40:43], a[188:191], v[136:139], a[40:43]
    v_mfma_f32_16x16x32_bf16 a[44:47], a[188:191], v[140:143], a[44:47]
    ds_read_b64_tr_b16 a[226:227], v13 offset:15424
    v_mfma_f32_16x16x32_bf16 a[48:51], a[188:191], v[144:147], a[48:51]
    s_add_u32 m0, s47, 40960
    v_mfma_f32_16x16x32_bf16 a[52:55], a[188:191], v[148:151], a[52:55]
    ds_read_b64_tr_b16 a[228:229], v14 offset:10336
    buffer_load_dwordx4 v2, s[20:23], s46 offen offset:0 lds
    v_mfma_f32_16x16x32_bf16 a[56:59], a[188:191], v[152:155], a[56:59]
    v_mfma_f32_16x16x32_bf16 a[60:63], a[192:195], v[136:139], a[60:63]
    ds_read_b64_tr_b16 a[230:231], v14 offset:15456
    v_mfma_f32_16x16x32_bf16 a[64:67], a[192:195], v[140:143], a[64:67]
    buffer_load_dwordx4 v3, s[20:23], s46 offen offset:1024 lds
    v_mfma_f32_16x16x32_bf16 a[68:71], a[192:195], v[144:147], a[68:71]
    ds_read_b64_tr_b16 a[232:233], v13 offset:10368
    v_mfma_f32_16x16x32_bf16 a[72:75], a[192:195], v[148:151], a[72:75]
    v_mfma_f32_16x16x32_bf16 a[76:79], a[192:195], v[152:155], a[76:79]
    ds_read_b64_tr_b16 a[234:235], v13 offset:15488
    buffer_load_dwordx4 v4, s[20:23], s46 offen offset:2048 lds
    v_mfma_f32_16x16x32_bf16 a[80:83], a[196:199], v[136:139], a[80:83]
    v_mfma_f32_16x16x32_bf16 a[84:87], a[196:199], v[140:143], a[84:87]
    ds_read_b64_tr_b16 a[236:237], v14 offset:10400
    v_mfma_f32_16x16x32_bf16 a[88:91], a[196:199], v[144:147], a[88:91]
    buffer_load_dwordx4 v5, s[20:23], s46 offen offset:3072 lds
    v_mfma_f32_16x16x32_bf16 a[92:95], a[196:199], v[148:151], a[92:95]
    ds_read_b64_tr_b16 a[238:239], v14 offset:15520
    v_mfma_f32_16x16x32_bf16 a[96:99], a[196:199], v[152:155], a[96:99]
    s_add_u32 m0, s47, 45056
    v_mfma_f32_16x16x32_bf16 a[100:103], a[200:203], v[136:139], a[100:103]
    ds_read_b64_tr_b16 a[240:241], v13 offset:10432
    buffer_load_dwordx4 v6, s[20:23], s46 offen offset:0 lds
    v_mfma_f32_16x16x32_bf16 a[104:107], a[200:203], v[140:143], a[104:107]
    v_mfma_f32_16x16x32_bf16 a[108:111], a[200:203], v[144:147], a[108:111]
    ds_read_b64_tr_b16 a[242:243], v13 offset:15552
    v_mfma_f32_16x16x32_bf16 a[112:115], a[200:203], v[148:151], a[112:115]
    buffer_load_dwordx4 v7, s[20:23], s46 offen offset:1024 lds
    v_mfma_f32_16x16x32_bf16 a[116:119], a[200:203], v[152:155], a[116:119]
    ds_read_b64_tr_b16 a[244:245], v14 offset:10464
    v_mfma_f32_16x16x32_bf16 a[120:123], a[204:207], v[136:139], a[120:123]
    v_mfma_f32_16x16x32_bf16 a[124:127], a[204:207], v[140:143], a[124:127]
    ds_read_b64_tr_b16 a[246:247], v14 offset:15584
    buffer_load_dwordx4 v8, s[20:23], s46 offen offset:2048 lds
    v_mfma_f32_16x16x32_bf16 a[128:131], a[204:207], v[144:147], a[128:131]
    v_mfma_f32_16x16x32_bf16 a[132:135], a[204:207], v[148:151], a[132:135]
    ds_read_b64_tr_b16 a[248:249], v13 offset:10496
    v_mfma_f32_16x16x32_bf16 a[136:139], a[204:207], v[152:155], a[136:139]
    buffer_load_dwordx4 v9, s[20:23], s46 offen offset:3072 lds
    v_mfma_f32_16x16x32_bf16 a[140:143], a[208:211], v[136:139], a[140:143]
    ds_read_b64_tr_b16 a[250:251], v13 offset:15616
    v_mfma_f32_16x16x32_bf16 a[144:147], a[208:211], v[140:143], a[144:147]
    s_add_u32 m0, s47, 49152
    v_mfma_f32_16x16x32_bf16 a[148:151], a[208:211], v[144:147], a[148:151]
    buffer_load_dwordx4 v10, s[20:23], s46 offen offset:0 lds
    v_mfma_f32_16x16x32_bf16 a[152:155], a[208:211], v[148:151], a[152:155]
    v_mfma_f32_16x16x32_bf16 a[156:159], a[208:211], v[152:155], a[156:159]
    v_mfma_f32_16x16x32_bf16 a[160:163], a[212:215], v[136:139], a[160:163]
    buffer_load_dwordx4 v11, s[20:23], s46 offen offset:1024 lds
    v_mfma_f32_16x16x32_bf16 a[164:167], a[212:215], v[140:143], a[164:167]
    v_mfma_f32_16x16x32_bf16 a[168:171], a[212:215], v[144:147], a[168:171]
    s_mov_b32 s55, s45
    v_mfma_f32_16x16x32_bf16 a[172:175], a[212:215], v[148:151], a[172:175]
    v_mfma_f32_16x16x32_bf16 a[176:179], a[212:215], v[152:155], a[176:179]
    s_waitcnt vmcnt(20) lgkmcnt(0)
    s_barrier
    v_add_u32 v15, 0, v17
    v_add_u32 v16, 0, v18
    v_mfma_f32_16x16x32_bf16 a[0:3], a[216:219], v[156:159], a[0:3]
    v_mfma_f32_16x16x32_bf16 a[4:7], a[216:219], v[160:163], a[4:7]
    ds_read_b64_tr_b16 a[180:181], v15 offset:0
    v_mfma_f32_16x16x32_bf16 a[8:11], a[216:219], v[164:167], a[8:11]
    s_add_u32 s50, s45, 0
    buffer_load_dwordx4 v[96:99], v12, s[16:19], s50 offen sc1
    v_mfma_f32_16x16x32_bf16 a[12:15], a[216:219], v[168:171], a[12:15]
    ds_read_b64_tr_b16 a[182:183], v15 offset:5120
    v_mfma_f32_16x16x32_bf16 a[16:19], a[216:219], v[172:175], a[16:19]
    v_mfma_f32_16x16x32_bf16 a[20:23], a[220:223], v[156:159], a[20:23]
    ds_read_b64_tr_b16 a[184:185], v16 offset:32
    v_mfma_f32_16x16x32_bf16 a[24:27], a[220:223], v[160:163], a[24:27]
    s_add_u32 s50, s45, 131072
    buffer_load_dwordx4 v[100:103], v12, s[16:19], s50 offen sc1
    v_mfma_f32_16x16x32_bf16 a[28:31], a[220:223], v[164:167], a[28:31]
    ds_read_b64_tr_b16 a[186:187], v16 offset:5152
    v_mfma_f32_16x16x32_bf16 a[32:35], a[220:223], v[168:171], a[32:35]
    v_mfma_f32_16x16x32_bf16 a[36:39], a[220:223], v[172:175], a[36:39]
    ds_read_b64_tr_b16 a[188:189], v15 offset:64
    v_mfma_f32_16x16x32_bf16 a[40:43], a[224:227], v[156:159], a[40:43]
    s_add_u32 s50, s45, 262144
    buffer_load_dwordx4 v[104:107], v12, s[16:19], s50 offen sc1
    v_mfma_f32_16x16x32_bf16 a[44:47], a[224:227], v[160:163], a[44:47]
    ds_read_b64_tr_b16 a[190:191], v15 offset:5184
    v_mfma_f32_16x16x32_bf16 a[48:51], a[224:227], v[164:167], a[48:51]
    v_mfma_f32_16x16x32_bf16 a[52:55], a[224:227], v[168:171], a[52:55]
    ds_read_b64_tr_b16 a[192:193], v16 offset:96
    v_mfma_f32_16x16x32_bf16 a[56:59], a[224:227], v[172:175], a[56:59]
    s_add_u32 s50, s45, 393216
    buffer_load_dwordx4 v[108:111], v12, s[16:19], s50 offen sc1
    v_mfma_f32_16x16x32_bf16 a[60:63], a[228:231], v[156:159], a[60:63]
    ds_read_b64_tr_b16 a[194:195], v16 offset:5216
    v_mfma_f32_16x16x32_bf16 a[64:67], a[228:231], v[160:163], a[64:67]
    v_mfma_f32_16x16x32_bf16 a[68:71], a[228:231], v[164:167], a[68:71]
    ds_read_b64_tr_b16 a[196:197], v15 offset:128
    v_mfma_f32_16x16x32_bf16 a[72:75], a[228:231], v[168:171], a[72:75]
    s_add_u32 s50, s45, 524288
    buffer_load_dwordx4 v[112:115], v12, s[16:19], s50 offen sc1
    v_mfma_f32_16x16x32_bf16 a[76:79], a[228:231], v[172:175], a[76:79]
    ds_read_b64_tr_b16 a[198:199], v15 offset:5248
    v_mfma_f32_16x16x32_bf16 a[80:83], a[232:235], v[156:159], a[80:83]
    v_mfma_f32_16x16x32_bf16 a[84:87], a[232:235], v[160:163], a[84:87]
    ds_read_b64_tr_b16 a[200:201], v16 offset:160
    v_mfma_f32_16x16x32_bf16 a[88:91], a[232:235], v[164:167], a[88:91]
    s_add_u32 s50, s45, 1024
    buffer_load_dwordx4 v[116:119], v12, s[16:19], s50 offen sc1
    v_mfma_f32_16x16x32_bf16 a[92:95], a[232:235], v[168:171], a[92:95]
    ds_read_b64_tr_b16 a[202:203], v16 offset:5280
    v_mfma_f32_16x16x32_bf16 a[96:99], a[232:235], v[172:175], a[96:99]
    v_mfma_f32_16x16x32_bf16 a[100:103], a[236:239], v[156:159], a[100:103]
    ds_read_b64_tr_b16 a[204:205], v15 offset:192
    v_mfma_f32_16x16x32_bf16 a[104:107], a[236:239], v[160:163], a[104:107]
    s_add_u32 s50, s45, 132096
    buffer_load_dwordx4 v[120:123], v12, s[16:19], s50 offen sc1
    v_mfma_f32_16x16x32_bf16 a[108:111], a[236:239], v[164:167], a[108:111]
    ds_read_b64_tr_b16 a[206:207], v15 offset:5312
    v_mfma_f32_16x16x32_bf16 a[112:115], a[236:239], v[168:171], a[112:115]
    v_mfma_f32_16x16x32_bf16 a[116:119], a[236:239], v[172:175], a[116:119]
    ds_read_b64_tr_b16 a[208:209], v16 offset:224
    v_mfma_f32_16x16x32_bf16 a[120:123], a[240:243], v[156:159], a[120:123]
    s_add_u32 s50, s45, 263168
    buffer_load_dwordx4 v[124:127], v12, s[16:19], s50 offen sc1
    v_mfma_f32_16x16x32_bf16 a[124:127], a[240:243], v[160:163], a[124:127]
    ds_read_b64_tr_b16 a[210:211], v16 offset:5344
    v_mfma_f32_16x16x32_bf16 a[128:131], a[240:243], v[164:167], a[128:131]
    v_mfma_f32_16x16x32_bf16 a[132:135], a[240:243], v[168:171], a[132:135]
    ds_read_b64_tr_b16 a[212:213], v15 offset:256
    v_mfma_f32_16x16x32_bf16 a[136:139], a[240:243], v[172:175], a[136:139]
    s_add_u32 s50, s45, 394240
    buffer_load_dwordx4 v[128:131], v12, s[16:19], s50 offen sc1
    v_mfma_f32_16x16x32_bf16 a[140:143], a[244:247], v[156:159], a[140:143]
    ds_read_b64_tr_b16 a[214:215], v15 offset:5376
    v_mfma_f32_16x16x32_bf16 a[144:147], a[244:247], v[160:163], a[144:147]
    v_mfma_f32_16x16x32_bf16 a[148:151], a[244:247], v[164:167], a[148:151]
    v_mfma_f32_16x16x32_bf16 a[152:155], a[244:247], v[168:171], a[152:155]
    s_add_u32 s50, s45, 525312
    buffer_load_dwordx4 v[132:135], v12, s[16:19], s50 offen sc1
    v_mfma_f32_16x16x32_bf16 a[156:159], a[244:247], v[172:175], a[156:159]
    v_mfma_f32_16x16x32_bf16 a[160:163], a[248:251], v[156:159], a[160:163]
    v_mfma_f32_16x16x32_bf16 a[164:167], a[248:251], v[160:163], a[164:167]
    v_mfma_f32_16x16x32_bf16 a[168:171], a[248:251], v[164:167], a[168:171]
    v_mfma_f32_16x16x32_bf16 a[172:175], a[248:251], v[168:171], a[172:175]
    v_mfma_f32_16x16x32_bf16 a[176:179], a[248:251], v[172:175], a[176:179]
    v_mov_b32 v13, v15
    v_mov_b32 v14, v16
    s_waitcnt vmcnt(20) lgkmcnt(0)
    v_mfma_f32_16x16x32_bf16 a[0:3], a[180:183], v[56:59], a[0:3]
    v_mfma_f32_16x16x32_bf16 a[4:7], a[180:183], v[60:63], a[4:7]
    ds_read_b64_tr_b16 a[216:217], v13 offset:10240
    v_mfma_f32_16x16x32_bf16 a[8:11], a[180:183], v[64:67], a[8:11]
    v_mfma_f32_16x16x32_bf16 a[12:15], a[180:183], v[68:71], a[12:15]
    ds_read_b64_tr_b16 a[218:219], v13 offset:15360
    v_mfma_f32_16x16x32_bf16 a[16:19], a[180:183], v[72:75], a[16:19]
    v_mfma_f32_16x16x32_bf16 a[20:23], a[184:187], v[56:59], a[20:23]
    ds_read_b64_tr_b16 a[220:221], v14 offset:10272
    v_mfma_f32_16x16x32_bf16 a[24:27], a[184:187], v[60:63], a[24:27]
    v_mfma_f32_16x16x32_bf16 a[28:31], a[184:187], v[64:67], a[28:31]
    ds_read_b64_tr_b16 a[222:223], v14 offset:15392
    v_mfma_f32_16x16x32_bf16 a[32:35], a[184:187], v[68:71], a[32:35]
    v_mfma_f32_16x16x32_bf16 a[36:39], a[184:187], v[72:75], a[36:39]
    ds_read_b64_tr_b16 a[224:225], v13 offset:10304
    v_mfma_f32_16x16x32_bf16 a[40:43], a[188:191], v[56:59], a[40:43]
    v_mfma_f32_16x16x32_bf16 a[44:47], a[188:191], v[60:63], a[44:47]
    ds_read_b64_tr_b16 a[226:227], v13 offset:15424
    v_mfma_f32_16x16x32_bf16 a[48:51], a[188:191], v[64:67], a[48:51]
    v_mfma_f32_16x16x32_bf16 a[52:55], a[188:191], v[68:71], a[52:55]
    ds_read_b64_tr_b16 a[228:229], v14 offset:10336
    v_mfma_f32_16x16x32_bf16 a[56:59], a[188:191], v[72:75], a[56:59]
    v_mfma_f32_16x16x32_bf16 a[60:63], a[192:195], v[56:59], a[60:63]
    ds_read_b64_tr_b16 a[230:231], v14 offset:15456
    v_mfma_f32_16x16x32_bf16 a[64:67], a[192:195], v[60:63], a[64:67]
    v_mfma_f32_16x16x32_bf16 a[68:71], a[192:195], v[64:67], a[68:71]
    ds_read_b64_tr_b16 a[232:233], v13 offset:10368
    v_mfma_f32_16x16x32_bf16 a[72:75], a[192:195], v[68:71], a[72:75]
    v_mfma_f32_16x16x32_bf16 a[76:79], a[192:195], v[72:75], a[76:79]
    ds_read_b64_tr_b16 a[234:235], v13 offset:15488
    v_mfma_f32_16x16x32_bf16 a[80:83], a[196:199], v[56:59], a[80:83]
    v_mfma_f32_16x16x32_bf16 a[84:87], a[196:199], v[60:63], a[84:87]
    ds_read_b64_tr_b16 a[236:237], v14 offset:10400
    v_mfma_f32_16x16x32_bf16 a[88:91], a[196:199], v[64:67], a[88:91]
    v_mfma_f32_16x16x32_bf16 a[92:95], a[196:199], v[68:71], a[92:95]
    ds_read_b64_tr_b16 a[238:239], v14 offset:15520
    v_mfma_f32_16x16x32_bf16 a[96:99], a[196:199], v[72:75], a[96:99]
    v_mfma_f32_16x16x32_bf16 a[100:103], a[200:203], v[56:59], a[100:103]
    ds_read_b64_tr_b16 a[240:241], v13 offset:10432
    v_mfma_f32_16x16x32_bf16 a[104:107], a[200:203], v[60:63], a[104:107]
    v_mfma_f32_16x16x32_bf16 a[108:111], a[200:203], v[64:67], a[108:111]
    ds_read_b64_tr_b16 a[242:243], v13 offset:15552
    v_mfma_f32_16x16x32_bf16 a[112:115], a[200:203], v[68:71], a[112:115]
    v_mfma_f32_16x16x32_bf16 a[116:119], a[200:203], v[72:75], a[116:119]
    ds_read_b64_tr_b16 a[244:245], v14 offset:10464
    v_mfma_f32_16x16x32_bf16 a[120:123], a[204:207], v[56:59], a[120:123]
    v_mfma_f32_16x16x32_bf16 a[124:127], a[204:207], v[60:63], a[124:127]
    ds_read_b64_tr_b16 a[246:247], v14 offset:15584
    v_mfma_f32_16x16x32_bf16 a[128:131], a[204:207], v[64:67], a[128:131]
    v_mfma_f32_16x16x32_bf16 a[132:135], a[204:207], v[68:71], a[132:135]
    ds_read_b64_tr_b16 a[248:249], v13 offset:10496
    v_mfma_f32_16x16x32_bf16 a[136:139], a[204:207], v[72:75], a[136:139]
    v_mfma_f32_16x16x32_bf16 a[140:143], a[208:211], v[56:59], a[140:143]
    ds_read_b64_tr_b16 a[250:251], v13 offset:15616
    v_mfma_f32_16x16x32_bf16 a[144:147], a[208:211], v[60:63], a[144:147]
    v_mfma_f32_16x16x32_bf16 a[148:151], a[208:211], v[64:67], a[148:151]
    v_mfma_f32_16x16x32_bf16 a[152:155], a[208:211], v[68:71], a[152:155]
    v_mfma_f32_16x16x32_bf16 a[156:159], a[208:211], v[72:75], a[156:159]
    v_mfma_f32_16x16x32_bf16 a[160:163], a[212:215], v[56:59], a[160:163]
    v_mfma_f32_16x16x32_bf16 a[164:167], a[212:215], v[60:63], a[164:167]
    v_mfma_f32_16x16x32_bf16 a[168:171], a[212:215], v[64:67], a[168:171]
    v_mfma_f32_16x16x32_bf16 a[172:175], a[212:215], v[68:71], a[172:175]
    v_mfma_f32_16x16x32_bf16 a[176:179], a[212:215], v[72:75], a[176:179]
    s_waitcnt vmcnt(10) lgkmcnt(0)
    s_barrier
    v_add_u32 v15, 40960, v17
    v_add_u32 v16, 40960, v18
    v_mfma_f32_16x16x32_bf16 a[0:3], a[216:219], v[76:79], a[0:3]
    v_mfma_f32_16x16x32_bf16 a[4:7], a[216:219], v[80:83], a[4:7]
    ds_read_b64_tr_b16 a[180:181], v15 offset:0
    v_mfma_f32_16x16x32_bf16 a[8:11], a[216:219], v[84:87], a[8:11]
    v_mfma_f32_16x16x32_bf16 a[12:15], a[216:219], v[88:91], a[12:15]
    ds_read_b64_tr_b16 a[182:183], v15 offset:5120
    v_mfma_f32_16x16x32_bf16 a[16:19], a[216:219], v[92:95], a[16:19]
    v_mfma_f32_16x16x32_bf16 a[20:23], a[220:223], v[76:79], a[20:23]
    ds_read_b64_tr_b16 a[184:185], v16 offset:32
    v_mfma_f32_16x16x32_bf16 a[24:27], a[220:223], v[80:83], a[24:27]
    v_mfma_f32_16x16x32_bf16 a[28:31], a[220:223], v[84:87], a[28:31]
    ds_read_b64_tr_b16 a[186:187], v16 offset:5152
    v_mfma_f32_16x16x32_bf16 a[32:35], a[220:223], v[88:91], a[32:35]
    v_mfma_f32_16x16x32_bf16 a[36:39], a[220:223], v[92:95], a[36:39]
    ds_read_b64_tr_b16 a[188:189], v15 offset:64
    v_mfma_f32_16x16x32_bf16 a[40:43], a[224:227], v[76:79], a[40:43]
    v_mfma_f32_16x16x32_bf16 a[44:47], a[224:227], v[80:83], a[44:47]
    ds_read_b64_tr_b16 a[190:191], v15 offset:5184
    v_mfma_f32_16x16x32_bf16 a[48:51], a[224:227], v[84:87], a[48:51]
    v_mfma_f32_16x16x32_bf16 a[52:55], a[224:227], v[88:91], a[52:55]
    ds_read_b64_tr_b16 a[192:193], v16 offset:96
    v_mfma_f32_16x16x32_bf16 a[56:59], a[224:227], v[92:95], a[56:59]
    v_mfma_f32_16x16x32_bf16 a[60:63], a[228:231], v[76:79], a[60:63]
    ds_read_b64_tr_b16 a[194:195], v16 offset:5216
    v_mfma_f32_16x16x32_bf16 a[64:67], a[228:231], v[80:83], a[64:67]
    v_mfma_f32_16x16x32_bf16 a[68:71], a[228:231], v[84:87], a[68:71]
    ds_read_b64_tr_b16 a[196:197], v15 offset:128
    v_mfma_f32_16x16x32_bf16 a[72:75], a[228:231], v[88:91], a[72:75]
    v_mfma_f32_16x16x32_bf16 a[76:79], a[228:231], v[92:95], a[76:79]
    ds_read_b64_tr_b16 a[198:199], v15 offset:5248
    v_mfma_f32_16x16x32_bf16 a[80:83], a[232:235], v[76:79], a[80:83]
    v_mfma_f32_16x16x32_bf16 a[84:87], a[232:235], v[80:83], a[84:87]
    ds_read_b64_tr_b16 a[200:201], v16 offset:160
    v_mfma_f32_16x16x32_bf16 a[88:91], a[232:235], v[84:87], a[88:91]
    v_mfma_f32_16x16x32_bf16 a[92:95], a[232:235], v[88:91], a[92:95]
    ds_read_b64_tr_b16 a[202:203], v16 offset:5280
    v_mfma_f32_16x16x32_bf16 a[96:99], a[232:235], v[92:95], a[96:99]
    v_mfma_f32_16x16x32_bf16 a[100:103], a[236:239], v[76:79], a[100:103]
    ds_read_b64_tr_b16 a[204:205], v15 offset:192
    v_mfma_f32_16x16x32_bf16 a[104:107], a[236:239], v[80:83], a[104:107]
    v_mfma_f32_16x16x32_bf16 a[108:111], a[236:239], v[84:87], a[108:111]
    ds_read_b64_tr_b16 a[206:207], v15 offset:5312
    v_mfma_f32_16x16x32_bf16 a[112:115], a[236:239], v[88:91], a[112:115]
    v_mfma_f32_16x16x32_bf16 a[116:119], a[236:239], v[92:95], a[116:119]
    ds_read_b64_tr_b16 a[208:209], v16 offset:224
    v_mfma_f32_16x16x32_bf16 a[120:123], a[240:243], v[76:79], a[120:123]
    v_mfma_f32_16x16x32_bf16 a[124:127], a[240:243], v[80:83], a[124:127]
    ds_read_b64_tr_b16 a[210:211], v16 offset:5344
    v_mfma_f32_16x16x32_bf16 a[128:131], a[240:243], v[84:87], a[128:131]
    v_mfma_f32_16x16x32_bf16 a[132:135], a[240:243], v[88:91], a[132:135]
    ds_read_b64_tr_b16 a[212:213], v15 offset:256
    v_mfma_f32_16x16x32_bf16 a[136:139], a[240:243], v[92:95], a[136:139]
    v_mfma_f32_16x16x32_bf16 a[140:143], a[244:247], v[76:79], a[140:143]
    ds_read_b64_tr_b16 a[214:215], v15 offset:5376
    v_mfma_f32_16x16x32_bf16 a[144:147], a[244:247], v[80:83], a[144:147]
    v_mfma_f32_16x16x32_bf16 a[148:151], a[244:247], v[84:87], a[148:151]
    v_mfma_f32_16x16x32_bf16 a[152:155], a[244:247], v[88:91], a[152:155]
    v_mfma_f32_16x16x32_bf16 a[156:159], a[244:247], v[92:95], a[156:159]
    v_mfma_f32_16x16x32_bf16 a[160:163], a[248:251], v[76:79], a[160:163]
    v_mfma_f32_16x16x32_bf16 a[164:167], a[248:251], v[80:83], a[164:167]
    v_mfma_f32_16x16x32_bf16 a[168:171], a[248:251], v[84:87], a[168:171]
    v_mfma_f32_16x16x32_bf16 a[172:175], a[248:251], v[88:91], a[172:175]
    v_mfma_f32_16x16x32_bf16 a[176:179], a[248:251], v[92:95], a[176:179]
    v_mov_b32 v13, v15
    v_mov_b32 v14, v16
    s_waitcnt vmcnt(0) lgkmcnt(0)
    v_mfma_f32_16x16x32_bf16 a[0:3], a[180:183], v[96:99], a[0:3]
    v_mfma_f32_16x16x32_bf16 a[4:7], a[180:183], v[100:103], a[4:7]
    ds_read_b64_tr_b16 a[216:217], v13 offset:10240
    v_mfma_f32_16x16x32_bf16 a[8:11], a[180:183], v[104:107], a[8:11]
    v_mfma_f32_16x16x32_bf16 a[12:15], a[180:183], v[108:111], a[12:15]
    ds_read_b64_tr_b16 a[218:219], v13 offset:15360
    v_mfma_f32_16x16x32_bf16 a[16:19], a[180:183], v[112:115], a[16:19]
    v_mfma_f32_16x16x32_bf16 a[20:23], a[184:187], v[96:99], a[20:23]
    ds_read_b64_tr_b16 a[220:221], v14 offset:10272
    v_mfma_f32_16x16x32_bf16 a[24:27], a[184:187], v[100:103], a[24:27]
    v_mfma_f32_16x16x32_bf16 a[28:31], a[184:187], v[104:107], a[28:31]
    ds_read_b64_tr_b16 a[222:223], v14 offset:15392
    v_mfma_f32_16x16x32_bf16 a[32:35], a[184:187], v[108:111], a[32:35]
    v_mfma_f32_16x16x32_bf16 a[36:39], a[184:187], v[112:115], a[36:39]
    ds_read_b64_tr_b16 a[224:225], v13 offset:10304
    v_mfma_f32_16x16x32_bf16 a[40:43], a[188:191], v[96:99], a[40:43]
    v_mfma_f32_16x16x32_bf16 a[44:47], a[188:191], v[100:103], a[44:47]
    ds_read_b64_tr_b16 a[226:227], v13 offset:15424
    v_mfma_f32_16x16x32_bf16 a[48:51], a[188:191], v[104:107], a[48:51]
    v_mfma_f32_16x16x32_bf16 a[52:55], a[188:191], v[108:111], a[52:55]
    ds_read_b64_tr_b16 a[228:229], v14 offset:10336
    v_mfma_f32_16x16x32_bf16 a[56:59], a[188:191], v[112:115], a[56:59]
    v_mfma_f32_16x16x32_bf16 a[60:63], a[192:195], v[96:99], a[60:63]
    ds_read_b64_tr_b16 a[230:231], v14 offset:15456
    v_mfma_f32_16x16x32_bf16 a[64:67], a[192:195], v[100:103], a[64:67]
    v_mfma_f32_16x16x32_bf16 a[68:71], a[192:195], v[104:107], a[68:71]
    ds_read_b64_tr_b16 a[232:233], v13 offset:10368
    v_mfma_f32_16x16x32_bf16 a[72:75], a[192:195], v[108:111], a[72:75]
    v_mfma_f32_16x16x32_bf16 a[76:79], a[192:195], v[112:115], a[76:79]
    ds_read_b64_tr_b16 a[234:235], v13 offset:15488
    v_mfma_f32_16x16x32_bf16 a[80:83], a[196:199], v[96:99], a[80:83]
    v_mfma_f32_16x16x32_bf16 a[84:87], a[196:199], v[100:103], a[84:87]
    ds_read_b64_tr_b16 a[236:237], v14 offset:10400
    v_mfma_f32_16x16x32_bf16 a[88:91], a[196:199], v[104:107], a[88:91]
    v_mfma_f32_16x16x32_bf16 a[92:95], a[196:199], v[108:111], a[92:95]
    ds_read_b64_tr_b16 a[238:239], v14 offset:15520
    v_mfma_f32_16x16x32_bf16 a[96:99], a[196:199], v[112:115], a[96:99]
    v_mfma_f32_16x16x32_bf16 a[100:103], a[200:203], v[96:99], a[100:103]
    ds_read_b64_tr_b16 a[240:241], v13 offset:10432
    v_mfma_f32_16x16x32_bf16 a[104:107], a[200:203], v[100:103], a[104:107]
    v_mfma_f32_16x16x32_bf16 a[108:111], a[200:203], v[104:107], a[108:111]
    ds_read_b64_tr_b16 a[242:243], v13 offset:15552
    v_mfma_f32_16x16x32_bf16 a[112:115], a[200:203], v[108:111], a[112:115]
    v_mfma_f32_16x16x32_bf16 a[116:119], a[200:203], v[112:115], a[116:119]
    ds_read_b64_tr_b16 a[244:245], v14 offset:10464
    v_mfma_f32_16x16x32_bf16 a[120:123], a[204:207], v[96:99], a[120:123]
    v_mfma_f32_16x16x32_bf16 a[124:127], a[204:207], v[100:103], a[124:127]
    ds_read_b64_tr_b16 a[246:247], v14 offset:15584
    v_mfma_f32_16x16x32_bf16 a[128:131], a[204:207], v[104:107], a[128:131]
    v_mfma_f32_16x16x32_bf16 a[132:135], a[204:207], v[108:111], a[132:135]
    ds_read_b64_tr_b16 a[248:249], v13 offset:10496
    v_mfma_f32_16x16x32_bf16 a[136:139], a[204:207], v[112:115], a[136:139]
    v_mfma_f32_16x16x32_bf16 a[140:143], a[208:211], v[96:99], a[140:143]
    ds_read_b64_tr_b16 a[250:251], v13 offset:15616
    v_mfma_f32_16x16x32_bf16 a[144:147], a[208:211], v[100:103], a[144:147]
    v_mfma_f32_16x16x32_bf16 a[148:151], a[208:211], v[104:107], a[148:151]
    v_mfma_f32_16x16x32_bf16 a[152:155], a[208:211], v[108:111], a[152:155]
    v_mfma_f32_16x16x32_bf16 a[156:159], a[208:211], v[112:115], a[156:159]
    v_mfma_f32_16x16x32_bf16 a[160:163], a[212:215], v[96:99], a[160:163]
    v_mfma_f32_16x16x32_bf16 a[164:167], a[212:215], v[100:103], a[164:167]
    v_mfma_f32_16x16x32_bf16 a[168:171], a[212:215], v[104:107], a[168:171]
    v_mfma_f32_16x16x32_bf16 a[172:175], a[212:215], v[108:111], a[172:175]
    v_mfma_f32_16x16x32_bf16 a[176:179], a[212:215], v[112:115], a[176:179]
    s_waitcnt lgkmcnt(0)
    v_mfma_f32_16x16x32_bf16 a[0:3], a[216:219], v[116:119], a[0:3]
    v_mfma_f32_16x16x32_bf16 a[4:7], a[216:219], v[120:123], a[4:7]
    v_mfma_f32_16x16x32_bf16 a[8:11], a[216:219], v[124:127], a[8:11]
    v_mfma_f32_16x16x32_bf16 a[12:15], a[216:219], v[128:131], a[12:15]
    v_mfma_f32_16x16x32_bf16 a[16:19], a[216:219], v[132:135], a[16:19]
    v_mfma_f32_16x16x32_bf16 a[20:23], a[220:223], v[116:119], a[20:23]
    v_mfma_f32_16x16x32_bf16 a[24:27], a[220:223], v[120:123], a[24:27]
    v_mfma_f32_16x16x32_bf16 a[28:31], a[220:223], v[124:127], a[28:31]
    v_mfma_f32_16x16x32_bf16 a[32:35], a[220:223], v[128:131], a[32:35]
    v_mfma_f32_16x16x32_bf16 a[36:39], a[220:223], v[132:135], a[36:39]
    v_mfma_f32_16x16x32_bf16 a[40:43], a[224:227], v[116:119], a[40:43]
    v_mfma_f32_16x16x32_bf16 a[44:47], a[224:227], v[120:123], a[44:47]
    v_mfma_f32_16x16x32_bf16 a[48:51], a[224:227], v[124:127], a[48:51]
    v_mfma_f32_16x16x32_bf16 a[52:55], a[224:227], v[128:131], a[52:55]
    v_mfma_f32_16x16x32_bf16 a[56:59], a[224:227], v[132:135], a[56:59]
    v_mfma_f32_16x16x32_bf16 a[60:63], a[228:231], v[116:119], a[60:63]
    v_mfma_f32_16x16x32_bf16 a[64:67], a[228:231], v[120:123], a[64:67]
    v_mfma_f32_16x16x32_bf16 a[68:71], a[228:231], v[124:127], a[68:71]
    v_mfma_f32_16x16x32_bf16 a[72:75], a[228:231], v[128:131], a[72:75]
    v_mfma_f32_16x16x32_bf16 a[76:79], a[228:231], v[132:135], a[76:79]
    v_mfma_f32_16x16x32_bf16 a[80:83], a[232:235], v[116:119], a[80:83]
    v_mfma_f32_16x16x32_bf16 a[84:87], a[232:235], v[120:123], a[84:87]
    v_mfma_f32_16x16x32_bf16 a[88:91], a[232:235], v[124:127], a[88:91]
    v_mfma_f32_16x16x32_bf16 a[92:95], a[232:235], v[128:131], a[92:95]
    v_mfma_f32_16x16x32_bf16 a[96:99], a[232:235], v[132:135], a[96:99]
    v_mfma_f32_16x16x32_bf16 a[100:103], a[236:239], v[116:119], a[100:103]
    v_mfma_f32_16x16x32_bf16 a[104:107], a[236:239], v[120:123], a[104:107]
    v_mfma_f32_16x16x32_bf16 a[108:111], a[236:239], v[124:127], a[108:111]
    v_mfma_f32_16x16x32_bf16 a[112:115], a[236:239], v[128:131], a[112:115]
    v_mfma_f32_16x16x32_bf16 a[116:119], a[236:239], v[132:135], a[116:119]
    v_mfma_f32_16x16x32_bf16 a[120:123], a[240:243], v[116:119], a[120:123]
    v_mfma_f32_16x16x32_bf16 a[124:127], a[240:243], v[120:123], a[124:127]
    v_mfma_f32_16x16x32_bf16 a[128:131], a[240:243], v[124:127], a[128:131]
    v_mfma_f32_16x16x32_bf16 a[132:135], a[240:243], v[128:131], a[132:135]
    v_mfma_f32_16x16x32_bf16 a[136:139], a[240:243], v[132:135], a[136:139]
    v_mfma_f32_16x16x32_bf16 a[140:143], a[244:247], v[116:119], a[140:143]
    v_mfma_f32_16x16x32_bf16 a[144:147], a[244:247], v[120:123], a[144:147]
    v_mfma_f32_16x16x32_bf16 a[148:151], a[244:247], v[124:127], a[148:151]
    v_mfma_f32_16x16x32_bf16 a[152:155], a[244:247], v[128:131], a[152:155]
    v_mfma_f32_16x16x32_bf16 a[156:159], a[244:247], v[132:135], a[156:159]
    v_mfma_f32_16x16x32_bf16 a[160:163], a[248:251], v[116:119], a[160:163]
    v_mfma_f32_16x16x32_bf16 a[164:167], a[248:251], v[120:123], a[164:167]
    v_mfma_f32_16x16x32_bf16 a[168:171], a[248:251], v[124:127], a[168:171]
    v_mfma_f32_16x16x32_bf16 a[172:175], a[248:251], v[128:131], a[172:175]
    v_mfma_f32_16x16x32_bf16 a[176:179], a[248:251], v[132:135], a[176:179]
    s_barrier
    s_mul_i32 s48, s42, 47104
    v_add_u32 v19, s48, v12
    s_nop 4
    s_lshl_b32 s48, s41, 2
    s_add_u32 s48, s48, s36
    s_mul_i32 s48, s48, 12288
    s_cmp_eq_u32 s43, 0
    s_cbranch_scc0 P2_RED1
    ds_write_b128 v19, a[92:95] offset:23552
    v_accvgpr_read_b32 v56, a0
    v_accvgpr_read_b32 v57, a1
    v_accvgpr_read_b32 v58, a2
    v_accvgpr_read_b32 v59, a3
    ds_write_b128 v19, a[96:99] offset:24576
    v_accvgpr_read_b32 v60, a4
    v_accvgpr_read_b32 v61, a5
    v_accvgpr_read_b32 v62, a6
    v_accvgpr_read_b32 v63, a7
    ds_write_b128 v19, a[100:103] offset:25600
    v_accvgpr_read_b32 v64, a8
    v_accvgpr_read_b32 v65, a9
    v_accvgpr_read_b32 v66, a10
    v_accvgpr_read_b32 v67, a11
    ds_write_b128 v19, a[104:107] offset:26624
    v_accvgpr_read_b32 v68, a12
    v_accvgpr_read_b32 v69, a13
    v_accvgpr_read_b32 v70, a14
    v_accvgpr_read_b32 v71, a15
    ds_write_b128 v19, a[108:111] offset:27648
    v_accvgpr_read_b32 v72, a16
    v_accvgpr_read_b32 v73, a17
    v_accvgpr_read_b32 v74, a18
    v_accvgpr_read_b32 v75, a19
    ds_write_b128 v19, a[112:115] offset:28672
    v_accvgpr_read_b32 v76, a20
    v_accvgpr_read_b32 v77, a21
    v_accvgpr_read_b32 v78, a22
    v_accvgpr_read_b32 v79, a23
    ds_write_b128 v19, a[116:119] offset:29696
    v_accvgpr_read_b32 v80, a24
    v_accvgpr_read_b32 v81, a25
    v_accvgpr_read_b32 v82, a26
    v_accvgpr_read_b32 v83, a27
    ds_write_b128 v19, a[120:123] offset:30720
    v_accvgpr_read_b32 v84, a28
    v_accvgpr_read_b32 v85, a29
    v_accvgpr_read_b32 v86, a30
    v_accvgpr_read_b32 v87, a31
    ds_write_b128 v19, a[124:127] offset:31744
    v_accvgpr_read_b32 v88, a32
    v_accvgpr_read_b32 v89, a33
    v_accvgpr_read_b32 v90, a34
    v_accvgpr_read_b32 v91, a35
    ds_write_b128 v19, a[128:131] offset:32768
    v_accvgpr_read_b32 v92, a36
    v_accvgpr_read_b32 v93, a37
    v_accvgpr_read_b32 v94, a38
    v_accvgpr_read_b32 v95, a39
    ds_write_b128 v19, a[132:135] offset:33792
    v_accvgpr_read_b32 v96, a40
    v_accvgpr_read_b32 v97, a41
    v_accvgpr_read_b32 v98, a42
    v_accvgpr_read_b32 v99, a43
    ds_write_b128 v19, a[136:139] offset:34816
    v_accvgpr_read_b32 v100, a44
    v_accvgpr_read_b32 v101, a45
    v_accvgpr_read_b32 v102, a46
    v_accvgpr_read_b32 v103, a47
    ds_write_b128 v19, a[140:143] offset:35840
    v_accvgpr_read_b32 v104, a48
    v_accvgpr_read_b32 v105, a49
    v_accvgpr_read_b32 v106, a50
    v_accvgpr_read_b32 v107, a51
    ds_write_b128 v19, a[144:147] offset:36864
    v_accvgpr_read_b32 v108, a52
    v_accvgpr_read_b32 v109, a53
    v_accvgpr_read_b32 v110, a54
    v_accvgpr_read_b32 v111, a55
    ds_write_b128 v19, a[148:151] offset:37888
    v_accvgpr_read_b32 v112, a56
    v_accvgpr_read_b32 v113, a57
    v_accvgpr_read_b32 v114, a58
    v_accvgpr_read_b32 v115, a59
    ds_write_b128 v19, a[152:155] offset:38912
    v_accvgpr_read_b32 v116, a60
    v_accvgpr_read_b32 v117, a61
    v_accvgpr_read_b32 v118, a62
    v_accvgpr_read_b32 v119, a63
    ds_write_b128 v19, a[156:159] offset:39936
    v_accvgpr_read_b32 v120, a64
    v_accvgpr_read_b32 v121, a65
    v_accvgpr_read_b32 v122, a66
    v_accvgpr_read_b32 v123, a67
    ds_write_b128 v19, a[160:163] offset:40960
    v_accvgpr_read_b32 v124, a68
    v_accvgpr_read_b32 v125, a69
    v_accvgpr_read_b32 v126, a70
    v_accvgpr_read_b32 v127, a71
    ds_write_b128 v19, a[164:167] offset:41984
    v_accvgpr_read_b32 v128, a72
    v_accvgpr_read_b32 v129, a73
    v_accvgpr_read_b32 v130, a74
    v_accvgpr_read_b32 v131, a75
    ds_write_b128 v19, a[168:171] offset:43008
    v_accvgpr_read_b32 v132, a76
    v_accvgpr_read_b32 v133, a77
    v_accvgpr_read_b32 v134, a78
    v_accvgpr_read_b32 v135, a79
    ds_write_b128 v19, a[172:175] offset:44032
    v_accvgpr_read_b32 v136, a80
    v_accvgpr_read_b32 v137, a81
    v_accvgpr_read_b32 v138, a82
    v_accvgpr_read_b32 v139, a83
    ds_write_b128 v19, a[176:179] offset:45056
    v_accvgpr_read_b32 v140, a84
    v_accvgpr_read_b32 v141, a85
    v_accvgpr_read_b32 v142, a86
    v_accvgpr_read_b32 v143, a87
    v_accvgpr_read_b32 v144, a88
    v_accvgpr_read_b32 v145, a89
    v_accvgpr_read_b32 v146, a90
    v_accvgpr_read_b32 v147, a91
    s_waitcnt lgkmcnt(0)
    s_barrier
    ds_read_b128 v[148:151], v19 offset:0
    ds_read_b128 v[152:155], v19 offset:1024
    ds_read_b128 v[156:159], v19 offset:2048
    ds_read_b128 v[160:163], v19 offset:3072
    ds_read_b128 v[164:167], v19 offset:4096
    ds_read_b128 v[168:171], v19 offset:5120
    ds_read_b128 v[172:175], v19 offset:6144
    ds_read_b128 v[176:179], v19 offset:7168
    ds_read_b128 v[180:183], v19 offset:8192
    ds_read_b128 v[184:187], v19 offset:9216
    ds_read_b128 v[188:191], v19 offset:10240
    ds_read_b128 v[192:195], v19 offset:11264
    s_waitcnt lgkmcnt(0)
    v_pk_add_f32 v[56:57], v[56:57], v[148:149]
    v_pk_add_f32 v[58:59], v[58:59], v[150:151]
    v_cvt_pk_bf16_f32 v200, v56, v57
    v_cvt_pk_bf16_f32 v201, v58, v59
    v_pk_add_f32 v[60:61], v[60:61], v[152:153]
    v_pk_add_f32 v[62:63], v[62:63], v[154:155]
    v_cvt_pk_bf16_f32 v202, v60, v61
    v_cvt_pk_bf16_f32 v203, v62, v63
    v_pk_add_f32 v[64:65], v[64:65], v[156:157]
    v_pk_add_f32 v[66:67], v[66:67], v[158:159]
    v_cvt_pk_bf16_f32 v204, v64, v65
    v_cvt_pk_bf16_f32 v205, v66, v67
    v_pk_add_f32 v[68:69], v[68:69], v[160:161]
    v_pk_add_f32 v[70:71], v[70:71], v[162:163]
    v_cvt_pk_bf16_f32 v206, v68, v69
    v_cvt_pk_bf16_f32 v207, v70, v71
    v_pk_add_f32 v[72:73], v[72:73], v[164:165]
    v_pk_add_f32 v[74:75], v[74:75], v[166:167]
    v_cvt_pk_bf16_f32 v208, v72, v73
    v_cvt_pk_bf16_f32 v209, v74, v75
    v_pk_add_f32 v[76:77], v[76:77], v[168:169]
    v_pk_add_f32 v[78:79], v[78:79], v[170:171]
    v_cvt_pk_bf16_f32 v210, v76, v77
    v_cvt_pk_bf16_f32 v211, v78, v79
    v_pk_add_f32 v[80:81], v[80:81], v[172:173]
    v_pk_add_f32 v[82:83], v[82:83], v[174:175]
    v_cvt_pk_bf16_f32 v212, v80, v81
    v_cvt_pk_bf16_f32 v213, v82, v83
    v_pk_add_f32 v[84:85], v[84:85], v[176:177]
    v_pk_add_f32 v[86:87], v[86:87], v[178:179]
    v_cvt_pk_bf16_f32 v214, v84, v85
    v_cvt_pk_bf16_f32 v215, v86, v87
    v_pk_add_f32 v[88:89], v[88:89], v[180:181]
    v_pk_add_f32 v[90:91], v[90:91], v[182:183]
    v_cvt_pk_bf16_f32 v216, v88, v89
    v_cvt_pk_bf16_f32 v217, v90, v91
    v_pk_add_f32 v[92:93], v[92:93], v[184:185]
    v_pk_add_f32 v[94:95], v[94:95], v[186:187]
    v_cvt_pk_bf16_f32 v218, v92, v93
    v_cvt_pk_bf16_f32 v219, v94, v95
    v_pk_add_f32 v[96:97], v[96:97], v[188:189]
    v_pk_add_f32 v[98:99], v[98:99], v[190:191]
    v_cvt_pk_bf16_f32 v220, v96, v97
    v_cvt_pk_bf16_f32 v221, v98, v99
    v_pk_add_f32 v[100:101], v[100:101], v[192:193]
    v_pk_add_f32 v[102:103], v[102:103], v[194:195]
    v_cvt_pk_bf16_f32 v222, v100, v101
    v_cvt_pk_bf16_f32 v223, v102, v103
    s_add_u32 s49, s48, 0
    s_cmp_eq_u32 s41, 0
    s_cselect_b32 s49, 1073741824, s49
    buffer_store_dwordx4 v[200:203], v12, s[24:27], s49 offen sc1
    s_add_u32 s49, s48, 1024
    s_cmp_eq_u32 s41, 1
    s_cselect_b32 s49, 1073741824, s49
    buffer_store_dwordx4 v[204:207], v12, s[24:27], s49 offen sc1
    s_add_u32 s49, s48, 2048
    s_cmp_eq_u32 s41, 2
    s_cselect_b32 s49, 1073741824, s49
    buffer_store_dwordx4 v[208:211], v12, s[24:27], s49 offen sc1
    s_add_u32 s49, s48, 3072
    s_cmp_eq_u32 s41, 3
    s_cselect_b32 s49, 1073741824, s49
    buffer_store_dwordx4 v[212:215], v12, s[24:27], s49 offen sc1
    s_add_u32 s49, s48, 4096
    s_cmp_eq_u32 s41, 0
    s_cselect_b32 s49, 1073741824, s49
    buffer_store_dwordx4 v[216:219], v12, s[24:27], s49 offen sc1
    s_add_u32 s49, s48, 5120
    s_cmp_eq_u32 s41, 1
    s_cselect_b32 s49, 1073741824, s49
    buffer_store_dwordx4 v[220:223], v12, s[24:27], s49 offen sc1
    ds_read_b128 v[148:151], v19 offset:12288
    ds_read_b128 v[152:155], v19 offset:13312
    ds_read_b128 v[156:159], v19 offset:14336
    ds_read_b128 v[160:163], v19 offset:15360
    ds_read_b128 v[164:167], v19 offset:16384
    ds_read_b128 v[168:171], v19 offset:17408
    ds_read_b128 v[172:175], v19 offset:18432
    ds_read_b128 v[176:179], v19 offset:19456
    ds_read_b128 v[180:183], v19 offset:20480
    ds_read_b128 v[184:187], v19 offset:21504
    ds_read_b128 v[188:191], v19 offset:22528
    s_waitcnt lgkmcnt(0)
    v_pk_add_f32 v[104:105], v[104:105], v[148:149]
    v_pk_add_f32 v[106:107], v[106:107], v[150:151]
    v_cvt_pk_bf16_f32 v224, v104, v105
    v_cvt_pk_bf16_f32 v225, v106, v107
    v_pk_add_f32 v[108:109], v[108:109], v[152:153]
    v_pk_add_f32 v[110:111], v[110:111], v[154:155]
    v_cvt_pk_bf16_f32 v226, v108, v109
    v_cvt_pk_bf16_f32 v227, v110, v111
    v_pk_add_f32 v[112:113], v[112:113], v[156:157]
    v_pk_add_f32 v[114:115], v[114:115], v[158:159]
    v_cvt_pk_bf16_f32 v228, v112, v113
    v_cvt_pk_bf16_f32 v229, v114, v115
    v_pk_add_f32 v[116:117], v[116:117], v[160:161]
    v_pk_add_f32 v[118:119], v[118:119], v[162:163]
    v_cvt_pk_bf16_f32 v230, v116, v117
    v_cvt_pk_bf16_f32 v231, v118, v119
    v_pk_add_f32 v[120:121], v[120:121], v[164:165]
    v_pk_add_f32 v[122:123], v[122:123], v[166:167]
    v_cvt_pk_bf16_f32 v232, v120, v121
    v_cvt_pk_bf16_f32 v233, v122, v123
    v_pk_add_f32 v[124:125], v[124:125], v[168:169]
    v_pk_add_f32 v[126:127], v[126:127], v[170:171]
    v_cvt_pk_bf16_f32 v234, v124, v125
    v_cvt_pk_bf16_f32 v235, v126, v127
    v_pk_add_f32 v[128:129], v[128:129], v[172:173]
    v_pk_add_f32 v[130:131], v[130:131], v[174:175]
    v_cvt_pk_bf16_f32 v236, v128, v129
    v_cvt_pk_bf16_f32 v237, v130, v131
    v_pk_add_f32 v[132:133], v[132:133], v[176:177]
    v_pk_add_f32 v[134:135], v[134:135], v[178:179]
    v_cvt_pk_bf16_f32 v238, v132, v133
    v_cvt_pk_bf16_f32 v239, v134, v135
    v_pk_add_f32 v[136:137], v[136:137], v[180:181]
    v_pk_add_f32 v[138:139], v[138:139], v[182:183]
    v_cvt_pk_bf16_f32 v240, v136, v137
    v_cvt_pk_bf16_f32 v241, v138, v139
    v_pk_add_f32 v[140:141], v[140:141], v[184:185]
    v_pk_add_f32 v[142:143], v[142:143], v[186:187]
    v_cvt_pk_bf16_f32 v242, v140, v141
    v_cvt_pk_bf16_f32 v243, v142, v143
    v_pk_add_f32 v[144:145], v[144:145], v[188:189]
    v_pk_add_f32 v[146:147], v[146:147], v[190:191]
    v_cvt_pk_bf16_f32 v244, v144, v145
    v_cvt_pk_bf16_f32 v245, v146, v147
    s_add_u32 s49, s48, 6144
    s_cmp_eq_u32 s41, 2
    s_cselect_b32 s49, 1073741824, s49
    buffer_store_dwordx4 v[224:227], v12, s[24:27], s49 offen sc1
    s_add_u32 s49, s48, 7168
    s_cmp_eq_u32 s41, 3
    s_cselect_b32 s49, 1073741824, s49
    buffer_store_dwordx4 v[228:231], v12, s[24:27], s49 offen sc1
    s_add_u32 s49, s48, 8192
    s_cmp_eq_u32 s41, 0
    s_cselect_b32 s49, 1073741824, s49
    buffer_store_dwordx4 v[232:235], v12, s[24:27], s49 offen sc1
    s_add_u32 s49, s48, 9216
    s_cmp_eq_u32 s41, 1
    s_cselect_b32 s49, 1073741824, s49
    buffer_store_dwordx4 v[236:239], v12, s[24:27], s49 offen sc1
    s_add_u32 s49, s48, 10240
    s_cmp_eq_u32 s41, 2
    s_cselect_b32 s49, 1073741824, s49
    buffer_store_dwordx4 v[240:243], v12, s[24:27], s49 offen sc1
    s_add_u32 s49, s48, 11264
    s_cmp_eq_u32 s41, 3
    s_cselect_b32 s49, 1073741824, s49
    buffer_store_dwordx4 v[244:247], v12, s[24:27], s49 offen sc1
    s_branch P2_RED2
P2_RED1:
    ds_write_b128 v19, a[0:3] offset:0
    v_accvgpr_read_b32 v56, a92
    v_accvgpr_read_b32 v57, a93
    v_accvgpr_read_b32 v58, a94
    v_accvgpr_read_b32 v59, a95
    ds_write_b128 v19, a[4:7] offset:1024
    v_accvgpr_read_b32 v60, a96
    v_accvgpr_read_b32 v61, a97
    v_accvgpr_read_b32 v62, a98
    v_accvgpr_read_b32 v63, a99
    ds_write_b128 v19, a[8:11] offset:2048
    v_accvgpr_read_b32 v64, a100
    v_accvgpr_read_b32 v65, a101
    v_accvgpr_read_b32 v66, a102
    v_accvgpr_read_b32 v67, a103
    ds_write_b128 v19, a[12:15] offset:3072
    v_accvgpr_read_b32 v68, a104
    v_accvgpr_read_b32 v69, a105
    v_accvgpr_read_b32 v70, a106
    v_accvgpr_read_b32 v71, a107
    ds_write_b128 v19, a[16:19] offset:4096
    v_accvgpr_read_b32 v72, a108
    v_accvgpr_read_b32 v73, a109
    v_accvgpr_read_b32 v74, a110
    v_accvgpr_read_b32 v75, a111
    ds_write_b128 v19, a[20:23] offset:5120
    v_accvgpr_read_b32 v76, a112
    v_accvgpr_read_b32 v77, a113
    v_accvgpr_read_b32 v78, a114
    v_accvgpr_read_b32 v79, a115
    ds_write_b128 v19, a[24:27] offset:6144
    v_accvgpr_read_b32 v80, a116
    v_accvgpr_read_b32 v81, a117
    v_accvgpr_read_b32 v82, a118
    v_accvgpr_read_b32 v83, a119
    ds_write_b128 v19, a[28:31] offset:7168
    v_accvgpr_read_b32 v84, a120
    v_accvgpr_read_b32 v85, a121
    v_accvgpr_read_b32 v86, a122
    v_accvgpr_read_b32 v87, a123
    ds_write_b128 v19, a[32:35] offset:8192
    v_accvgpr_read_b32 v88, a124
    v_accvgpr_read_b32 v89, a125
    v_accvgpr_read_b32 v90, a126
    v_accvgpr_read_b32 v91, a127
    ds_write_b128 v19, a[36:39] offset:9216
    v_accvgpr_read_b32 v92, a128
    v_accvgpr_read_b32 v93, a129
    v_accvgpr_read_b32 v94, a130
    v_accvgpr_read_b32 v95, a131
    ds_write_b128 v19, a[40:43] offset:10240
    v_accvgpr_read_b32 v96, a132
    v_accvgpr_read_b32 v97, a133
    v_accvgpr_read_b32 v98, a134
    v_accvgpr_read_b32 v99, a135
    ds_write_b128 v19, a[44:47] offset:11264
    v_accvgpr_read_b32 v100, a136
    v_accvgpr_read_b32 v101, a137
    v_accvgpr_read_b32 v102, a138
    v_accvgpr_read_b32 v103, a139
    ds_write_b128 v19, a[48:51] offset:12288
    v_accvgpr_read_b32 v104, a140
    v_accvgpr_read_b32 v105, a141
    v_accvgpr_read_b32 v106, a142
    v_accvgpr_read_b32 v107, a143
    ds_write_b128 v19, a[52:55] offset:13312
    v_accvgpr_read_b32 v108, a144
    v_accvgpr_read_b32 v109, a145
    v_accvgpr_read_b32 v110, a146
    v_accvgpr_read_b32 v111, a147
    ds_write_b128 v19, a[56:59] offset:14336
    v_accvgpr_read_b32 v112, a148
    v_accvgpr_read_b32 v113, a149
    v_accvgpr_read_b32 v114, a150
    v_accvgpr_read_b32 v115, a151
    ds_write_b128 v19, a[60:63] offset:15360
    v_accvgpr_read_b32 v116, a152
    v_accvgpr_read_b32 v117, a153
    v_accvgpr_read_b32 v118, a154
    v_accvgpr_read_b32 v119, a155
    ds_write_b128 v19, a[64:67] offset:16384
    v_accvgpr_read_b32 v120, a156
    v_accvgpr_read_b32 v121, a157
    v_accvgpr_read_b32 v122, a158
    v_accvgpr_read_b32 v123, a159
    ds_write_b128 v19, a[68:71] offset:17408
    v_accvgpr_read_b32 v124, a160
    v_accvgpr_read_b32 v125, a161
    v_accvgpr_read_b32 v126, a162
    v_accvgpr_read_b32 v127, a163
    ds_write_b128 v19, a[72:75] offset:18432
    v_accvgpr_read_b32 v128, a164
    v_accvgpr_read_b32 v129, a165
    v_accvgpr_read_b32 v130, a166
    v_accvgpr_read_b32 v131, a167
    ds_write_b128 v19, a[76:79] offset:19456
    v_accvgpr_read_b32 v132, a168
    v_accvgpr_read_b32 v133, a169
    v_accvgpr_read_b32 v134, a170
    v_accvgpr_read_b32 v135, a171
    ds_write_b128 v19, a[80:83] offset:20480
    v_accvgpr_read_b32 v136, a172
    v_accvgpr_read_b32 v137, a173
    v_accvgpr_read_b32 v138, a174
    v_accvgpr_read_b32 v139, a175
    ds_write_b128 v19, a[84:87] offset:21504
    v_accvgpr_read_b32 v140, a176
    v_accvgpr_read_b32 v141, a177
    v_accvgpr_read_b32 v142, a178
    v_accvgpr_read_b32 v143, a179
    ds_write_b128 v19, a[88:91] offset:22528
    s_waitcnt lgkmcnt(0)
    s_barrier
    ds_read_b128 v[148:151], v19 offset:23552
    ds_read_b128 v[152:155], v19 offset:24576
    ds_read_b128 v[156:159], v19 offset:25600
    ds_read_b128 v[160:163], v19 offset:26624
    ds_read_b128 v[164:167], v19 offset:27648
    ds_read_b128 v[168:171], v19 offset:28672
    ds_read_b128 v[172:175], v19 offset:29696
    ds_read_b128 v[176:179], v19 offset:30720
    ds_read_b128 v[180:183], v19 offset:31744
    ds_read_b128 v[184:187], v19 offset:32768
    ds_read_b128 v[188:191], v19 offset:33792
    ds_read_b128 v[192:195], v19 offset:34816
    s_waitcnt lgkmcnt(0)
    v_pk_add_f32 v[56:57], v[56:57], v[148:149]
    v_pk_add_f32 v[58:59], v[58:59], v[150:151]
    v_cvt_pk_bf16_f32 v200, v56, v57
    v_cvt_pk_bf16_f32 v201, v58, v59
    v_pk_add_f32 v[60:61], v[60:61], v[152:153]
    v_pk_add_f32 v[62:63], v[62:63], v[154:155]
    v_cvt_pk_bf16_f32 v202, v60, v61
    v_cvt_pk_bf16_f32 v203, v62, v63
    v_pk_add_f32 v[64:65], v[64:65], v[156:157]
    v_pk_add_f32 v[66:67], v[66:67], v[158:159]
    v_cvt_pk_bf16_f32 v204, v64, v65
    v_cvt_pk_bf16_f32 v205, v66, v67
    v_pk_add_f32 v[68:69], v[68:69], v[160:161]
    v_pk_add_f32 v[70:71], v[70:71], v[162:163]
    v_cvt_pk_bf16_f32 v206, v68, v69
    v_cvt_pk_bf16_f32 v207, v70, v71
    v_pk_add_f32 v[72:73], v[72:73], v[164:165]
    v_pk_add_f32 v[74:75], v[74:75], v[166:167]
    v_cvt_pk_bf16_f32 v208, v72, v73
    v_cvt_pk_bf16_f32 v209, v74, v75
    v_pk_add_f32 v[76:77], v[76:77], v[168:169]
    v_pk_add_f32 v[78:79], v[78:79], v[170:171]
    v_cvt_pk_bf16_f32 v210, v76, v77
    v_cvt_pk_bf16_f32 v211, v78, v79
    v_pk_add_f32 v[80:81], v[80:81], v[172:173]
    v_pk_add_f32 v[82:83], v[82:83], v[174:175]
    v_cvt_pk_bf16_f32 v212, v80, v81
    v_cvt_pk_bf16_f32 v213, v82, v83
    v_pk_add_f32 v[84:85], v[84:85], v[176:177]
    v_pk_add_f32 v[86:87], v[86:87], v[178:179]
    v_cvt_pk_bf16_f32 v214, v84, v85
    v_cvt_pk_bf16_f32 v215, v86, v87
    v_pk_add_f32 v[88:89], v[88:89], v[180:181]
    v_pk_add_f32 v[90:91], v[90:91], v[182:183]
    v_cvt_pk_bf16_f32 v216, v88, v89
    v_cvt_pk_bf16_f32 v217, v90, v91
    v_pk_add_f32 v[92:93], v[92:93], v[184:185]
    v_pk_add_f32 v[94:95], v[94:95], v[186:187]
    v_cvt_pk_bf16_f32 v218, v92, v93
    v_cvt_pk_bf16_f32 v219, v94, v95
    v_pk_add_f32 v[96:97], v[96:97], v[188:189]
    v_pk_add_f32 v[98:99], v[98:99], v[190:191]
    v_cvt_pk_bf16_f32 v220, v96, v97
    v_cvt_pk_bf16_f32 v221, v98, v99
    v_pk_add_f32 v[100:101], v[100:101], v[192:193]
    v_pk_add_f32 v[102:103], v[102:103], v[194:195]
    v_cvt_pk_bf16_f32 v222, v100, v101
    v_cvt_pk_bf16_f32 v223, v102, v103
    s_add_u32 s49, s48, 0
    s_cmp_eq_u32 s41, 0
    s_cselect_b32 s49, 1073741824, s49
    buffer_store_dwordx4 v[200:203], v12, s[24:27], s49 offen sc1
    s_add_u32 s49, s48, 1024
    s_cmp_eq_u32 s41, 1
    s_cselect_b32 s49, 1073741824, s49
    buffer_store_dwordx4 v[204:207], v12, s[24:27], s49 offen sc1
    s_add_u32 s49, s48, 2048
    s_cmp_eq_u32 s41, 2
    s_cselect_b32 s49, 1073741824, s49
    buffer_store_dwordx4 v[208:211], v12, s[24:27], s49 offen sc1
    s_add_u32 s49, s48, 3072
    s_cmp_eq_u32 s41, 3
    s_cselect_b32 s49, 1073741824, s49
    buffer_store_dwordx4 v[212:215], v12, s[24:27], s49 offen sc1
    s_add_u32 s49, s48, 4096
    s_cmp_eq_u32 s41, 0
    s_cselect_b32 s49, 1073741824, s49
    buffer_store_dwordx4 v[216:219], v12, s[24:27], s49 offen sc1
    s_add_u32 s49, s48, 5120
    s_cmp_eq_u32 s41, 1
    s_cselect_b32 s49, 1073741824, s49
    buffer_store_dwordx4 v[220:223], v12, s[24:27], s49 offen sc1
    ds_read_b128 v[148:151], v19 offset:35840
    ds_read_b128 v[152:155], v19 offset:36864
    ds_read_b128 v[156:159], v19 offset:37888
    ds_read_b128 v[160:163], v19 offset:38912
    ds_read_b128 v[164:167], v19 offset:39936
    ds_read_b128 v[168:171], v19 offset:40960
    ds_read_b128 v[172:175], v19 offset:41984
    ds_read_b128 v[176:179], v19 offset:43008
    ds_read_b128 v[180:183], v19 offset:44032
    ds_read_b128 v[184:187], v19 offset:45056
    s_waitcnt lgkmcnt(0)
    v_pk_add_f32 v[104:105], v[104:105], v[148:149]
    v_pk_add_f32 v[106:107], v[106:107], v[150:151]
    v_cvt_pk_bf16_f32 v224, v104, v105
    v_cvt_pk_bf16_f32 v225, v106, v107
    v_pk_add_f32 v[108:109], v[108:109], v[152:153]
    v_pk_add_f32 v[110:111], v[110:111], v[154:155]
    v_cvt_pk_bf16_f32 v226, v108, v109
    v_cvt_pk_bf16_f32 v227, v110, v111
    v_pk_add_f32 v[112:113], v[112:113], v[156:157]
    v_pk_add_f32 v[114:115], v[114:115], v[158:159]
    v_cvt_pk_bf16_f32 v228, v112, v113
    v_cvt_pk_bf16_f32 v229, v114, v115
    v_pk_add_f32 v[116:117], v[116:117], v[160:161]
    v_pk_add_f32 v[118:119], v[118:119], v[162:163]
    v_cvt_pk_bf16_f32 v230, v116, v117
    v_cvt_pk_bf16_f32 v231, v118, v119
    v_pk_add_f32 v[120:121], v[120:121], v[164:165]
    v_pk_add_f32 v[122:123], v[122:123], v[166:167]
    v_cvt_pk_bf16_f32 v232, v120, v121
    v_cvt_pk_bf16_f32 v233, v122, v123
    v_pk_add_f32 v[124:125], v[124:125], v[168:169]
    v_pk_add_f32 v[126:127], v[126:127], v[170:171]
    v_cvt_pk_bf16_f32 v234, v124, v125
    v_cvt_pk_bf16_f32 v235, v126, v127
    v_pk_add_f32 v[128:129], v[128:129], v[172:173]
    v_pk_add_f32 v[130:131], v[130:131], v[174:175]
    v_cvt_pk_bf16_f32 v236, v128, v129
    v_cvt_pk_bf16_f32 v237, v130, v131
    v_pk_add_f32 v[132:133], v[132:133], v[176:177]
    v_pk_add_f32 v[134:135], v[134:135], v[178:179]
    v_cvt_pk_bf16_f32 v238, v132, v133
    v_cvt_pk_bf16_f32 v239, v134, v135
    v_pk_add_f32 v[136:137], v[136:137], v[180:181]
    v_pk_add_f32 v[138:139], v[138:139], v[182:183]
    v_cvt_pk_bf16_f32 v240, v136, v137
    v_cvt_pk_bf16_f32 v241, v138, v139
    v_pk_add_f32 v[140:141], v[140:141], v[184:185]
    v_pk_add_f32 v[142:143], v[142:143], v[186:187]
    v_cvt_pk_bf16_f32 v242, v140, v141
    v_cvt_pk_bf16_f32 v243, v142, v143
    s_add_u32 s49, s48, 6144
    s_cmp_eq_u32 s41, 2
    s_cselect_b32 s49, 1073741824, s49
    buffer_store_dwordx4 v[224:227], v12, s[24:27], s49 offen sc1
    s_add_u32 s49, s48, 7168
    s_cmp_eq_u32 s41, 3
    s_cselect_b32 s49, 1073741824, s49
    buffer_store_dwordx4 v[228:231], v12, s[24:27], s49 offen sc1
    s_add_u32 s49, s48, 8192
    s_cmp_eq_u32 s41, 0
    s_cselect_b32 s49, 1073741824, s49
    buffer_store_dwordx4 v[232:235], v12, s[24:27], s49 offen sc1
    s_add_u32 s49, s48, 9216
    s_cmp_eq_u32 s41, 1
    s_cselect_b32 s49, 1073741824, s49
    buffer_store_dwordx4 v[236:239], v12, s[24:27], s49 offen sc1
    s_add_u32 s49, s48, 10240
    s_cmp_eq_u32 s41, 2
    s_cselect_b32 s49, 1073741824, s49
    buffer_store_dwordx4 v[240:243], v12, s[24:27], s49 offen sc1
    s_add_u32 s49, s48, 11264
    s_cmp_eq_u32 s41, 3
    s_cselect_b32 s49, 1073741824, s49
    buffer_store_dwordx4 v[244:247], v12, s[24:27], s49 offen sc1
P2_RED2:
    s_waitcnt vmcnt(0)
    s_barrier
    s_cmp_lg_u32 s36, 0
    s_cbranch_scc1 P2_SIG_b
    s_add_u32 s48, s52, 32768
    v_mov_b32 v19, 0
    v_mov_b32 v20, s99
    s_mov_b64 s[14:15], exec
    s_mov_b64 exec, 1
    buffer_store_dword v20, v19, s[92:95], s48 offen sc1
    s_mov_b64 exec, s[14:15]
P2_SIG_b:
    s_cmp_lg_u32 s36, 0
    s_cbranch_scc1 P2_POLLED_b
    v_and_b32 v19, 3, v1
    s_add_u32 s49, s41, 1
    s_and_b32 s49, s49, 3
    v_mov_b32 v20, s49
    v_cmp_eq_u32 vcc, s41, v19
    s_nop 1
    v_cndmask_b32 v19, v19, v20, vcc
    s_lshl_b32 s48, s40, 7
    s_add_u32 s48, s48, s53
    s_add_u32 s48, s48, 32768
    v_lshlrev_b32 v19, 9, v19
    s_mov_b32 s51, 0x40000
P2_POLL_b:
    buffer_load_dword v20, v19, s[92:95], s48 offen sc1
    s_waitcnt vmcnt(0)
    v_cmp_ne_u32 vcc, s99, v20
    s_nop 4
    s_cbranch_vccz P2_POLLED_b
    s_sub_u32 s51, s51, 1
    s_cmp_eq_u32 s51, 0
    s_cbranch_scc1 P2_POLLED_b
    s_sleep 1
    s_branch P2_POLL_b
P2_POLLED_b:
    s_barrier
    v_and_b32 v21, 15, v1
    v_mul_u32_u24 v21, 2304, v21
    v_lshrrev_b32 v22, 4, v1
    v_lshl_add_u32 v21, v22, 3, v21
    s_add_u32 s48, s41, 0
    s_mul_i32 s49, s36, 12
    s_add_u32 s48, s48, s49
    s_lshl_b32 s48, s48, 10
    s_add_u32 s49, s41, 1
    s_and_b32 s49, s49, 3
    s_mul_i32 s49, s49, 49152
    s_add_u32 s49, s49, s48
    buffer_load_dwordx4 v[56:59], v12, s[24:27], s49 offen sc1
    s_add_u32 s49, s41, 2
    s_and_b32 s49, s49, 3
    s_mul_i32 s49, s49, 49152
    s_add_u32 s49, s49, s48
    buffer_load_dwordx4 v[60:63], v12, s[24:27], s49 offen sc1
    s_add_u32 s49, s41, 3
    s_and_b32 s49, s49, 3
    s_mul_i32 s49, s49, 49152
    s_add_u32 s49, s49, s48
    buffer_load_dwordx4 v[64:67], v12, s[24:27], s49 offen sc1
    s_add_u32 s48, s41, 4
    s_mul_i32 s49, s36, 12
    s_add_u32 s48, s48, s49
    s_lshl_b32 s48, s48, 10
    s_add_u32 s49, s41, 1
    s_and_b32 s49, s49, 3
    s_mul_i32 s49, s49, 49152
    s_add_u32 s49, s49, s48
    buffer_load_dwordx4 v[72:75], v12, s[24:27], s49 offen sc1
    s_add_u32 s49, s41, 2
    s_and_b32 s49, s49, 3
    s_mul_i32 s49, s49, 49152
    s_add_u32 s49, s49, s48
    buffer_load_dwordx4 v[76:79], v12, s[24:27], s49 offen sc1
    s_add_u32 s49, s41, 3
    s_and_b32 s49, s49, 3
    s_mul_i32 s49, s49, 49152
    s_add_u32 s49, s49, s48
    buffer_load_dwordx4 v[80:83], v12, s[24:27], s49 offen sc1
    s_add_u32 s48, s41, 8
    s_mul_i32 s49, s36, 12
    s_add_u32 s48, s48, s49
    s_lshl_b32 s48, s48, 10
    s_add_u32 s49, s41, 1
    s_and_b32 s49, s49, 3
    s_mul_i32 s49, s49, 49152
    s_add_u32 s49, s49, s48
    buffer_load_dwordx4 v[88:91], v12, s[24:27], s49 offen sc1
    s_add_u32 s49, s41, 2
    s_and_b32 s49, s49, 3
    s_mul_i32 s49, s49, 49152
    s_add_u32 s49, s49, s48
    buffer_load_dwordx4 v[92:95], v12, s[24:27], s49 offen sc1
    s_add_u32 s49, s41, 3
    s_and_b32 s49, s49, 3
    s_mul_i32 s49, s49, 49152
    s_add_u32 s49, s49, s48
    buffer_load_dwordx4 v[96:99], v12, s[24:27], s49 offen sc1
    s_lshl_b32 s49, s41, 2
    s_set_gpr_idx_on s49, 0x1
    v_mov_b32 v68, v200
    v_mov_b32 v69, v201
    v_mov_b32 v70, v202
    v_mov_b32 v71, v203
    v_mov_b32 v84, v216
    v_mov_b32 v85, v217
    v_mov_b32 v86, v218
    v_mov_b32 v87, v219
    v_mov_b32 v100, v232
    v_mov_b32 v101, v233
    v_mov_b32 v102, v234
    v_mov_b32 v103, v235
    s_set_gpr_idx_off
    s_waitcnt vmcnt(6)
    v_lshlrev_b32 v120, 16, v56
    v_and_b32 v121, 0xffff0000, v56
    v_lshlrev_b32 v122, 16, v57
    v_and_b32 v123, 0xffff0000, v57
    v_lshlrev_b32 v124, 16, v60
    v_and_b32 v125, 0xffff0000, v60
    v_add_f32 v120, v120, v124
    v_add_f32 v121, v121, v125
    v_lshlrev_b32 v124, 16, v61
    v_and_b32 v125, 0xffff0000, v61
    v_add_f32 v122, v122, v124
    v_add_f32 v123, v123, v125
    v_lshlrev_b32 v124, 16, v64
    v_and_b32 v125, 0xffff0000, v64
    v_add_f32 v120, v120, v124
    v_add_f32 v121, v121, v125
    v_lshlrev_b32 v124, 16, v65
    v_and_b32 v125, 0xffff0000, v65
    v_add_f32 v122, v122, v124
    v_add_f32 v123, v123, v125
    v_lshlrev_b32 v124, 16, v68
    v_and_b32 v125, 0xffff0000, v68
    v_add_f32 v120, v120, v124
    v_add_f32 v121, v121, v125
    v_lshlrev_b32 v124, 16, v69
    v_and_b32 v125, 0xffff0000, v69
    v_add_f32 v122, v122, v124
    v_add_f32 v123, v123, v125
    v_cvt_pk_bf16_f32 v126, v120, v121
    v_cvt_pk_bf16_f32 v127, v122, v123
    s_add_u32 s48, s41, 0
    s_lshl_b32 s48, s48, 1
    s_add_u32 s48, s48, 0
    s_mul_i32 s49, s43, 23
    s_add_u32 s49, s49, s48
    s_mul_i32 s50, s49, 52
    s_lshr_b32 s50, s50, 8
    s_mul_i32 s51, s50, 5
    s_sub_u32 s51, s49, s51
    s_lshl_b32 s51, s51, 4
    s_mul_i32 s56, s42, 80
    s_add_u32 s51, s51, s56
    s_mul_i32 s51, s51, 2304
    s_lshl_b32 s50, s50, 5
    s_add_u32 s51, s51, s50
    s_sub_u32 s56, 23, s43
    s_cmp_ge_u32 s48, s56
    s_cselect_b32 s51, 1073741824, s51
    buffer_store_dwordx2 v[126:127], v21, s[28:31], s51 offen
    v_lshlrev_b32 v128, 16, v58
    v_and_b32 v129, 0xffff0000, v58
    v_lshlrev_b32 v130, 16, v59
    v_and_b32 v131, 0xffff0000, v59
    v_lshlrev_b32 v132, 16, v62
    v_and_b32 v133, 0xffff0000, v62
    v_add_f32 v128, v128, v132
    v_add_f32 v129, v129, v133
    v_lshlrev_b32 v132, 16, v63
    v_and_b32 v133, 0xffff0000, v63
    v_add_f32 v130, v130, v132
    v_add_f32 v131, v131, v133
    v_lshlrev_b32 v132, 16, v66
    v_and_b32 v133, 0xffff0000, v66
    v_add_f32 v128, v128, v132
    v_add_f32 v129, v129, v133
    v_lshlrev_b32 v132, 16, v67
    v_and_b32 v133, 0xffff0000, v67
    v_add_f32 v130, v130, v132
    v_add_f32 v131, v131, v133
    v_lshlrev_b32 v132, 16, v70
    v_and_b32 v133, 0xffff0000, v70
    v_add_f32 v128, v128, v132
    v_add_f32 v129, v129, v133
    v_lshlrev_b32 v132, 16, v71
    v_and_b32 v133, 0xffff0000, v71
    v_add_f32 v130, v130, v132
    v_add_f32 v131, v131, v133
    v_cvt_pk_bf16_f32 v134, v128, v129
    v_cvt_pk_bf16_f32 v135, v130, v131
    s_add_u32 s48, s41, 0
    s_lshl_b32 s48, s48, 1
    s_add_u32 s48, s48, 1
    s_mul_i32 s49, s43, 23
    s_add_u32 s49, s49, s48
    s_mul_i32 s50, s49, 52
    s_lshr_b32 s50, s50, 8
    s_mul_i32 s51, s50, 5
    s_sub_u32 s51, s49, s51
    s_lshl_b32 s51, s51, 4
    s_mul_i32 s56, s42, 80
    s_add_u32 s51, s51, s56
    s_mul_i32 s51, s51, 2304
    s_lshl_b32 s50, s50, 5
    s_add_u32 s51, s51, s50
    s_sub_u32 s56, 23, s43
    s_cmp_ge_u32 s48, s56
    s_cselect_b32 s51, 1073741824, s51
    buffer_store_dwordx2 v[134:135], v21, s[28:31], s51 offen
    s_waitcnt vmcnt(5)
    v_lshlrev_b32 v120, 16, v72
    v_and_b32 v121, 0xffff0000, v72
    v_lshlrev_b32 v122, 16, v73
    v_and_b32 v123, 0xffff0000, v73
    v_lshlrev_b32 v124, 16, v76
    v_and_b32 v125, 0xffff0000, v76
    v_add_f32 v120, v120, v124
    v_add_f32 v121, v121, v125
    v_lshlrev_b32 v124, 16, v77
    v_and_b32 v125, 0xffff0000, v77
    v_add_f32 v122, v122, v124
    v_add_f32 v123, v123, v125
    v_lshlrev_b32 v124, 16, v80
    v_and_b32 v125, 0xffff0000, v80
    v_add_f32 v120, v120, v124
    v_add_f32 v121, v121, v125
    v_lshlrev_b32 v124, 16, v81
    v_and_b32 v125, 0xffff0000, v81
    v_add_f32 v122, v122, v124
    v_add_f32 v123, v123, v125
    v_lshlrev_b32 v124, 16, v84
    v_and_b32 v125, 0xffff0000, v84
    v_add_f32 v120, v120, v124
    v_add_f32 v121, v121, v125
    v_lshlrev_b32 v124, 16, v85
    v_and_b32 v125, 0xffff0000, v85
    v_add_f32 v122, v122, v124
    v_add_f32 v123, v123, v125
    v_cvt_pk_bf16_f32 v126, v120, v121
    v_cvt_pk_bf16_f32 v127, v122, v123
    s_add_u32 s48, s41, 4
    s_lshl_b32 s48, s48, 1
    s_add_u32 s48, s48, 0
    s_mul_i32 s49, s43, 23
    s_add_u32 s49, s49, s48
    s_mul_i32 s50, s49, 52
    s_lshr_b32 s50, s50, 8
    s_mul_i32 s51, s50, 5
    s_sub_u32 s51, s49, s51
    s_lshl_b32 s51, s51, 4
    s_mul_i32 s56, s42, 80
    s_add_u32 s51, s51, s56
    s_mul_i32 s51, s51, 2304
    s_lshl_b32 s50, s50, 5
    s_add_u32 s51, s51, s50
    s_sub_u32 s56, 23, s43
    s_cmp_ge_u32 s48, s56
    s_cselect_b32 s51, 1073741824, s51
    buffer_store_dwordx2 v[126:127], v21, s[28:31], s51 offen
    v_lshlrev_b32 v128, 16, v74
    v_and_b32 v129, 0xffff0000, v74
    v_lshlrev_b32 v130, 16, v75
    v_and_b32 v131, 0xffff0000, v75
    v_lshlrev_b32 v132, 16, v78
    v_and_b32 v133, 0xffff0000, v78
    v_add_f32 v128, v128, v132
    v_add_f32 v129, v129, v133
    v_lshlrev_b32 v132, 16, v79
    v_and_b32 v133, 0xffff0000, v79
    v_add_f32 v130, v130, v132
    v_add_f32 v131, v131, v133
    v_lshlrev_b32 v132, 16, v82
    v_and_b32 v133, 0xffff0000, v82
    v_add_f32 v128, v128, v132
    v_add_f32 v129, v129, v133
    v_lshlrev_b32 v132, 16, v83
    v_and_b32 v133, 0xffff0000, v83
    v_add_f32 v130, v130, v132
    v_add_f32 v131, v131, v133
    v_lshlrev_b32 v132, 16, v86
    v_and_b32 v133, 0xffff0000, v86
    v_add_f32 v128, v128, v132
    v_add_f32 v129, v129, v133
    v_lshlrev_b32 v132, 16, v87
    v_and_b32 v133, 0xffff0000, v87
    v_add_f32 v130, v130, v132
    v_add_f32 v131, v131, v133
    v_cvt_pk_bf16_f32 v134, v128, v129
    v_cvt_pk_bf16_f32 v135, v130, v131
    s_add_u32 s48, s41, 4
    s_lshl_b32 s48, s48, 1
    s_add_u32 s48, s48, 1
    s_mul_i32 s49, s43, 23
    s_add_u32 s49, s49, s48
    s_mul_i32 s50, s49, 52
    s_lshr_b32 s50, s50, 8
    s_mul_i32 s51, s50, 5
    s_sub_u32 s51, s49, s51
    s_lshl_b32 s51, s51, 4
    s_mul_i32 s56, s42, 80
    s_add_u32 s51, s51, s56
    s_mul_i32 s51, s51, 2304
    s_lshl_b32 s50, s50, 5
    s_add_u32 s51, s51, s50
    s_sub_u32 s56, 23, s43
    s_cmp_ge_u32 s48, s56
    s_cselect_b32 s51, 1073741824, s51
    buffer_store_dwordx2 v[134:135], v21, s[28:31], s51 offen
    s_waitcnt vmcnt(4)
    v_lshlrev_b32 v120, 16, v88
    v_and_b32 v121, 0xffff0000, v88
    v_lshlrev_b32 v122, 16, v89
    v_and_b32 v123, 0xffff0000, v89
    v_lshlrev_b32 v124, 16, v92
    v_and_b32 v125, 0xffff0000, v92
    v_add_f32 v120, v120, v124
    v_add_f32 v121, v121, v125
    v_lshlrev_b32 v124, 16, v93
    v_and_b32 v125, 0xffff0000, v93
    v_add_f32 v122, v122, v124
    v_add_f32 v123, v123, v125
    v_lshlrev_b32 v124, 16, v96
    v_and_b32 v125, 0xffff0000, v96
    v_add_f32 v120, v120, v124
    v_add_f32 v121, v121, v125
    v_lshlrev_b32 v124, 16, v97
    v_and_b32 v125, 0xffff0000, v97
    v_add_f32 v122, v122, v124
    v_add_f32 v123, v123, v125
    v_lshlrev_b32 v124, 16, v100
    v_and_b32 v125, 0xffff0000, v100
    v_add_f32 v120, v120, v124
    v_add_f32 v121, v121, v125
    v_lshlrev_b32 v124, 16, v101
    v_and_b32 v125, 0xffff0000, v101
    v_add_f32 v122, v122, v124
    v_add_f32 v123, v123, v125
    v_cvt_pk_bf16_f32 v126, v120, v121
    v_cvt_pk_bf16_f32 v127, v122, v123
    s_add_u32 s48, s41, 8
    s_lshl_b32 s48, s48, 1
    s_add_u32 s48, s48, 0
    s_mul_i32 s49, s43, 23
    s_add_u32 s49, s49, s48
    s_mul_i32 s50, s49, 52
    s_lshr_b32 s50, s50, 8
    s_mul_i32 s51, s50, 5
    s_sub_u32 s51, s49, s51
    s_lshl_b32 s51, s51, 4
    s_mul_i32 s56, s42, 80
    s_add_u32 s51, s51, s56
    s_mul_i32 s51, s51, 2304
    s_lshl_b32 s50, s50, 5
    s_add_u32 s51, s51, s50
    s_sub_u32 s56, 23, s43
    s_cmp_ge_u32 s48, s56
    s_cselect_b32 s51, 1073741824, s51
    buffer_store_dwordx2 v[126:127], v21, s[28:31], s51 offen
    v_lshlrev_b32 v128, 16, v90
    v_and_b32 v129, 0xffff0000, v90
    v_lshlrev_b32 v130, 16, v91
    v_and_b32 v131, 0xffff0000, v91
    v_lshlrev_b32 v132, 16, v94
    v_and_b32 v133, 0xffff0000, v94
    v_add_f32 v128, v128, v132
    v_add_f32 v129, v129, v133
    v_lshlrev_b32 v132, 16, v95
    v_and_b32 v133, 0xffff0000, v95
    v_add_f32 v130, v130, v132
    v_add_f32 v131, v131, v133
    v_lshlrev_b32 v132, 16, v98
    v_and_b32 v133, 0xffff0000, v98
    v_add_f32 v128, v128, v132
    v_add_f32 v129, v129, v133
    v_lshlrev_b32 v132, 16, v99
    v_and_b32 v133, 0xffff0000, v99
    v_add_f32 v130, v130, v132
    v_add_f32 v131, v131, v133
    v_lshlrev_b32 v132, 16, v102
    v_and_b32 v133, 0xffff0000, v102
    v_add_f32 v128, v128, v132
    v_add_f32 v129, v129, v133
    v_lshlrev_b32 v132, 16, v103
    v_and_b32 v133, 0xffff0000, v103
    v_add_f32 v130, v130, v132
    v_add_f32 v131, v131, v133
    v_cvt_pk_bf16_f32 v134, v128, v129
    v_cvt_pk_bf16_f32 v135, v130, v131
    s_add_u32 s48, s41, 8
    s_lshl_b32 s48, s48, 1
    s_add_u32 s48, s48, 1
    s_mul_i32 s49, s43, 23
    s_add_u32 s49, s49, s48
    s_mul_i32 s50, s49, 52
    s_lshr_b32 s50, s50, 8
    s_mul_i32 s51, s50, 5
    s_sub_u32 s51, s49, s51
    s_lshl_b32 s51, s51, 4
    s_mul_i32 s56, s42, 80
    s_add_u32 s51, s51, s56
    s_mul_i32 s51, s51, 2304
    s_lshl_b32 s50, s50, 5
    s_add_u32 s51, s51, s50
    s_sub_u32 s56, 23, s43
    s_cmp_ge_u32 s48, s56
    s_cselect_b32 s51, 1073741824, s51
    buffer_store_dwordx2 v[134:135], v21, s[28:31], s51 offen
    s_endpgm
K1_SLOW:
    v_mov_b32 v96, 0
    v_mov_b32 v97, 0
    v_mov_b32 v98, 0
    v_mov_b32 v99, 0
    v_mov_b32 v196, 0
    v_mov_b32 v176, 0xff7fffff
    v_mov_b32 v197, 0
    v_mov_b32 v177, 0xff7fffff
    v_mov_b32 v198, 0
    v_mov_b32 v178, 0xff7fffff
    v_mov_b32 v199, 0
    v_mov_b32 v179, 0xff7fffff
    v_mov_b32 v200, 0
    v_mov_b32 v180, 0xff7fffff
    v_mfma_f32_32x32x16_bf16 a[0:15], v[96:99], v[96:99], 0
    v_mfma_f32_32x32x16_bf16 a[16:31], v[96:99], v[96:99], 0
    v_mfma_f32_32x32x16_bf16 a[32:47], v[96:99], v[96:99], 0
    v_mfma_f32_32x32x16_bf16 a[48:63], v[96:99], v[96:99], 0
    v_mfma_f32_32x32x16_bf16 a[64:79], v[96:99], v[96:99], 0
    v_mfma_f32_32x32x16_bf16 a[80:95], v[96:99], v[96:99], 0
    v_mfma_f32_32x32x16_bf16 a[96:111], v[96:99], v[96:99], 0
    v_mfma_f32_32x32x16_bf16 a[112:127], v[96:99], v[96:99], 0
    v_mfma_f32_32x32x16_bf16 a[128:143], v[96:99], v[96:99], 0
    v_mfma_f32_32x32x16_bf16 a[144:159], v[96:99], v[96:99], 0
    s_mov_b32 s44, 0
K1_SLOOP:
    s_and_b32 s45, s44, 1
    s_cmp_lg_u32 s45, 0
    s_cbranch_scc1 K1_SNODMA
    s_barrier
    s_lshr_b32 s46, s44, 1
    s_lshl_b32 s46, s46, 14
    s_add_u32 m0, s47, 0
    s_nop 0
    buffer_load_dwordx4 v6, s[24:27], s46 offen offset:0 nt lds
    buffer_load_dwordx4 v7, s[24:27], s46 offen offset:1056 nt lds
    buffer_load_dwordx4 v8, s[24:27], s46 offen offset:2112 nt lds
    buffer_load_dwordx4 v9, s[24:27], s46 offen offset:3168 nt lds
    s_add_u32 m0, s47, 67584
    s_nop 0
    buffer_load_dwordx4 v10, s[28:31], s46 offen offset:0 nt lds
    buffer_load_dwordx4 v11, s[28:31], s46 offen offset:1056 nt lds
    buffer_load_dwordx4 v12, s[28:31], s46 offen offset:2112 nt lds
    buffer_load_dwordx4 v13, s[28:31], s46 offen offset:3168 nt lds
    s_waitcnt vmcnt(0)
    s_barrier
K1_SNODMA:
    s_lshl_b32 s46, s45, 9
    s_mul_i32 s48, s45, 8448
    v_add_u32 v184, s46, v14
    v_add_u32 v185, s48, v217
    ds_read_b128 a[160:163], v184 offset:0
    ds_read_b128 a[164:167], v184 offset:64
    ds_read_b128 a[168:171], v184 offset:128
    ds_read_b128 a[172:175], v184 offset:192
    ds_read_b128 a[176:179], v184 offset:256
    ds_read_b128 a[180:183], v184 offset:320
    ds_read_b128 a[184:187], v184 offset:384
    ds_read_b128 a[188:191], v184 offset:448
    s_waitcnt lgkmcnt(0)
    ds_read_b64_tr_b16 a[192:193], v185 offset:0
    ds_read_b64_tr_b16 a[194:195], v185 offset:512
    ds_read_b64_tr_b16 a[196:197], v185 offset:32
    ds_read_b64_tr_b16 a[198:199], v185 offset:544
    ds_read_b64_tr_b16 a[200:201], v185 offset:64
    ds_read_b64_tr_b16 a[202:203], v185 offset:576
    ds_read_b64_tr_b16 a[204:205], v185 offset:96
    ds_read_b64_tr_b16 a[206:207], v185 offset:608
    ds_read_b64_tr_b16 a[208:209], v185 offset:128
    ds_read_b64_tr_b16 a[210:211], v185 offset:640
    ds_read_b64_tr_b16 a[212:213], v185 offset:160
    ds_read_b64_tr_b16 a[214:215], v185 offset:672
    ds_read_b64_tr_b16 a[216:217], v185 offset:192
    ds_read_b64_tr_b16 a[218:219], v185 offset:704
    ds_read_b64_tr_b16 a[220:221], v185 offset:224
    ds_read_b64_tr_b16 a[222:223], v185 offset:736
    v_mfma_f32_16x16x32_bf16 v[96:99], a[160:163], v[16:19], 0
    v_mfma_f32_16x16x32_bf16 v[104:107], a[160:163], v[32:35], 0
    v_mfma_f32_16x16x32_bf16 v[112:115], a[160:163], v[48:51], 0
    v_mfma_f32_16x16x32_bf16 v[120:123], a[160:163], v[64:67], 0
    v_mfma_f32_16x16x32_bf16 v[128:131], a[160:163], v[80:83], 0
    v_mfma_f32_16x16x32_bf16 v[96:99], a[164:167], v[20:23], v[96:99]
    v_mfma_f32_16x16x32_bf16 v[104:107], a[164:167], v[36:39], v[104:107]
    v_mfma_f32_16x16x32_bf16 v[112:115], a[164:167], v[52:55], v[112:115]
    v_mfma_f32_16x16x32_bf16 v[120:123], a[164:167], v[68:71], v[120:123]
    v_mfma_f32_16x16x32_bf16 v[128:131], a[164:167], v[84:87], v[128:131]
    v_mfma_f32_16x16x32_bf16 v[96:99], a[168:171], v[24:27], v[96:99]
    v_mfma_f32_16x16x32_bf16 v[104:107], a[168:171], v[40:43], v[104:107]
    v_mfma_f32_16x16x32_bf16 v[112:115], a[168:171], v[56:59], v[112:115]
    v_mfma_f32_16x16x32_bf16 v[120:123], a[168:171], v[72:75], v[120:123]
    v_mfma_f32_16x16x32_bf16 v[128:131], a[168:171], v[88:91], v[128:131]
    v_mfma_f32_16x16x32_bf16 v[96:99], a[172:175], v[28:31], v[96:99]
    v_mfma_f32_16x16x32_bf16 v[104:107], a[172:175], v[44:47], v[104:107]
    v_mfma_f32_16x16x32_bf16 v[112:115], a[172:175], v[60:63], v[112:115]
    v_mfma_f32_16x16x32_bf16 v[120:123], a[172:175], v[76:79], v[120:123]
    v_mfma_f32_16x16x32_bf16 v[128:131], a[172:175], v[92:95], v[128:131]
    v_mfma_f32_16x16x32_bf16 v[100:103], a[176:179], v[16:19], 0
    v_mfma_f32_16x16x32_bf16 v[108:111], a[176:179], v[32:35], 0
    v_mfma_f32_16x16x32_bf16 v[116:119], a[176:179], v[48:51], 0
    v_mfma_f32_16x16x32_bf16 v[124:127], a[176:179], v[64:67], 0
    v_mfma_f32_16x16x32_bf16 v[132:135], a[176:179], v[80:83], 0
    v_mfma_f32_16x16x32_bf16 v[100:103], a[180:183], v[20:23], v[100:103]
    v_mfma_f32_16x16x32_bf16 v[108:111], a[180:183], v[36:39], v[108:111]
    v_mfma_f32_16x16x32_bf16 v[116:119], a[180:183], v[52:55], v[116:119]
    v_mfma_f32_16x16x32_bf16 v[124:127], a[180:183], v[68:71], v[124:127]
    v_mfma_f32_16x16x32_bf16 v[132:135], a[180:183], v[84:87], v[132:135]
    v_mfma_f32_16x16x32_bf16 v[100:103], a[184:187], v[24:27], v[100:103]
    v_mfma_f32_16x16x32_bf16 v[108:111], a[184:187], v[40:43], v[108:111]
    v_mfma_f32_16x16x32_bf16 v[116:119], a[184:187], v[56:59], v[116:119]
    v_mfma_f32_16x16x32_bf16 v[124:127], a[184:187], v[72:75], v[124:127]
    v_mfma_f32_16x16x32_bf16 v[132:135], a[184:187], v[88:91], v[132:135]
    v_mfma_f32_16x16x32_bf16 v[100:103], a[188:191], v[28:31], v[100:103]
    v_mfma_f32_16x16x32_bf16 v[108:111], a[188:191], v[44:47], v[108:111]
    v_mfma_f32_16x16x32_bf16 v[116:119], a[188:191], v[60:63], v[116:119]
    v_mfma_f32_16x16x32_bf16 v[124:127], a[188:191], v[76:79], v[124:127]
    v_mfma_f32_16x16x32_bf16 v[132:135], a[188:191], v[92:95], v[132:135]
    s_nop 7
    s_nop 3
    v_max3_f32 v201, v96, v97, v98
    v_max3_f32 v201, v201, v99, v100
    v_max3_f32 v201, v201, v101, v102
    v_max_f32 v201, v201, v103
    v_max3_f32 v202, v104, v105, v106
    v_max3_f32 v202, v202, v107, v108
    v_max3_f32 v202, v202, v109, v110
    v_max_f32 v202, v202, v111
    v_max3_f32 v203, v112, v113, v114
    v_max3_f32 v203, v203, v115, v116
    v_max3_f32 v203, v203, v117, v118
    v_max_f32 v203, v203, v119
    v_max3_f32 v204, v120, v121, v122
    v_max3_f32 v204, v204, v123, v124
    v_max3_f32 v204, v204, v125, v126
    v_max_f32 v204, v204, v127
    v_max3_f32 v205, v128, v129, v130
    v_max3_f32 v205, v205, v131, v132
    v_max3_f32 v205, v205, v133, v134
    v_max_f32 v205, v205, v135
    v_mov_b32 v206, v201
    v_mov_b32 v207, v202
    v_mov_b32 v208, v203
    v_mov_b32 v209, v204
    v_mov_b32 v210, v205
    s_nop 1
    v_permlane32_swap_b32 v201, v206
    v_permlane32_swap_b32 v202, v207
    v_permlane32_swap_b32 v203, v208
    v_permlane32_swap_b32 v204, v209
    v_permlane32_swap_b32 v205, v210
    s_nop 1
    v_max_f32 v201, v201, v206
    v_max_f32 v202, v202, v207
    v_max_f32 v203, v203, v208
    v_max_f32 v204, v204, v209
    v_max_f32 v205, v205, v210
    v_mov_b32 v206, v201
    v_mov_b32 v207, v202
    v_mov_b32 v208, v203
    v_mov_b32 v209, v204
    v_mov_b32 v210, v205
    s_nop 1
    v_permlane16_swap_b32 v201, v206
    v_permlane16_swap_b32 v202, v207
    v_permlane16_swap_b32 v203, v208
    v_permlane16_swap_b32 v204, v209
    v_permlane16_swap_b32 v205, v210
    s_nop 1
    v_max_f32 v201, v201, v206
    v_max_f32 v202, v202, v207
    v_max_f32 v203, v203, v208
    v_max_f32 v204, v204, v209
    v_max_f32 v205, v205, v210
    v_max_f32 v201, v201, v176
    v_sub_f32 v206, v176, v201
    v_mov_b32 v176, v201
    v_max_f32 v202, v202, v177
    v_sub_f32 v207, v177, v202
    v_mov_b32 v177, v202
    v_max_f32 v203, v203, v178
    v_sub_f32 v208, v178, v203
    v_mov_b32 v178, v203
    v_max_f32 v204, v204, v179
    v_sub_f32 v209, v179, v204
    v_mov_b32 v179, v204
    v_max_f32 v205, v205, v180
    v_sub_f32 v210, v180, v205
    v_mov_b32 v180, v205
    v_exp_f32 v206, v206
    v_exp_f32 v207, v207
    v_exp_f32 v208, v208
    v_exp_f32 v209, v209
    v_exp_f32 v210, v210
    s_nop 0
    v_mul_f32 v196, v196, v206
    v_mul_f32 v197, v197, v207
    v_mul_f32 v198, v198, v208
    v_mul_f32 v199, v199, v209
    v_mul_f32 v200, v200, v210
    v_accvgpr_read_b32 v136, a0
    v_accvgpr_read_b32 v137, a1
    v_accvgpr_read_b32 v138, a2
    v_accvgpr_read_b32 v139, a3
    v_mul_f32 v136, v136, v206
    v_mul_f32 v137, v137, v206
    v_mul_f32 v138, v138, v206
    v_mul_f32 v139, v139, v206
    v_accvgpr_write_b32 a0, v136
    v_accvgpr_write_b32 a1, v137
    v_accvgpr_write_b32 a2, v138
    v_accvgpr_write_b32 a3, v139
    v_accvgpr_read_b32 v136, a4
    v_accvgpr_read_b32 v137, a5
    v_accvgpr_read_b32 v138, a6
    v_accvgpr_read_b32 v139, a7
    v_mul_f32 v136, v136, v207
    v_mul_f32 v137, v137, v207
    v_mul_f32 v138, v138, v207
    v_mul_f32 v139, v139, v207
    v_accvgpr_write_b32 a4, v136
    v_accvgpr_write_b32 a5, v137
    v_accvgpr_write_b32 a6, v138
    v_accvgpr_write_b32 a7, v139
    v_accvgpr_read_b32 v136, a8
    v_accvgpr_read_b32 v137, a9
    v_accvgpr_read_b32 v138, a10
    v_accvgpr_read_b32 v139, a11
    v_mul_f32 v136, v136, v208
    v_mul_f32 v137, v137, v208
    v_mul_f32 v138, v138, v208
    v_mul_f32 v139, v139, v208
    v_accvgpr_write_b32 a8, v136
    v_accvgpr_write_b32 a9, v137
    v_accvgpr_write_b32 a10, v138
    v_accvgpr_write_b32 a11, v139
    v_accvgpr_read_b32 v136, a12
    v_accvgpr_read_b32 v137, a13
    v_accvgpr_read_b32 v138, a14
    v_accvgpr_read_b32 v139, a15
    v_mul_f32 v136, v136, v209
    v_mul_f32 v137, v137, v209
    v_mul_f32 v138, v138, v209
    v_mul_f32 v139, v139, v209
    v_accvgpr_write_b32 a12, v136
    v_accvgpr_write_b32 a13, v137
    v_accvgpr_write_b32 a14, v138
    v_accvgpr_write_b32 a15, v139
    v_accvgpr_read_b32 v136, a16
    v_accvgpr_read_b32 v137, a17
    v_accvgpr_read_b32 v138, a18
    v_accvgpr_read_b32 v139, a19
    v_mul_f32 v136, v136, v210
    v_mul_f32 v137, v137, v210
    v_mul_f32 v138, v138, v210
    v_mul_f32 v139, v139, v210
    v_accvgpr_write_b32 a16, v136
    v_accvgpr_write_b32 a17, v137
    v_accvgpr_write_b32 a18, v138
    v_accvgpr_write_b32 a19, v139
    v_accvgpr_read_b32 v136, a20
    v_accvgpr_read_b32 v137, a21
    v_accvgpr_read_b32 v138, a22
    v_accvgpr_read_b32 v139, a23
    v_mul_f32 v136, v136, v206
    v_mul_f32 v137, v137, v206
    v_mul_f32 v138, v138, v206
    v_mul_f32 v139, v139, v206
    v_accvgpr_write_b32 a20, v136
    v_accvgpr_write_b32 a21, v137
    v_accvgpr_write_b32 a22, v138
    v_accvgpr_write_b32 a23, v139
    v_accvgpr_read_b32 v136, a24
    v_accvgpr_read_b32 v137, a25
    v_accvgpr_read_b32 v138, a26
    v_accvgpr_read_b32 v139, a27
    v_mul_f32 v136, v136, v207
    v_mul_f32 v137, v137, v207
    v_mul_f32 v138, v138, v207
    v_mul_f32 v139, v139, v207
    v_accvgpr_write_b32 a24, v136
    v_accvgpr_write_b32 a25, v137
    v_accvgpr_write_b32 a26, v138
    v_accvgpr_write_b32 a27, v139
    v_accvgpr_read_b32 v136, a28
    v_accvgpr_read_b32 v137, a29
    v_accvgpr_read_b32 v138, a30
    v_accvgpr_read_b32 v139, a31
    v_mul_f32 v136, v136, v208
    v_mul_f32 v137, v137, v208
    v_mul_f32 v138, v138, v208
    v_mul_f32 v139, v139, v208
    v_accvgpr_write_b32 a28, v136
    v_accvgpr_write_b32 a29, v137
    v_accvgpr_write_b32 a30, v138
    v_accvgpr_write_b32 a31, v139
    v_accvgpr_read_b32 v136, a32
    v_accvgpr_read_b32 v137, a33
    v_accvgpr_read_b32 v138, a34
    v_accvgpr_read_b32 v139, a35
    v_mul_f32 v136, v136, v209
    v_mul_f32 v137, v137, v209
    v_mul_f32 v138, v138, v209
    v_mul_f32 v139, v139, v209
    v_accvgpr_write_b32 a32, v136
    v_accvgpr_write_b32 a33, v137
    v_accvgpr_write_b32 a34, v138
    v_accvgpr_write_b32 a35, v139
    v_accvgpr_read_b32 v136, a36
    v_accvgpr_read_b32 v137, a37
    v_accvgpr_read_b32 v138, a38
    v_accvgpr_read_b32 v139, a39
    v_mul_f32 v136, v136, v210
    v_mul_f32 v137, v137, v210
    v_mul_f32 v138, v138, v210
    v_mul_f32 v139, v139, v210
    v_accvgpr_write_b32 a36, v136
    v_accvgpr_write_b32 a37, v137
    v_accvgpr_write_b32 a38, v138
    v_accvgpr_write_b32 a39, v139
    v_accvgpr_read_b32 v136, a40
    v_accvgpr_read_b32 v137, a41
    v_accvgpr_read_b32 v138, a42
    v_accvgpr_read_b32 v139, a43
    v_mul_f32 v136, v136, v206
    v_mul_f32 v137, v137, v206
    v_mul_f32 v138, v138, v206
    v_mul_f32 v139, v139, v206
    v_accvgpr_write_b32 a40, v136
    v_accvgpr_write_b32 a41, v137
    v_accvgpr_write_b32 a42, v138
    v_accvgpr_write_b32 a43, v139
    v_accvgpr_read_b32 v136, a44
    v_accvgpr_read_b32 v137, a45
    v_accvgpr_read_b32 v138, a46
    v_accvgpr_read_b32 v139, a47
    v_mul_f32 v136, v136, v207
    v_mul_f32 v137, v137, v207
    v_mul_f32 v138, v138, v207
    v_mul_f32 v139, v139, v207
    v_accvgpr_write_b32 a44, v136
    v_accvgpr_write_b32 a45, v137
    v_accvgpr_write_b32 a46, v138
    v_accvgpr_write_b32 a47, v139
    v_accvgpr_read_b32 v136, a48
    v_accvgpr_read_b32 v137, a49
    v_accvgpr_read_b32 v138, a50
    v_accvgpr_read_b32 v139, a51
    v_mul_f32 v136, v136, v208
    v_mul_f32 v137, v137, v208
    v_mul_f32 v138, v138, v208
    v_mul_f32 v139, v139, v208
    v_accvgpr_write_b32 a48, v136
    v_accvgpr_write_b32 a49, v137
    v_accvgpr_write_b32 a50, v138
    v_accvgpr_write_b32 a51, v139
    v_accvgpr_read_b32 v136, a52
    v_accvgpr_read_b32 v137, a53
    v_accvgpr_read_b32 v138, a54
    v_accvgpr_read_b32 v139, a55
    v_mul_f32 v136, v136, v209
    v_mul_f32 v137, v137, v209
    v_mul_f32 v138, v138, v209
    v_mul_f32 v139, v139, v209
    v_accvgpr_write_b32 a52, v136
    v_accvgpr_write_b32 a53, v137
    v_accvgpr_write_b32 a54, v138
    v_accvgpr_write_b32 a55, v139
    v_accvgpr_read_b32 v136, a56
    v_accvgpr_read_b32 v137, a57
    v_accvgpr_read_b32 v138, a58
    v_accvgpr_read_b32 v139, a59
    v_mul_f32 v136, v136, v210
    v_mul_f32 v137, v137, v210
    v_mul_f32 v138, v138, v210
    v_mul_f32 v139, v139, v210
    v_accvgpr_write_b32 a56, v136
    v_accvgpr_write_b32 a57, v137
    v_accvgpr_write_b32 a58, v138
    v_accvgpr_write_b32 a59, v139
    v_accvgpr_read_b32 v136, a60
    v_accvgpr_read_b32 v137, a61
    v_accvgpr_read_b32 v138, a62
    v_accvgpr_read_b32 v139, a63
    v_mul_f32 v136, v136, v206
    v_mul_f32 v137, v137, v206
    v_mul_f32 v138, v138, v206
    v_mul_f32 v139, v139, v206
    v_accvgpr_write_b32 a60, v136
    v_accvgpr_write_b32 a61, v137
    v_accvgpr_write_b32 a62, v138
    v_accvgpr_write_b32 a63, v139
    v_accvgpr_read_b32 v136, a64
    v_accvgpr_read_b32 v137, a65
    v_accvgpr_read_b32 v138, a66
    v_accvgpr_read_b32 v139, a67
    v_mul_f32 v136, v136, v207
    v_mul_f32 v137, v137, v207
    v_mul_f32 v138, v138, v207
    v_mul_f32 v139, v139, v207
    v_accvgpr_write_b32 a64, v136
    v_accvgpr_write_b32 a65, v137
    v_accvgpr_write_b32 a66, v138
    v_accvgpr_write_b32 a67, v139
    v_accvgpr_read_b32 v136, a68
    v_accvgpr_read_b32 v137, a69
    v_accvgpr_read_b32 v138, a70
    v_accvgpr_read_b32 v139, a71
    v_mul_f32 v136, v136, v208
    v_mul_f32 v137, v137, v208
    v_mul_f32 v138, v138, v208
    v_mul_f32 v139, v139, v208
    v_accvgpr_write_b32 a68, v136
    v_accvgpr_write_b32 a69, v137
    v_accvgpr_write_b32 a70, v138
    v_accvgpr_write_b32 a71, v139
    v_accvgpr_read_b32 v136, a72
    v_accvgpr_read_b32 v137, a73
    v_accvgpr_read_b32 v138, a74
    v_accvgpr_read_b32 v139, a75
    v_mul_f32 v136, v136, v209
    v_mul_f32 v137, v137, v209
    v_mul_f32 v138, v138, v209
    v_mul_f32 v139, v139, v209
    v_accvgpr_write_b32 a72, v136
    v_accvgpr_write_b32 a73, v137
    v_accvgpr_write_b32 a74, v138
    v_accvgpr_write_b32 a75, v139
    v_accvgpr_read_b32 v136, a76
    v_accvgpr_read_b32 v137, a77
    v_accvgpr_read_b32 v138, a78
    v_accvgpr_read_b32 v139, a79
    v_mul_f32 v136, v136, v210
    v_mul_f32 v137, v137, v210
    v_mul_f32 v138, v138, v210
    v_mul_f32 v139, v139, v210
    v_accvgpr_write_b32 a76, v136
    v_accvgpr_write_b32 a77, v137
    v_accvgpr_write_b32 a78, v138
    v_accvgpr_write_b32 a79, v139
    v_accvgpr_read_b32 v136, a80
    v_accvgpr_read_b32 v137, a81
    v_accvgpr_read_b32 v138, a82
    v_accvgpr_read_b32 v139, a83
    v_mul_f32 v136, v136, v206
    v_mul_f32 v137, v137, v206
    v_mul_f32 v138, v138, v206
    v_mul_f32 v139, v139, v206
    v_accvgpr_write_b32 a80, v136
    v_accvgpr_write_b32 a81, v137
    v_accvgpr_write_b32 a82, v138
    v_accvgpr_write_b32 a83, v139
    v_accvgpr_read_b32 v136, a84
    v_accvgpr_read_b32 v137, a85
    v_accvgpr_read_b32 v138, a86
    v_accvgpr_read_b32 v139, a87
    v_mul_f32 v136, v136, v207
    v_mul_f32 v137, v137, v207
    v_mul_f32 v138, v138, v207
    v_mul_f32 v139, v139, v207
    v_accvgpr_write_b32 a84, v136
    v_accvgpr_write_b32 a85, v137
    v_accvgpr_write_b32 a86, v138
    v_accvgpr_write_b32 a87, v139
    v_accvgpr_read_b32 v136, a88
    v_accvgpr_read_b32 v137, a89
    v_accvgpr_read_b32 v138, a90
    v_accvgpr_read_b32 v139, a91
    v_mul_f32 v136, v136, v208
    v_mul_f32 v137, v137, v208
    v_mul_f32 v138, v138, v208
    v_mul_f32 v139, v139, v208
    v_accvgpr_write_b32 a88, v136
    v_accvgpr_write_b32 a89, v137
    v_accvgpr_write_b32 a90, v138
    v_accvgpr_write_b32 a91, v139
    v_accvgpr_read_b32 v136, a92
    v_accvgpr_read_b32 v137, a93
    v_accvgpr_read_b32 v138, a94
    v_accvgpr_read_b32 v139, a95
    v_mul_f32 v136, v136, v209
    v_mul_f32 v137, v137, v209
    v_mul_f32 v138, v138, v209
    v_mul_f32 v139, v139, v209
    v_accvgpr_write_b32 a92, v136
    v_accvgpr_write_b32 a93, v137
    v_accvgpr_write_b32 a94, v138
    v_accvgpr_write_b32 a95, v139
    v_accvgpr_read_b32 v136, a96
    v_accvgpr_read_b32 v137, a97
    v_accvgpr_read_b32 v138, a98
    v_accvgpr_read_b32 v139, a99
    v_mul_f32 v136, v136, v210
    v_mul_f32 v137, v137, v210
    v_mul_f32 v138, v138, v210
    v_mul_f32 v139, v139, v210
    v_accvgpr_write_b32 a96, v136
    v_accvgpr_write_b32 a97, v137
    v_accvgpr_write_b32 a98, v138
    v_accvgpr_write_b32 a99, v139
    v_accvgpr_read_b32 v136, a100
    v_accvgpr_read_b32 v137, a101
    v_accvgpr_read_b32 v138, a102
    v_accvgpr_read_b32 v139, a103
    v_mul_f32 v136, v136, v206
    v_mul_f32 v137, v137, v206
    v_mul_f32 v138, v138, v206
    v_mul_f32 v139, v139, v206
    v_accvgpr_write_b32 a100, v136
    v_accvgpr_write_b32 a101, v137
    v_accvgpr_write_b32 a102, v138
    v_accvgpr_write_b32 a103, v139
    v_accvgpr_read_b32 v136, a104
    v_accvgpr_read_b32 v137, a105
    v_accvgpr_read_b32 v138, a106
    v_accvgpr_read_b32 v139, a107
    v_mul_f32 v136, v136, v207
    v_mul_f32 v137, v137, v207
    v_mul_f32 v138, v138, v207
    v_mul_f32 v139, v139, v207
    v_accvgpr_write_b32 a104, v136
    v_accvgpr_write_b32 a105, v137
    v_accvgpr_write_b32 a106, v138
    v_accvgpr_write_b32 a107, v139
    v_accvgpr_read_b32 v136, a108
    v_accvgpr_read_b32 v137, a109
    v_accvgpr_read_b32 v138, a110
    v_accvgpr_read_b32 v139, a111
    v_mul_f32 v136, v136, v208
    v_mul_f32 v137, v137, v208
    v_mul_f32 v138, v138, v208
    v_mul_f32 v139, v139, v208
    v_accvgpr_write_b32 a108, v136
    v_accvgpr_write_b32 a109, v137
    v_accvgpr_write_b32 a110, v138
    v_accvgpr_write_b32 a111, v139
    v_accvgpr_read_b32 v136, a112
    v_accvgpr_read_b32 v137, a113
    v_accvgpr_read_b32 v138, a114
    v_accvgpr_read_b32 v139, a115
    v_mul_f32 v136, v136, v209
    v_mul_f32 v137, v137, v209
    v_mul_f32 v138, v138, v209
    v_mul_f32 v139, v139, v209
    v_accvgpr_write_b32 a112, v136
    v_accvgpr_write_b32 a113, v137
    v_accvgpr_write_b32 a114, v138
    v_accvgpr_write_b32 a115, v139
    v_accvgpr_read_b32 v136, a116
    v_accvgpr_read_b32 v137, a117
    v_accvgpr_read_b32 v138, a118
    v_accvgpr_read_b32 v139, a119
    v_mul_f32 v136, v136, v210
    v_mul_f32 v137, v137, v210
    v_mul_f32 v138, v138, v210
    v_mul_f32 v139, v139, v210
    v_accvgpr_write_b32 a116, v136
    v_accvgpr_write_b32 a117, v137
    v_accvgpr_write_b32 a118, v138
    v_accvgpr_write_b32 a119, v139
    v_accvgpr_read_b32 v136, a120
    v_accvgpr_read_b32 v137, a121
    v_accvgpr_read_b32 v138, a122
    v_accvgpr_read_b32 v139, a123
    v_mul_f32 v136, v136, v206
    v_mul_f32 v137, v137, v206
    v_mul_f32 v138, v138, v206
    v_mul_f32 v139, v139, v206
    v_accvgpr_write_b32 a120, v136
    v_accvgpr_write_b32 a121, v137
    v_accvgpr_write_b32 a122, v138
    v_accvgpr_write_b32 a123, v139
    v_accvgpr_read_b32 v136, a124
    v_accvgpr_read_b32 v137, a125
    v_accvgpr_read_b32 v138, a126
    v_accvgpr_read_b32 v139, a127
    v_mul_f32 v136, v136, v207
    v_mul_f32 v137, v137, v207
    v_mul_f32 v138, v138, v207
    v_mul_f32 v139, v139, v207
    v_accvgpr_write_b32 a124, v136
    v_accvgpr_write_b32 a125, v137
    v_accvgpr_write_b32 a126, v138
    v_accvgpr_write_b32 a127, v139
    v_accvgpr_read_b32 v136, a128
    v_accvgpr_read_b32 v137, a129
    v_accvgpr_read_b32 v138, a130
    v_accvgpr_read_b32 v139, a131
    v_mul_f32 v136, v136, v208
    v_mul_f32 v137, v137, v208
    v_mul_f32 v138, v138, v208
    v_mul_f32 v139, v139, v208
    v_accvgpr_write_b32 a128, v136
    v_accvgpr_write_b32 a129, v137
    v_accvgpr_write_b32 a130, v138
    v_accvgpr_write_b32 a131, v139
    v_accvgpr_read_b32 v136, a132
    v_accvgpr_read_b32 v137, a133
    v_accvgpr_read_b32 v138, a134
    v_accvgpr_read_b32 v139, a135
    v_mul_f32 v136, v136, v209
    v_mul_f32 v137, v137, v209
    v_mul_f32 v138, v138, v209
    v_mul_f32 v139, v139, v209
    v_accvgpr_write_b32 a132, v136
    v_accvgpr_write_b32 a133, v137
    v_accvgpr_write_b32 a134, v138
    v_accvgpr_write_b32 a135, v139
    v_accvgpr_read_b32 v136, a136
    v_accvgpr_read_b32 v137, a137
    v_accvgpr_read_b32 v138, a138
    v_accvgpr_read_b32 v139, a139
    v_mul_f32 v136, v136, v210
    v_mul_f32 v137, v137, v210
    v_mul_f32 v138, v138, v210
    v_mul_f32 v139, v139, v210
    v_accvgpr_write_b32 a136, v136
    v_accvgpr_write_b32 a137, v137
    v_accvgpr_write_b32 a138, v138
    v_accvgpr_write_b32 a139, v139
    v_accvgpr_read_b32 v136, a140
    v_accvgpr_read_b32 v137, a141
    v_accvgpr_read_b32 v138, a142
    v_accvgpr_read_b32 v139, a143
    v_mul_f32 v136, v136, v206
    v_mul_f32 v137, v137, v206
    v_mul_f32 v138, v138, v206
    v_mul_f32 v139, v139, v206
    v_accvgpr_write_b32 a140, v136
    v_accvgpr_write_b32 a141, v137
    v_accvgpr_write_b32 a142, v138
    v_accvgpr_write_b32 a143, v139
    v_accvgpr_read_b32 v136, a144
    v_accvgpr_read_b32 v137, a145
    v_accvgpr_read_b32 v138, a146
    v_accvgpr_read_b32 v139, a147
    v_mul_f32 v136, v136, v207
    v_mul_f32 v137, v137, v207
    v_mul_f32 v138, v138, v207
    v_mul_f32 v139, v139, v207
    v_accvgpr_write_b32 a144, v136
    v_accvgpr_write_b32 a145, v137
    v_accvgpr_write_b32 a146, v138
    v_accvgpr_write_b32 a147, v139
    v_accvgpr_read_b32 v136, a148
    v_accvgpr_read_b32 v137, a149
    v_accvgpr_read_b32 v138, a150
    v_accvgpr_read_b32 v139, a151
    v_mul_f32 v136, v136, v208
    v_mul_f32 v137, v137, v208
    v_mul_f32 v138, v138, v208
    v_mul_f32 v139, v139, v208
    v_accvgpr_write_b32 a148, v136
    v_accvgpr_write_b32 a149, v137
    v_accvgpr_write_b32 a150, v138
    v_accvgpr_write_b32 a151, v139
    v_accvgpr_read_b32 v136, a152
    v_accvgpr_read_b32 v137, a153
    v_accvgpr_read_b32 v138, a154
    v_accvgpr_read_b32 v139, a155
    v_mul_f32 v136, v136, v209
    v_mul_f32 v137, v137, v209
    v_mul_f32 v138, v138, v209
    v_mul_f32 v139, v139, v209
    v_accvgpr_write_b32 a152, v136
    v_accvgpr_write_b32 a153, v137
    v_accvgpr_write_b32 a154, v138
    v_accvgpr_write_b32 a155, v139
    v_accvgpr_read_b32 v136, a156
    v_accvgpr_read_b32 v137, a157
    v_accvgpr_read_b32 v138, a158
    v_accvgpr_read_b32 v139, a159
    v_mul_f32 v136, v136, v210
    v_mul_f32 v137, v137, v210
    v_mul_f32 v138, v138, v210
    v_mul_f32 v139, v139, v210
    v_accvgpr_write_b32 a156, v136
    v_accvgpr_write_b32 a157, v137
    v_accvgpr_write_b32 a158, v138
    v_accvgpr_write_b32 a159, v139
    v_sub_f32 v96, v96, v176
    v_sub_f32 v97, v97, v176
    v_sub_f32 v98, v98, v176
    v_sub_f32 v99, v99, v176
    v_sub_f32 v100, v100, v176
    v_sub_f32 v101, v101, v176
    v_sub_f32 v102, v102, v176
    v_sub_f32 v103, v103, v176
    v_exp_f32 v96, v96
    v_exp_f32 v97, v97
    v_exp_f32 v98, v98
    v_exp_f32 v99, v99
    v_exp_f32 v100, v100
    v_exp_f32 v101, v101
    v_exp_f32 v102, v102
    v_exp_f32 v103, v103
    s_nop 0
    v_add_f32 v196, v196, v96
    v_add_f32 v196, v196, v97
    v_add_f32 v196, v196, v98
    v_add_f32 v196, v196, v99
    v_add_f32 v196, v196, v100
    v_add_f32 v196, v196, v101
    v_add_f32 v196, v196, v102
    v_add_f32 v196, v196, v103
    v_cvt_pk_bf16_f32 v96, v96, v97
    v_cvt_pk_bf16_f32 v97, v98, v99
    v_cvt_pk_bf16_f32 v98, v100, v101
    v_cvt_pk_bf16_f32 v99, v102, v103
    v_sub_f32 v104, v104, v177
    v_sub_f32 v105, v105, v177
    v_sub_f32 v106, v106, v177
    v_sub_f32 v107, v107, v177
    v_sub_f32 v108, v108, v177
    v_sub_f32 v109, v109, v177
    v_sub_f32 v110, v110, v177
    v_sub_f32 v111, v111, v177
    v_exp_f32 v104, v104
    v_exp_f32 v105, v105
    v_exp_f32 v106, v106
    v_exp_f32 v107, v107
    v_exp_f32 v108, v108
    v_exp_f32 v109, v109
    v_exp_f32 v110, v110
    v_exp_f32 v111, v111
    s_nop 0
    v_add_f32 v197, v197, v104
    v_add_f32 v197, v197, v105
    v_add_f32 v197, v197, v106
    v_add_f32 v197, v197, v107
    v_add_f32 v197, v197, v108
    v_add_f32 v197, v197, v109
    v_add_f32 v197, v197, v110
    v_add_f32 v197, v197, v111
    v_cvt_pk_bf16_f32 v104, v104, v105
    v_cvt_pk_bf16_f32 v105, v106, v107
    v_cvt_pk_bf16_f32 v106, v108, v109
    v_cvt_pk_bf16_f32 v107, v110, v111
    v_sub_f32 v112, v112, v178
    v_sub_f32 v113, v113, v178
    v_sub_f32 v114, v114, v178
    v_sub_f32 v115, v115, v178
    v_sub_f32 v116, v116, v178
    v_sub_f32 v117, v117, v178
    v_sub_f32 v118, v118, v178
    v_sub_f32 v119, v119, v178
    v_exp_f32 v112, v112
    v_exp_f32 v113, v113
    v_exp_f32 v114, v114
    v_exp_f32 v115, v115
    v_exp_f32 v116, v116
    v_exp_f32 v117, v117
    v_exp_f32 v118, v118
    v_exp_f32 v119, v119
    s_nop 0
    v_add_f32 v198, v198, v112
    v_add_f32 v198, v198, v113
    v_add_f32 v198, v198, v114
    v_add_f32 v198, v198, v115
    v_add_f32 v198, v198, v116
    v_add_f32 v198, v198, v117
    v_add_f32 v198, v198, v118
    v_add_f32 v198, v198, v119
    v_cvt_pk_bf16_f32 v112, v112, v113
    v_cvt_pk_bf16_f32 v113, v114, v115
    v_cvt_pk_bf16_f32 v114, v116, v117
    v_cvt_pk_bf16_f32 v115, v118, v119
    v_sub_f32 v120, v120, v179
    v_sub_f32 v121, v121, v179
    v_sub_f32 v122, v122, v179
    v_sub_f32 v123, v123, v179
    v_sub_f32 v124, v124, v179
    v_sub_f32 v125, v125, v179
    v_sub_f32 v126, v126, v179
    v_sub_f32 v127, v127, v179
    v_exp_f32 v120, v120
    v_exp_f32 v121, v121
    v_exp_f32 v122, v122
    v_exp_f32 v123, v123
    v_exp_f32 v124, v124
    v_exp_f32 v125, v125
    v_exp_f32 v126, v126
    v_exp_f32 v127, v127
    s_nop 0
    v_add_f32 v199, v199, v120
    v_add_f32 v199, v199, v121
    v_add_f32 v199, v199, v122
    v_add_f32 v199, v199, v123
    v_add_f32 v199, v199, v124
    v_add_f32 v199, v199, v125
    v_add_f32 v199, v199, v126
    v_add_f32 v199, v199, v127
    v_cvt_pk_bf16_f32 v120, v120, v121
    v_cvt_pk_bf16_f32 v121, v122, v123
    v_cvt_pk_bf16_f32 v122, v124, v125
    v_cvt_pk_bf16_f32 v123, v126, v127
    v_sub_f32 v128, v128, v180
    v_sub_f32 v129, v129, v180
    v_sub_f32 v130, v130, v180
    v_sub_f32 v131, v131, v180
    v_sub_f32 v132, v132, v180
    v_sub_f32 v133, v133, v180
    v_sub_f32 v134, v134, v180
    v_sub_f32 v135, v135, v180
    v_exp_f32 v128, v128
    v_exp_f32 v129, v129
    v_exp_f32 v130, v130
    v_exp_f32 v131, v131
    v_exp_f32 v132, v132
    v_exp_f32 v133, v133
    v_exp_f32 v134, v134
    v_exp_f32 v135, v135
    s_nop 0
    v_add_f32 v200, v200, v128
    v_add_f32 v200, v200, v129
    v_add_f32 v200, v200, v130
    v_add_f32 v200, v200, v131
    v_add_f32 v200, v200, v132
    v_add_f32 v200, v200, v133
    v_add_f32 v200, v200, v134
    v_add_f32 v200, v200, v135
    v_cvt_pk_bf16_f32 v128, v128, v129
    v_cvt_pk_bf16_f32 v129, v130, v131
    v_cvt_pk_bf16_f32 v130, v132, v133
    v_cvt_pk_bf16_f32 v131, v134, v135
    s_waitcnt lgkmcnt(0)
    s_nop 1
    v_mfma_f32_16x16x32_bf16 a[0:3], a[192:195], v[96:99], a[0:3]
    v_mfma_f32_16x16x32_bf16 a[4:7], a[192:195], v[104:107], a[4:7]
    v_mfma_f32_16x16x32_bf16 a[8:11], a[192:195], v[112:115], a[8:11]
    v_mfma_f32_16x16x32_bf16 a[12:15], a[192:195], v[120:123], a[12:15]
    v_mfma_f32_16x16x32_bf16 a[16:19], a[192:195], v[128:131], a[16:19]
    v_mfma_f32_16x16x32_bf16 a[20:23], a[196:199], v[96:99], a[20:23]
    v_mfma_f32_16x16x32_bf16 a[24:27], a[196:199], v[104:107], a[24:27]
    v_mfma_f32_16x16x32_bf16 a[28:31], a[196:199], v[112:115], a[28:31]
    v_mfma_f32_16x16x32_bf16 a[32:35], a[196:199], v[120:123], a[32:35]
    v_mfma_f32_16x16x32_bf16 a[36:39], a[196:199], v[128:131], a[36:39]
    v_mfma_f32_16x16x32_bf16 a[40:43], a[200:203], v[96:99], a[40:43]
    v_mfma_f32_16x16x32_bf16 a[44:47], a[200:203], v[104:107], a[44:47]
    v_mfma_f32_16x16x32_bf16 a[48:51], a[200:203], v[112:115], a[48:51]
    v_mfma_f32_16x16x32_bf16 a[52:55], a[200:203], v[120:123], a[52:55]
    v_mfma_f32_16x16x32_bf16 a[56:59], a[200:203], v[128:131], a[56:59]
    v_mfma_f32_16x16x32_bf16 a[60:63], a[204:207], v[96:99], a[60:63]
    v_mfma_f32_16x16x32_bf16 a[64:67], a[204:207], v[104:107], a[64:67]
    v_mfma_f32_16x16x32_bf16 a[68:71], a[204:207], v[112:115], a[68:71]
    v_mfma_f32_16x16x32_bf16 a[72:75], a[204:207], v[120:123], a[72:75]
    v_mfma_f32_16x16x32_bf16 a[76:79], a[204:207], v[128:131], a[76:79]
    v_mfma_f32_16x16x32_bf16 a[80:83], a[208:211], v[96:99], a[80:83]
    v_mfma_f32_16x16x32_bf16 a[84:87], a[208:211], v[104:107], a[84:87]
    v_mfma_f32_16x16x32_bf16 a[88:91], a[208:211], v[112:115], a[88:91]
    v_mfma_f32_16x16x32_bf16 a[92:95], a[208:211], v[120:123], a[92:95]
    v_mfma_f32_16x16x32_bf16 a[96:99], a[208:211], v[128:131], a[96:99]
    v_mfma_f32_16x16x32_bf16 a[100:103], a[212:215], v[96:99], a[100:103]
    v_mfma_f32_16x16x32_bf16 a[104:107], a[212:215], v[104:107], a[104:107]
    v_mfma_f32_16x16x32_bf16 a[108:111], a[212:215], v[112:115], a[108:111]
    v_mfma_f32_16x16x32_bf16 a[112:115], a[212:215], v[120:123], a[112:115]
    v_mfma_f32_16x16x32_bf16 a[116:119], a[212:215], v[128:131], a[116:119]
    v_mfma_f32_16x16x32_bf16 a[120:123], a[216:219], v[96:99], a[120:123]
    v_mfma_f32_16x16x32_bf16 a[124:127], a[216:219], v[104:107], a[124:127]
    v_mfma_f32_16x16x32_bf16 a[128:131], a[216:219], v[112:115], a[128:131]
    v_mfma_f32_16x16x32_bf16 a[132:135], a[216:219], v[120:123], a[132:135]
    v_mfma_f32_16x16x32_bf16 a[136:139], a[216:219], v[128:131], a[136:139]
    v_mfma_f32_16x16x32_bf16 a[140:143], a[220:223], v[96:99], a[140:143]
    v_mfma_f32_16x16x32_bf16 a[144:147], a[220:223], v[104:107], a[144:147]
    v_mfma_f32_16x16x32_bf16 a[148:151], a[220:223], v[112:115], a[148:151]
    v_mfma_f32_16x16x32_bf16 a[152:155], a[220:223], v[120:123], a[152:155]
    v_mfma_f32_16x16x32_bf16 a[156:159], a[220:223], v[128:131], a[156:159]
    s_add_u32 s44, s44, 1
    s_cmp_lt_u32 s44, 32
    s_cbranch_scc1 K1_SLOOP
    v_mov_b32 v201, v196
    v_mov_b32 v202, v197
    v_mov_b32 v203, v198
    v_mov_b32 v204, v199
    v_mov_b32 v205, v200
    s_nop 1
    v_permlane32_swap_b32 v196, v201
    v_permlane32_swap_b32 v197, v202
    v_permlane32_swap_b32 v198, v203
    v_permlane32_swap_b32 v199, v204
    v_permlane32_swap_b32 v200, v205
    s_nop 1
    v_add_f32 v196, v196, v201
    v_add_f32 v197, v197, v202
    v_add_f32 v198, v198, v203
    v_add_f32 v199, v199, v204
    v_add_f32 v200, v200, v205
    v_mov_b32 v201, v196
    v_mov_b32 v202, v197
    v_mov_b32 v203, v198
    v_mov_b32 v204, v199
    v_mov_b32 v205, v200
    s_nop 1
    v_permlane16_swap_b32 v196, v201
    v_permlane16_swap_b32 v197, v202
    v_permlane16_swap_b32 v198, v203
    v_permlane16_swap_b32 v199, v204
    v_permlane16_swap_b32 v200, v205
    s_nop 1
    v_add_f32 v196, v196, v201
    v_add_f32 v197, v197, v202
    v_add_f32 v198, v198, v203
    v_add_f32 v199, v199, v204
    v_add_f32 v200, v200, v205
    v_mov_b32 v136, 0
    v_mov_b32 v137, 0
    v_mov_b32 v138, 0
    v_mov_b32 v139, 0
    v_mov_b32 v144, 0
    v_mov_b32 v145, 0
    v_mov_b32 v146, 0
    v_mov_b32 v147, 0
    v_mov_b32 v152, 0
    v_mov_b32 v153, 0
    v_mov_b32 v154, 0
    v_mov_b32 v155, 0
    v_mov_b32 v160, 0
    v_mov_b32 v161, 0
    v_mov_b32 v162, 0
    v_mov_b32 v163, 0
    v_mov_b32 v168, 0
    v_mov_b32 v169, 0
    v_mov_b32 v170, 0
    v_mov_b32 v171, 0
    s_barrier
    s_branch K1_SLOWRET
K1_END:
    s_endpgm
.section .rodata,"a"
.p2align 6
.amdhsa_kernel concat_heads__gqa_block_cached__gqa_block_cached__near_ridge_kernel
  .amdhsa_next_free_vgpr 512
  .amdhsa_next_free_sgpr 102
  .amdhsa_accum_offset 256
  .amdhsa_group_segment_fixed_size 0
  .amdhsa_kernarg_size 104
  .amdhsa_user_sgpr_count 2
  .amdhsa_user_sgpr_kernarg_segment_ptr 1
  .amdhsa_system_sgpr_workgroup_id_x 1
.end_amdhsa_kernel
```
